```python
import torch

def _softmax(x, axis=-1):
    return torch.softmax(x, dim=axis)
def _gelu(x):
    return torch.nn.functional.gelu(x, approximate="tanh")
def _silu(x):
    return torch.nn.functional.silu(x)
def _sigmoid(x):
    return torch.sigmoid(x)
def _layernorm(x, axis=-1, eps=1e-5):
    m = x.mean(dim=axis, keepdim=True)
    v = x.var(dim=axis, keepdim=True, unbiased=False)
    return (x - m) / torch.sqrt(v + eps)
def _scatter_add(tgt, idx, src, axis=0):
    return tgt.clone().index_add_(axis, idx, src)
def _segment_sum(src, seg, n):
    out = torch.zeros((n,) + src.shape[1:], dtype=src.dtype)
    return out.index_add_(0, seg, src)
def _pad(x, pw):
    flat = tuple(v for pair in reversed(pw) for v in pair)
    return torch.nn.functional.pad(x, flat)

kernel_name = 'parallel_sum__ssm_conv_s5__mixer_token_mlp__prompt'

def setup_inputs():

    _w = (lambda a: (lambda t: t.to(torch.bfloat16) if t.is_floating_point() else t)(torch.as_tensor(a)))
    def _A_setup():
        B, S, D = 1, 2048, 576
        P = D
        Lambda_re = -0.5 * (lambda _x: torch.exp(torch.as_tensor(_x)))((lambda *s: torch.randn(*s, dtype=torch.bfloat16) * 0.2)(P))
        Lambda_im = (lambda *s: torch.randn(*s, dtype=torch.bfloat16) * 0.8)(P) * 1.0
        B_re = (lambda *s: torch.randn(*s, dtype=torch.bfloat16) * 0.2)(P, D) * (D ** -0.5)
        B_im = (lambda *s: torch.randn(*s, dtype=torch.bfloat16) * 0.2)(P, D) * (D ** -0.5)
        C_re = (lambda *s: torch.randn(*s, dtype=torch.bfloat16) * 0.2)(D, P) * (P ** -0.5)
        C_im = (lambda *s: torch.randn(*s, dtype=torch.bfloat16) * 0.2)(D, P) * (P ** -0.5)
        log_dt = (lambda *s: torch.randn(*s, dtype=torch.bfloat16) * 0.2)(P) * 0.3 - 2.0
        Dskip = (lambda *s: torch.randn(*s, dtype=torch.bfloat16) * 0.05)(D)
        return {
            "x": _w((lambda *s: torch.randn(*s, dtype=torch.bfloat16) * 0.05)(B, S, D)),
            "Lambda_re": _w(Lambda_re),
            "Lambda_im": _w(Lambda_im),
            "B_re": _w(B_re),
            "B_im": _w(B_im),
            "C_re": _w(C_re),
            "C_im": _w(C_im),
            "log_dt": _w(log_dt),
            "Dskip": _w(Dskip),
        }
    _A_in = _A_setup()

    def _B_setup():
        B, S, D, F = 1, 2048, 576, 4608
        return {
            "x": _w((lambda *s: torch.randn(*s, dtype=torch.bfloat16) * 0.05)(B, S, D)),
            "w1": _w((lambda *s: torch.randn(*s, dtype=torch.bfloat16) * 0.8)(S, F) * (S ** -0.5)),
            "b1": _w((lambda *s: torch.randn(*s, dtype=torch.bfloat16) * 3.2)(F) * 0.02),
            "w2": _w((lambda *s: torch.randn(*s, dtype=torch.bfloat16) * 0.4)(F, S) * (F ** -0.5)),
            "b2": _w((lambda *s: torch.randn(*s, dtype=torch.bfloat16) * 3.2)(S) * 0.02),
        }
    _B_in = _B_setup()

    return {
        "A_x": _A_in["x"],
        "A_Lambda_re": _A_in["Lambda_re"],
        "A_Lambda_im": _A_in["Lambda_im"],
        "A_B_re": _A_in["B_re"],
        "A_B_im": _A_in["B_im"],
        "A_C_re": _A_in["C_re"],
        "A_C_im": _A_in["C_im"],
        "A_log_dt": _A_in["log_dt"],
        "A_Dskip": _A_in["Dskip"],
        "B_x": _B_in["x"],
        "B_w1": _B_in["w1"],
        "B_b1": _B_in["b1"],
        "B_w2": _B_in["w2"],
        "B_b2": _B_in["b2"],
    }

def reference(A_x, A_Lambda_re, A_Lambda_im, A_B_re, A_B_im, A_C_re, A_C_im, A_log_dt, A_Dskip, B_x, B_w1, B_b1, B_w2, B_b2):
    def _A_ref(x, Lambda_re, Lambda_im, B_re, B_im, C_re, C_im, log_dt, Dskip):
        Bsz, L, H = x.shape
        Lam = Lambda_re + 1j * Lambda_im
        Bmat = B_re + 1j * B_im
        Cmat = C_re + 1j * C_im
        dt = torch.exp(log_dt)
        Lam_bar = torch.exp(dt * Lam)
        B_bar = ((Lam_bar - 1.0) / Lam)[:, None] * Bmat
        Bu = torch.einsum("bld,pd->blp", x + 0j, B_bar)
        h = torch.zeros_like(Bu[:, 0, :])
        hs = []
        for t in range(L):
            h = Lam_bar[None, :] * h + Bu[:, t, :]
            hs.append(h)
        hseq = torch.stack(hs, 1)
        y = 2.0 * torch.einsum("blp,dp->bld", hseq, Cmat).real + x * Dskip[None, None, :]
        return y

    def _B_ref(x, w1, b1, w2, b2):
        B, S, D = x.shape
        h = _layernorm(x, axis=-1)
        u = torch.einsum("bsd,sf->bdf", h, w1) + b1
        u = _gelu(u)
        y = torch.einsum("bdf,fs->bds", u, w2) + b2
        return (lambda x, *d: x.permute(*d))(y, 0, 2, 1)

    x = A_x
    xn = _layernorm(x, axis=-1)
    return x + _A_ref(xn, A_Lambda_re, A_Lambda_im, A_B_re, A_B_im, A_C_re, A_C_im, A_log_dt, A_Dskip) + _B_ref(xn, B_w1, B_b1, B_w2, B_b2)
```

```asm
; @launch grid=(256,1,1) block=(512,1,1) lds=163840
.amdgcn_target "amdgcn-amd-amdhsa--gfx950"
.text
.globl parallel_sum__ssm_conv_s5__mixer_token_mlp__prompt_kernel
.p2align 8
.type parallel_sum__ssm_conv_s5__mixer_token_mlp__prompt_kernel,@function
parallel_sum__ssm_conv_s5__mixer_token_mlp__prompt_kernel:
    s_cmp_ge_u32 s2, 256
    s_cbranch_scc1 k_end
    s_load_dwordx16 s[64:79], s[0:1], 0
    s_load_dwordx16 s[80:95], s[0:1], 64
    s_load_dwordx2 s[96:97], s[0:1], 128
    s_memrealtime s[24:25]
    v_lshrrev_b32 v1, 6, v0
    v_and_b32 v2, 63, v0
    v_readfirstlane_b32 s20, v1
    s_and_b32 s22, s2, 7
    s_lshr_b32 s21, s2, 3
    s_sub_u32 s3, s21, 19
    s_cmp_lt_u32 s3, 8
    s_cselect_b32 s26, 3, 4
    s_mul_i32 s26, s26, 28672
    v_lshlrev_b32 v248, 3, v2
    s_cmp_ge_u32 s21, 12
    s_cselect_b32 s30, 1, 0
    s_cselect_b32 s31, 12, 0
    s_cmp_ge_u32 s21, 27
    s_cselect_b32 s31, 20, s31
    s_sub_u32 s31, s21, s31
    s_lshl_b32 s3, s22, 1
    s_add_u32 s30, s30, s3
    s_cmp_ge_u32 s20, 4
    s_cbranch_scc1 hi_entry
c1_entry:
    s_lshr_b32 s44, s2, 2
    s_lshl_b32 s44, s44, 5
    s_and_b32 s45, s2, 3
    s_lshl_b32 s45, s45, 2
    s_add_u32 s44, s44, s45
    s_lshr_b32 s45, s20, 1
    s_lshl_b32 s45, s45, 4
    s_add_u32 s44, s44, s45
    s_and_b32 s45, s20, 1
    s_lshl_b32 s45, s45, 1
    s_add_u32 s51, s44, s45
    s_mul_i32 s44, s51, 1152
    v_lshrrev_b32 v3, 5, v2
    v_and_b32 v4, 31, v2
    v_mul_u32_u24 v5, 1152, v3
    v_lshl_add_u32 v6, v4, 2, v5
    v_lshl_add_u32 v5, v4, 3, v5
    s_waitcnt lgkmcnt(0)
    s_mov_b32 s4, s64
    s_mov_b32 s5, s65
    s_mov_b32 s6, 0x240000
    s_mov_b32 s7, 0x00020000
    buffer_load_dwordx2 v[164:165], v5, s[4:7], s44 offen offset:0
    buffer_load_dwordx2 v[166:167], v5, s[4:7], s44 offen offset:256
    buffer_load_dwordx2 v[168:169], v5, s[4:7], s44 offen offset:512
    buffer_load_dwordx2 v[170:171], v5, s[4:7], s44 offen offset:768
    buffer_load_dword v172, v6, s[4:7], s44 offen offset:1024
    s_mul_i32 s45, s20, 2688
    s_add_u32 s45, s45, 143360
    v_mul_u32_u24 v238, 1344, v3
    v_add_u32 v238, s45, v238
    v_lshl_add_u32 v195, v4, 2, v238
    v_lshl_add_u32 v238, v4, 3, v238
    v_lshlrev_b32 v198, 3, v3
    v_bfe_u32 v5, v2, 2, 2
    v_mul_u32_u24 v5, 1344, v5
    v_and_b32 v6, 3, v2
    v_lshl_add_u32 v5, v6, 3, v5
    v_lshrrev_b32 v6, 4, v2
    v_lshl_add_u32 v5, v6, 5, v5
    v_add_u32 v239, 143360, v5
    v_and_b32 v5, 15, v2
    v_lshlrev_b32 v5, 4, v5
    v_lshl_add_u32 v199, v6, 11, v5
    s_and_b32 s45, s2, 3
    s_cmp_eq_u32 s45, 1
    s_cselect_b32 s45, 0x3000080, 0
    v_cmp_le_u32 vcc, 128, v5
    v_add_u32 v5, s45, v199
    s_nop 0
    v_cndmask_b32 v199, v199, v5, vcc
    s_or_b32 s44, s2, s20
    s_cbranch_scc1 c1_notag
    s_mov_b32 s60, s94
    s_mov_b32 s61, s95
    s_mov_b32 s62, 0x100
    s_mov_b32 s63, 0x00020000
    s_or_b32 s24, s24, 1
    v_mov_b32 v4, s24
    v_mov_b32 v5, s25
    v_mov_b32 v6, 0
    s_mov_b64 exec, 1
    buffer_store_dwordx2 v[4:5], v6, s[60:63], 0 offen sc1
    s_mov_b64 exec, -1
c1_notag:
    s_and_b32 s40, s20, 1
    s_lshr_b32 s41, s20, 1
    v_and_b32 v3, 15, v2
    v_lshrrev_b32 v4, 4, v2
    v_and_b32 v5, 7, v3
    v_xor_b32 v5, v5, v4
    v_lshlrev_b32 v5, 4, v5
    v_lshl_add_u32 v5, v3, 7, v5
    v_and_b32 v6, 1, v3
    v_lshrrev_b32 v7, 1, v3
    v_and_b32 v8, 6, v7
    v_or_b32 v8, v8, v6
    v_xor_b32 v8, v8, v4
    v_lshlrev_b32 v8, 4, v8
    v_mul_u32_u24 v6, 48, v6
    v_add_u32 v6, v6, v7
    v_lshl_add_u32 v8, v6, 7, v8
    s_lshl_b32 s44, s40, 13
    s_mul_i32 s45, s41, 3072
    s_add_u32 s45, s45, 16384
    v_add_u32 v200, s44, v5
    v_xor_b32 v201, 64, v200
    v_add_u32 v202, s45, v8
    v_xor_b32 v203, 64, v202
    v_lshlrev_b32 v218, 4, v4
    v_lshl_add_u32 v218, v3, 6, v218
    v_add_u32 v10, s26, v200
    v_add_u32 v11, s26, v201
    v_add_u32 v12, s26, v202
    v_add_u32 v13, s26, v203
    v_lshlrev_b32 v219, 4, v3
    v_lshlrev_b32 v20, 4, v4
    s_lshl_b32 s3, s22, 3
    s_mov_b32 s32, 0x206090c
    s_mov_b32 s33, 0xf121518
    s_lshr_b64 s[32:33], s[32:33], s3
    s_and_b32 s32, s32, 0xff
    s_add_u32 s32, s32, s21
    s_cmp_ge_u32 s32, 27
    s_cselect_b32 s3, 27, 0
    s_sub_u32 s32, s32, s3
    s_mul_i32 s3, s22, 27
    s_add_u32 s3, s3, s32
    s_mul_i32 s32, s3, 43691
    s_lshr_b32 s32, s32, 18
    s_mul_i32 s33, s32, 6
    s_sub_u32 s33, s3, s33
    s_lshr_b32 s34, s22, 1
    s_and_b32 s3, s22, 1
    s_lshl_b32 s3, s3, 3
    s_lshr_b32 s35, s21, 2
    s_add_u32 s35, s35, s3
    s_and_b32 s36, s21, 3
    s_cmp_ge_u32 s34, 2
    s_cselect_b32 s38, 4, 5
    s_add_u32 s37, s38, 18
    s_mul_i32 s39, s34, 5
    s_cmp_eq_u32 s34, 3
    s_cselect_b32 s39, 14, s39
    v_lshrrev_b32 v5, 2, v2
    v_and_b32 v6, 7, v5
    v_and_b32 v7, 3, v2
    v_lshlrev_b32 v7, 3, v7
    v_lshl_add_u32 v7, v5, 8, v7
    s_lshl_b32 s44, s40, 2
    s_add_u32 s45, s44, 0
    v_xor_b32 v8, s45, v6
    v_lshl_add_u32 v204, v8, 5, v7
    s_add_u32 s45, s44, 1
    v_xor_b32 v8, s45, v6
    v_lshl_add_u32 v205, v8, 5, v7
    s_add_u32 s45, s44, 2
    v_xor_b32 v8, s45, v6
    v_lshl_add_u32 v206, v8, 5, v7
    s_add_u32 s45, s44, 3
    v_xor_b32 v8, s45, v6
    v_lshl_add_u32 v207, v8, 5, v7
    s_mul_i32 s45, s41, 6144
    s_add_u32 s45, s45, 16384
    v_lshlrev_b32 v216, 4, v2
    v_add_u32 v208, s45, v216
    s_lshl_b32 s44, s20, 1
    s_add_u32 s45, s44, 0
    v_xor_b32 v8, s45, v6
    v_lshl_add_u32 v209, v8, 5, v7
    s_add_u32 s45, s44, 1
    v_xor_b32 v8, s45, v6
    v_lshl_add_u32 v210, v8, 5, v7
    v_and_b32 v3, 15, v2
    v_lshrrev_b32 v4, 4, v2
    v_and_b32 v5, 7, v3
    v_xor_b32 v5, v5, v4
    v_lshlrev_b32 v5, 4, v5
    v_lshl_add_u32 v5, v3, 7, v5
    v_add_u32 v211, 16384, v5
    v_xor_b32 v212, 64, v211
    v_add_u32 v213, 16384, v216
    v_add_u32 v214, 17408, v216
    v_lshlrev_b32 v217, 3, v4
    v_mov_b32 v215, v216
    v_lshrrev_b32 v5, 3, v2
    v_cmp_eq_u32 vcc, 3, v5
    v_add_u32 v5, 0x3000080, v215
    s_nop 0
    v_cndmask_b32 v215, v215, v5, vcc
    s_add_u32 s16, s96, 0x1910000
    s_addc_u32 s17, s97, 0
    s_mov_b32 s18, 0x10000
    s_mov_b32 s19, 0x00020000
    s_mul_i32 s44, s31, 6
    s_mul_i32 s45, s41, 3
    s_add_u32 s44, s44, s45
    s_lshl_b32 s54, s44, 6
    s_add_u32 s54, s54, 16384
    s_lshl_b32 s44, s44, 16
    s_lshl_b32 s45, s30, 1
    s_add_u32 s45, s45, s40
    s_lshl_b32 s49, s45, 9
    s_lshl_b32 s45, s45, 11
    s_add_u32 s42, s44, s45
    s_add_u32 s43, s42, 65536
    s_add_u32 s48, s42, 131072
    s_lshl_b32 s50, s31, 4
    s_add_u32 s50, s50, s30
    s_lshl_b32 s50, s50, 2
    s_add_u32 s50, s50, s20
    s_lshl_b32 s50, s50, 3
    s_add_u32 s50, s50, 2048
    s_mov_b32 s8, s96
    s_mov_b32 s9, s97
    s_mov_b32 s10, 0x3240080
    s_mov_b32 s11, 0x00020000
    s_add_u32 s12, s96, 0x1900000
    s_addc_u32 s13, s97, 0
    s_mov_b32 s14, 0x6000
    s_mov_b32 s15, 0x00020000
    s_mov_b32 s46, 0x3ae38e39
    s_mov_b32 s47, 0x3727c5ac
    s_lshl_b32 s51, s51, 3
    s_lshr_b32 s44, s2, 3
    s_mul_i32 s44, s44, 73728
    s_and_b32 s45, s2, 7
    s_lshl_b32 s45, s45, 8
    s_add_u32 s44, s44, s45
    s_mov_b32 s45, 0
    s_waitcnt vmcnt(0)
    s_mov_b32 s60, s94
    s_mov_b32 s61, s95
    s_mov_b32 s62, 0x100
    s_mov_b32 s63, 0x00020000
    v_mov_b32 v249, 0
    buffer_load_dwordx2 v[250:251], v249, s[60:63], 0 offen sc1
ln_loop:
    v_lshlrev_b32 v174, 16, v164
    v_and_b32 v175, 0xffff0000, v164
    v_lshlrev_b32 v176, 16, v165
    v_and_b32 v177, 0xffff0000, v165
    v_lshlrev_b32 v178, 16, v166
    v_and_b32 v179, 0xffff0000, v166
    v_lshlrev_b32 v180, 16, v167
    v_and_b32 v181, 0xffff0000, v167
    v_lshlrev_b32 v182, 16, v168
    v_and_b32 v183, 0xffff0000, v168
    v_lshlrev_b32 v184, 16, v169
    v_and_b32 v185, 0xffff0000, v169
    v_lshlrev_b32 v186, 16, v170
    v_and_b32 v187, 0xffff0000, v170
    v_lshlrev_b32 v188, 16, v171
    v_and_b32 v189, 0xffff0000, v171
    v_lshlrev_b32 v190, 16, v172
    v_and_b32 v191, 0xffff0000, v172
    v_pk_add_f32 v[100:101], v[174:175], v[176:177]
    v_pk_add_f32 v[102:103], v[178:179], v[180:181]
    v_pk_add_f32 v[100:101], v[100:101], v[182:183]
    v_pk_add_f32 v[102:103], v[102:103], v[184:185]
    v_pk_add_f32 v[100:101], v[100:101], v[186:187]
    v_pk_add_f32 v[102:103], v[102:103], v[188:189]
    v_pk_add_f32 v[100:101], v[100:101], v[190:191]
    v_pk_add_f32 v[100:101], v[100:101], v[102:103]
    v_add_f32 v192, v100, v101
    s_nop 1
    v_add_f32_dpp v192, v192, v192 row_ror:8 row_mask:0xf bank_mask:0xf
    s_nop 1
    v_add_f32_dpp v192, v192, v192 row_ror:4 row_mask:0xf bank_mask:0xf
    s_nop 1
    v_add_f32_dpp v192, v192, v192 row_ror:2 row_mask:0xf bank_mask:0xf
    s_nop 1
    v_add_f32_dpp v192, v192, v192 row_ror:1 row_mask:0xf bank_mask:0xf
    v_mov_b32 v193, v192
    s_nop 1
    v_permlane16_swap_b32 v192, v193
    s_nop 1
    v_add_f32 v192, v192, v193
    v_mul_f32 v104, s46, v192
    v_mul_f32 v105, s46, v192
    v_cvt_pk_bf16_f32 v196, v104, v104
    v_lshlrev_b32 v196, 16, v196
    v_pk_add_f32 v[220:221], v[174:175], v[104:105] neg_lo:[0,1] neg_hi:[0,1]
    v_pk_add_f32 v[222:223], v[176:177], v[104:105] neg_lo:[0,1] neg_hi:[0,1]
    v_pk_add_f32 v[224:225], v[178:179], v[104:105] neg_lo:[0,1] neg_hi:[0,1]
    v_pk_add_f32 v[226:227], v[180:181], v[104:105] neg_lo:[0,1] neg_hi:[0,1]
    v_pk_add_f32 v[228:229], v[182:183], v[104:105] neg_lo:[0,1] neg_hi:[0,1]
    v_pk_add_f32 v[230:231], v[184:185], v[104:105] neg_lo:[0,1] neg_hi:[0,1]
    v_pk_add_f32 v[232:233], v[186:187], v[104:105] neg_lo:[0,1] neg_hi:[0,1]
    v_pk_add_f32 v[234:235], v[188:189], v[104:105] neg_lo:[0,1] neg_hi:[0,1]
    v_pk_add_f32 v[236:237], v[190:191], v[104:105] neg_lo:[0,1] neg_hi:[0,1]
    v_mov_b32 v106, v196
    v_mov_b32 v107, v196
    v_pk_mul_f32 v[100:101], v[220:221], v[220:221]
    v_pk_mul_f32 v[102:103], v[222:223], v[222:223]
    v_pk_fma_f32 v[100:101], v[224:225], v[224:225], v[100:101]
    v_pk_fma_f32 v[102:103], v[226:227], v[226:227], v[102:103]
    v_pk_fma_f32 v[100:101], v[228:229], v[228:229], v[100:101]
    v_pk_fma_f32 v[102:103], v[230:231], v[230:231], v[102:103]
    v_pk_fma_f32 v[100:101], v[232:233], v[232:233], v[100:101]
    v_pk_fma_f32 v[102:103], v[234:235], v[234:235], v[102:103]
    v_pk_fma_f32 v[100:101], v[236:237], v[236:237], v[100:101]
    v_pk_add_f32 v[100:101], v[100:101], v[102:103]
    v_add_f32 v192, v100, v101
    v_pk_add_f32 v[174:175], v[174:175], v[106:107] neg_lo:[0,1] neg_hi:[0,1]
    v_pk_add_f32 v[176:177], v[176:177], v[106:107] neg_lo:[0,1] neg_hi:[0,1]
    v_add_f32_dpp v192, v192, v192 row_ror:8 row_mask:0xf bank_mask:0xf
    v_pk_add_f32 v[178:179], v[178:179], v[106:107] neg_lo:[0,1] neg_hi:[0,1]
    v_pk_add_f32 v[180:181], v[180:181], v[106:107] neg_lo:[0,1] neg_hi:[0,1]
    v_add_f32_dpp v192, v192, v192 row_ror:4 row_mask:0xf bank_mask:0xf
    v_pk_add_f32 v[182:183], v[182:183], v[106:107] neg_lo:[0,1] neg_hi:[0,1]
    v_pk_add_f32 v[184:185], v[184:185], v[106:107] neg_lo:[0,1] neg_hi:[0,1]
    v_add_f32_dpp v192, v192, v192 row_ror:2 row_mask:0xf bank_mask:0xf
    v_pk_add_f32 v[186:187], v[186:187], v[106:107] neg_lo:[0,1] neg_hi:[0,1]
    v_pk_add_f32 v[188:189], v[188:189], v[106:107] neg_lo:[0,1] neg_hi:[0,1]
    v_add_f32_dpp v192, v192, v192 row_ror:1 row_mask:0xf bank_mask:0xf
    v_mov_b32 v193, v192
    v_pk_add_f32 v[190:191], v[190:191], v[106:107] neg_lo:[0,1] neg_hi:[0,1]
    v_cvt_pk_bf16_f32 v164, v174, v175
    v_permlane16_swap_b32 v192, v193
    v_cvt_pk_bf16_f32 v165, v176, v177
    v_cvt_pk_bf16_f32 v166, v178, v179
    v_add_f32 v192, v192, v193
    v_mul_f32 v192, s46, v192
    v_cvt_pk_bf16_f32 v192, v192, v192
    v_lshlrev_b32 v192, 16, v192
    v_add_f32 v192, s47, v192
    v_cvt_pk_bf16_f32 v192, v192, v192
    v_lshlrev_b32 v192, 16, v192
    v_sqrt_f32 v192, v192
    v_cvt_pk_bf16_f32 v167, v180, v181
    v_cvt_pk_bf16_f32 v168, v182, v183
    v_cvt_pk_bf16_f32 v169, v184, v185
    v_cvt_pk_bf16_f32 v192, v192, v192
    v_lshlrev_b32 v192, 16, v192
    v_rcp_f32 v197, v192
    v_cvt_pk_bf16_f32 v170, v186, v187
    v_cvt_pk_bf16_f32 v171, v188, v189
    v_cvt_pk_bf16_f32 v172, v190, v191
    v_lshlrev_b32 v174, 16, v164
    v_and_b32 v175, 0xffff0000, v164
    v_lshlrev_b32 v176, 16, v165
    v_and_b32 v177, 0xffff0000, v165
    v_lshlrev_b32 v178, 16, v166
    v_and_b32 v179, 0xffff0000, v166
    v_lshlrev_b32 v180, 16, v167
    v_and_b32 v181, 0xffff0000, v167
    v_lshlrev_b32 v182, 16, v168
    v_and_b32 v183, 0xffff0000, v168
    v_lshlrev_b32 v184, 16, v169
    v_and_b32 v185, 0xffff0000, v169
    v_lshlrev_b32 v186, 16, v170
    v_and_b32 v187, 0xffff0000, v170
    v_lshlrev_b32 v188, 16, v171
    v_and_b32 v189, 0xffff0000, v171
    v_lshlrev_b32 v190, 16, v172
    v_and_b32 v191, 0xffff0000, v172
    v_mov_b32 v108, v197
    v_mov_b32 v109, v197
    v_pk_mul_f32 v[174:175], v[174:175], v[108:109]
    v_pk_mul_f32 v[176:177], v[176:177], v[108:109]
    v_pk_mul_f32 v[178:179], v[178:179], v[108:109]
    v_pk_mul_f32 v[180:181], v[180:181], v[108:109]
    v_pk_mul_f32 v[182:183], v[182:183], v[108:109]
    v_pk_mul_f32 v[184:185], v[184:185], v[108:109]
    v_pk_mul_f32 v[186:187], v[186:187], v[108:109]
    v_pk_mul_f32 v[188:189], v[188:189], v[108:109]
    v_pk_mul_f32 v[190:191], v[190:191], v[108:109]
    v_cvt_pk_bf16_f32 v164, v174, v175
    v_cvt_pk_bf16_f32 v165, v176, v177
    v_cvt_pk_bf16_f32 v166, v178, v179
    v_cvt_pk_bf16_f32 v167, v180, v181
    v_cvt_pk_bf16_f32 v168, v182, v183
    v_cvt_pk_bf16_f32 v169, v184, v185
    v_cvt_pk_bf16_f32 v170, v186, v187
    v_cvt_pk_bf16_f32 v171, v188, v189
    v_cvt_pk_bf16_f32 v172, v190, v191
    s_cmp_lg_u32 s45, 0
    s_cbranch_scc1 ln_out
    s_mov_b32 exec_lo, 1
    s_mov_b32 exec_hi, 1
    buffer_store_dwordx2 v[196:197], v198, s[12:15], s51 offen sc1
    s_mov_b64 exec, -1
    s_mov_b32 s45, 1
    s_branch ln_loop
ln_out:
    ds_write_b64 v238, v[164:165] offset:0
    ds_write_b64 v238, v[166:167] offset:256
    ds_write_b64 v238, v[168:169] offset:512
    ds_write_b64 v238, v[170:171] offset:768
    ds_write_b32 v195, v172 offset:1024
    s_mov_b32 s59, 0
tg_1:
    s_waitcnt vmcnt(0)
    v_readfirstlane_b32 s58, v250
    s_add_u32 s59, s59, 1
    s_cmp_eq_u32 s58, 0
    s_cbranch_scc1 tg_3
    s_sub_u32 s58, s24, s58
    s_cmp_lt_i32 s58, 1500
    s_cbranch_scc1 tg_2
    s_cmp_gt_u32 s59, 64
    s_cbranch_scc1 tg_2
tg_3:
    s_cmp_gt_u32 s59, 16384
    s_cbranch_scc1 tg_2
    s_sleep 2
    s_mov_b32 s60, s94
    s_mov_b32 s61, s95
    s_mov_b32 s62, 0x100
    s_mov_b32 s63, 0x00020000
    v_mov_b32 v249, 0
    buffer_load_dwordx2 v[250:251], v249, s[60:63], 0 offen sc1
    s_branch tg_1
tg_2:
    s_waitcnt lgkmcnt(0)
    s_barrier
    s_cmp_lg_u32 s20, 0
    s_cbranch_scc1 lns_4
    ds_read_b64_tr_b16 v[32:33], v239 offset:0
    ds_read_b64_tr_b16 v[34:35], v239 offset:5376
    ds_read_b64_tr_b16 v[36:37], v239 offset:128
    ds_read_b64_tr_b16 v[38:39], v239 offset:5504
    ds_read_b64_tr_b16 v[40:41], v239 offset:256
    ds_read_b64_tr_b16 v[42:43], v239 offset:5632
    ds_read_b64_tr_b16 v[44:45], v239 offset:384
    ds_read_b64_tr_b16 v[46:47], v239 offset:5760
    ds_read_b64_tr_b16 v[48:49], v239 offset:512
    ds_read_b64_tr_b16 v[50:51], v239 offset:5888
    ds_read_b64_tr_b16 v[52:53], v239 offset:640
    ds_read_b64_tr_b16 v[54:55], v239 offset:6016
    ds_read_b64_tr_b16 v[56:57], v239 offset:768
    ds_read_b64_tr_b16 v[58:59], v239 offset:6144
    s_waitcnt lgkmcnt(8)
    ds_read_b64_tr_b16 v[60:61], v239 offset:896
    ds_read_b64_tr_b16 v[62:63], v239 offset:6272
    ds_read_b64_tr_b16 v[64:65], v239 offset:1024
    ds_read_b64_tr_b16 v[66:67], v239 offset:6400
    s_waitcnt lgkmcnt(15)
    buffer_store_dwordx4 v[32:35], v199, s[8:11], s44 offen sc1
    s_add_u32 s44, s44, 8192
    s_waitcnt lgkmcnt(14)
    buffer_store_dwordx4 v[36:39], v199, s[8:11], s44 offen sc1
    s_add_u32 s44, s44, 8192
    s_waitcnt lgkmcnt(12)
    buffer_store_dwordx4 v[40:43], v199, s[8:11], s44 offen sc1
    s_add_u32 s44, s44, 8192
    s_waitcnt lgkmcnt(10)
    buffer_store_dwordx4 v[44:47], v199, s[8:11], s44 offen sc1
    s_add_u32 s44, s44, 8192
    s_waitcnt lgkmcnt(8)
    buffer_store_dwordx4 v[48:51], v199, s[8:11], s44 offen sc1
    s_add_u32 s44, s44, 8192
    s_waitcnt lgkmcnt(6)
    buffer_store_dwordx4 v[52:55], v199, s[8:11], s44 offen sc1
    s_add_u32 s44, s44, 8192
    s_waitcnt lgkmcnt(4)
    buffer_store_dwordx4 v[56:59], v199, s[8:11], s44 offen sc1
    s_add_u32 s44, s44, 8192
    s_waitcnt lgkmcnt(2)
    buffer_store_dwordx4 v[60:63], v199, s[8:11], s44 offen sc1
    s_add_u32 s44, s44, 8192
    s_waitcnt lgkmcnt(0)
    buffer_store_dwordx4 v[64:67], v199, s[8:11], s44 offen sc1
    s_add_u32 s44, s44, 8192
    v_mov_b32 v252, 0
    v_mov_b32 v253, 0
    v_mov_b32 v249, 163776
    ds_write_b128 v249, v[250:253]
    s_waitcnt lgkmcnt(0)
lns_4:
    s_sub_u32 s3, s21, 19
    s_cmp_lt_u32 s3, 8
    s_cbranch_scc1 ln_lo
    s_barrier
    ds_read_b128 v[80:83], v10 offset:0
    ds_read_b128 v[96:99], v12 offset:0
    ds_read_b128 v[100:103], v12 offset:1024
    ds_read_b128 v[104:107], v12 offset:2048
    ds_read_b128 v[84:87], v10 offset:2048
    ds_read_b128 v[88:91], v10 offset:4096
    ds_read_b128 v[92:95], v10 offset:6144
    s_waitcnt lgkmcnt(3)
    v_mfma_f32_16x16x32_bf16 v[32:35], v[96:99], v[80:83], 0
    ds_read_b128 v[108:111], v11 offset:0
    v_mfma_f32_16x16x32_bf16 v[36:39], v[100:103], v[80:83], 0
    ds_read_b128 v[124:127], v13 offset:0
    v_mfma_f32_16x16x32_bf16 v[40:43], v[104:107], v[80:83], 0
    ds_read_b128 v[128:131], v13 offset:1024
    s_waitcnt lgkmcnt(3)
    v_mfma_f32_16x16x32_bf16 v[44:47], v[96:99], v[84:87], 0
    ds_read_b128 v[132:135], v13 offset:2048
    v_mfma_f32_16x16x32_bf16 v[48:51], v[100:103], v[84:87], 0
    ds_read_b128 v[112:115], v11 offset:2048
    v_mfma_f32_16x16x32_bf16 v[52:55], v[104:107], v[84:87], 0
    ds_read_b128 v[116:119], v11 offset:4096
    s_add_u32 s26, s26, 28672
    v_mfma_f32_16x16x32_bf16 v[56:59], v[96:99], v[88:91], 0
    ds_read_b128 v[120:123], v11 offset:6144
    s_cmp_eq_u32 s26, 143360
    v_mfma_f32_16x16x32_bf16 v[60:63], v[100:103], v[88:91], 0
    s_cselect_b32 s26, 0, s26
    v_mfma_f32_16x16x32_bf16 v[64:67], v[104:107], v[88:91], 0
    v_add_u32 v10, s26, v200
    v_mfma_f32_16x16x32_bf16 v[68:71], v[96:99], v[92:95], 0
    v_add_u32 v11, s26, v201
    v_mfma_f32_16x16x32_bf16 v[72:75], v[100:103], v[92:95], 0
    v_add_u32 v12, s26, v202
    v_mfma_f32_16x16x32_bf16 v[76:79], v[104:107], v[92:95], 0
    v_add_u32 v13, s26, v203
    s_waitcnt lgkmcnt(3)
    v_mfma_f32_16x16x32_bf16 v[32:35], v[124:127], v[108:111], v[32:35]
    ds_read_b128 v[80:83], v10 offset:0
    v_mfma_f32_16x16x32_bf16 v[36:39], v[128:131], v[108:111], v[36:39]
    ds_read_b128 v[96:99], v12 offset:0
    v_mfma_f32_16x16x32_bf16 v[40:43], v[132:135], v[108:111], v[40:43]
    ds_read_b128 v[100:103], v12 offset:1024
    s_waitcnt lgkmcnt(3)
    v_mfma_f32_16x16x32_bf16 v[44:47], v[124:127], v[112:115], v[44:47]
    ds_read_b128 v[104:107], v12 offset:2048
    v_mfma_f32_16x16x32_bf16 v[48:51], v[128:131], v[112:115], v[48:51]
    ds_read_b128 v[84:87], v10 offset:2048
    v_mfma_f32_16x16x32_bf16 v[52:55], v[132:135], v[112:115], v[52:55]
    ds_read_b128 v[88:91], v10 offset:4096
    v_mfma_f32_16x16x32_bf16 v[56:59], v[124:127], v[116:119], v[56:59]
    ds_read_b128 v[92:95], v10 offset:6144
    v_mfma_f32_16x16x32_bf16 v[60:63], v[128:131], v[116:119], v[60:63]
    v_mfma_f32_16x16x32_bf16 v[64:67], v[132:135], v[116:119], v[64:67]
    v_mfma_f32_16x16x32_bf16 v[68:71], v[124:127], v[120:123], v[68:71]
    v_mfma_f32_16x16x32_bf16 v[72:75], v[128:131], v[120:123], v[72:75]
    v_mfma_f32_16x16x32_bf16 v[76:79], v[132:135], v[120:123], v[76:79]
    s_waitcnt lgkmcnt(3)
    v_mfma_f32_16x16x32_bf16 v[32:35], v[96:99], v[80:83], v[32:35]
    ds_read_b128 v[108:111], v11 offset:0
    v_mfma_f32_16x16x32_bf16 v[36:39], v[100:103], v[80:83], v[36:39]
    ds_read_b128 v[124:127], v13 offset:0
    v_mfma_f32_16x16x32_bf16 v[40:43], v[104:107], v[80:83], v[40:43]
    ds_read_b128 v[128:131], v13 offset:1024
    s_waitcnt lgkmcnt(3)
    v_mfma_f32_16x16x32_bf16 v[44:47], v[96:99], v[84:87], v[44:47]
    ds_read_b128 v[132:135], v13 offset:2048
    v_mfma_f32_16x16x32_bf16 v[48:51], v[100:103], v[84:87], v[48:51]
    ds_read_b128 v[112:115], v11 offset:2048
    v_mfma_f32_16x16x32_bf16 v[52:55], v[104:107], v[84:87], v[52:55]
    ds_read_b128 v[116:119], v11 offset:4096
    s_add_u32 s26, s26, 28672
    v_mfma_f32_16x16x32_bf16 v[56:59], v[96:99], v[88:91], v[56:59]
    ds_read_b128 v[120:123], v11 offset:6144
    s_cmp_eq_u32 s26, 143360
    v_mfma_f32_16x16x32_bf16 v[60:63], v[100:103], v[88:91], v[60:63]
    s_cselect_b32 s26, 0, s26
    v_mfma_f32_16x16x32_bf16 v[64:67], v[104:107], v[88:91], v[64:67]
    v_add_u32 v10, s26, v200
    v_mfma_f32_16x16x32_bf16 v[68:71], v[96:99], v[92:95], v[68:71]
    v_add_u32 v11, s26, v201
    v_mfma_f32_16x16x32_bf16 v[72:75], v[100:103], v[92:95], v[72:75]
    v_add_u32 v12, s26, v202
    v_mfma_f32_16x16x32_bf16 v[76:79], v[104:107], v[92:95], v[76:79]
    v_add_u32 v13, s26, v203
    s_cmp_lg_u32 s20, 0
    s_cbranch_scc1 ph_5
    s_lshl_b32 s52, s2, 3
    s_waitcnt vmcnt(0)
    s_mov_b64 exec, 1
    buffer_store_dwordx2 v[250:251], v248, s[16:19], s52 offen sc1
    s_mov_b64 exec, -1
ph_5:
    s_barrier
    s_waitcnt lgkmcnt(3)
    v_mfma_f32_16x16x32_bf16 v[32:35], v[124:127], v[108:111], v[32:35]
    ds_read_b128 v[80:83], v10 offset:0
    v_mfma_f32_16x16x32_bf16 v[36:39], v[128:131], v[108:111], v[36:39]
    ds_read_b128 v[96:99], v12 offset:0
    v_mfma_f32_16x16x32_bf16 v[40:43], v[132:135], v[108:111], v[40:43]
    ds_read_b128 v[100:103], v12 offset:1024
    s_waitcnt lgkmcnt(3)
    v_mfma_f32_16x16x32_bf16 v[44:47], v[124:127], v[112:115], v[44:47]
    ds_read_b128 v[104:107], v12 offset:2048
    v_mfma_f32_16x16x32_bf16 v[48:51], v[128:131], v[112:115], v[48:51]
    ds_read_b128 v[84:87], v10 offset:2048
    v_mfma_f32_16x16x32_bf16 v[52:55], v[132:135], v[112:115], v[52:55]
    ds_read_b128 v[88:91], v10 offset:4096
    v_mfma_f32_16x16x32_bf16 v[56:59], v[124:127], v[116:119], v[56:59]
    ds_read_b128 v[92:95], v10 offset:6144
    v_mfma_f32_16x16x32_bf16 v[60:63], v[128:131], v[116:119], v[60:63]
    v_mfma_f32_16x16x32_bf16 v[64:67], v[132:135], v[116:119], v[64:67]
    v_mfma_f32_16x16x32_bf16 v[68:71], v[124:127], v[120:123], v[68:71]
    v_mfma_f32_16x16x32_bf16 v[72:75], v[128:131], v[120:123], v[72:75]
    v_mfma_f32_16x16x32_bf16 v[76:79], v[132:135], v[120:123], v[76:79]
    s_mov_b32 s27, 3
c1_loop:
    s_waitcnt lgkmcnt(3)
    v_mfma_f32_16x16x32_bf16 v[32:35], v[96:99], v[80:83], v[32:35]
    ds_read_b128 v[108:111], v11 offset:0
    v_mfma_f32_16x16x32_bf16 v[36:39], v[100:103], v[80:83], v[36:39]
    ds_read_b128 v[124:127], v13 offset:0
    v_mfma_f32_16x16x32_bf16 v[40:43], v[104:107], v[80:83], v[40:43]
    ds_read_b128 v[128:131], v13 offset:1024
    s_waitcnt lgkmcnt(3)
    v_mfma_f32_16x16x32_bf16 v[44:47], v[96:99], v[84:87], v[44:47]
    ds_read_b128 v[132:135], v13 offset:2048
    v_mfma_f32_16x16x32_bf16 v[48:51], v[100:103], v[84:87], v[48:51]
    ds_read_b128 v[112:115], v11 offset:2048
    v_mfma_f32_16x16x32_bf16 v[52:55], v[104:107], v[84:87], v[52:55]
    ds_read_b128 v[116:119], v11 offset:4096
    s_add_u32 s26, s26, 28672
    v_mfma_f32_16x16x32_bf16 v[56:59], v[96:99], v[88:91], v[56:59]
    ds_read_b128 v[120:123], v11 offset:6144
    s_cmp_eq_u32 s26, 143360
    v_mfma_f32_16x16x32_bf16 v[60:63], v[100:103], v[88:91], v[60:63]
    s_cselect_b32 s26, 0, s26
    v_mfma_f32_16x16x32_bf16 v[64:67], v[104:107], v[88:91], v[64:67]
    v_add_u32 v10, s26, v200
    v_mfma_f32_16x16x32_bf16 v[68:71], v[96:99], v[92:95], v[68:71]
    v_add_u32 v11, s26, v201
    v_mfma_f32_16x16x32_bf16 v[72:75], v[100:103], v[92:95], v[72:75]
    v_add_u32 v12, s26, v202
    v_mfma_f32_16x16x32_bf16 v[76:79], v[104:107], v[92:95], v[76:79]
    v_add_u32 v13, s26, v203
    s_barrier
    s_waitcnt lgkmcnt(3)
    v_mfma_f32_16x16x32_bf16 v[32:35], v[124:127], v[108:111], v[32:35]
    ds_read_b128 v[80:83], v10 offset:0
    v_mfma_f32_16x16x32_bf16 v[36:39], v[128:131], v[108:111], v[36:39]
    ds_read_b128 v[96:99], v12 offset:0
    v_mfma_f32_16x16x32_bf16 v[40:43], v[132:135], v[108:111], v[40:43]
    ds_read_b128 v[100:103], v12 offset:1024
    s_waitcnt lgkmcnt(3)
    v_mfma_f32_16x16x32_bf16 v[44:47], v[124:127], v[112:115], v[44:47]
    ds_read_b128 v[104:107], v12 offset:2048
    v_mfma_f32_16x16x32_bf16 v[48:51], v[128:131], v[112:115], v[48:51]
    ds_read_b128 v[84:87], v10 offset:2048
    v_mfma_f32_16x16x32_bf16 v[52:55], v[132:135], v[112:115], v[52:55]
    ds_read_b128 v[88:91], v10 offset:4096
    v_mfma_f32_16x16x32_bf16 v[56:59], v[124:127], v[116:119], v[56:59]
    ds_read_b128 v[92:95], v10 offset:6144
    v_mfma_f32_16x16x32_bf16 v[60:63], v[128:131], v[116:119], v[60:63]
    v_mfma_f32_16x16x32_bf16 v[64:67], v[132:135], v[116:119], v[64:67]
    v_mfma_f32_16x16x32_bf16 v[68:71], v[124:127], v[120:123], v[68:71]
    s_sub_u32 s27, s27, 1
    v_mfma_f32_16x16x32_bf16 v[72:75], v[128:131], v[120:123], v[72:75]
    s_cmp_lg_u32 s27, 0
    v_mfma_f32_16x16x32_bf16 v[76:79], v[132:135], v[120:123], v[76:79]
    s_cbranch_scc1 c1_loop
    s_waitcnt lgkmcnt(3)
    v_mfma_f32_16x16x32_bf16 v[32:35], v[96:99], v[80:83], v[32:35]
    ds_read_b128 v[108:111], v11 offset:0
    v_mfma_f32_16x16x32_bf16 v[36:39], v[100:103], v[80:83], v[36:39]
    ds_read_b128 v[124:127], v13 offset:0
    v_mfma_f32_16x16x32_bf16 v[40:43], v[104:107], v[80:83], v[40:43]
    ds_read_b128 v[128:131], v13 offset:1024
    s_waitcnt lgkmcnt(3)
    v_mfma_f32_16x16x32_bf16 v[44:47], v[96:99], v[84:87], v[44:47]
    ds_read_b128 v[132:135], v13 offset:2048
    v_mfma_f32_16x16x32_bf16 v[48:51], v[100:103], v[84:87], v[48:51]
    ds_read_b128 v[112:115], v11 offset:2048
    v_mfma_f32_16x16x32_bf16 v[52:55], v[104:107], v[84:87], v[52:55]
    ds_read_b128 v[116:119], v11 offset:4096
    s_add_u32 s26, s26, 28672
    v_mfma_f32_16x16x32_bf16 v[56:59], v[96:99], v[88:91], v[56:59]
    ds_read_b128 v[120:123], v11 offset:6144
    s_cmp_eq_u32 s26, 143360
    v_mfma_f32_16x16x32_bf16 v[60:63], v[100:103], v[88:91], v[60:63]
    s_cselect_b32 s26, 0, s26
    v_mfma_f32_16x16x32_bf16 v[64:67], v[104:107], v[88:91], v[64:67]
    v_add_u32 v10, s26, v200
    v_mfma_f32_16x16x32_bf16 v[68:71], v[96:99], v[92:95], v[68:71]
    v_add_u32 v11, s26, v201
    v_mfma_f32_16x16x32_bf16 v[72:75], v[100:103], v[92:95], v[72:75]
    v_add_u32 v12, s26, v202
    v_mfma_f32_16x16x32_bf16 v[76:79], v[104:107], v[92:95], v[76:79]
    v_add_u32 v13, s26, v203
    s_cmp_lg_u32 s20, 3
    s_cbranch_scc1 w3_6
    v_lshlrev_b32 v249, 4, v2
    buffer_load_dwordx4 v[240:243], v249, s[16:19], 0 offen sc1
    buffer_load_dwordx4 v[244:247], v249, s[16:19], 0 offen offset:1024 sc1
w3_6:
    s_mov_b32 s4, s86
    s_mov_b32 s5, s87
    s_mov_b32 s6, 0x2400
    s_mov_b32 s7, 0x00020000
    s_lshl_b32 s44, s32, 8
    s_lshl_b32 s45, s40, 7
    s_add_u32 s44, s44, s45
    buffer_load_dwordx2 v[24:25], v217, s[4:7], s44 offen offset:0
    buffer_load_dwordx2 v[26:27], v217, s[4:7], s44 offen offset:32
    buffer_load_dwordx2 v[28:29], v217, s[4:7], s44 offen offset:64
    buffer_load_dwordx2 v[30:31], v217, s[4:7], s44 offen offset:96
    s_barrier
    s_waitcnt lgkmcnt(3)
    v_mfma_f32_16x16x32_bf16 v[32:35], v[124:127], v[108:111], v[32:35]
    ds_read_b128 v[80:83], v10 offset:0
    v_mfma_f32_16x16x32_bf16 v[36:39], v[128:131], v[108:111], v[36:39]
    ds_read_b128 v[96:99], v12 offset:0
    v_mfma_f32_16x16x32_bf16 v[40:43], v[132:135], v[108:111], v[40:43]
    ds_read_b128 v[100:103], v12 offset:1024
    s_waitcnt lgkmcnt(3)
    v_mfma_f32_16x16x32_bf16 v[44:47], v[124:127], v[112:115], v[44:47]
    ds_read_b128 v[104:107], v12 offset:2048
    v_mfma_f32_16x16x32_bf16 v[48:51], v[128:131], v[112:115], v[48:51]
    ds_read_b128 v[84:87], v10 offset:2048
    v_mfma_f32_16x16x32_bf16 v[52:55], v[132:135], v[112:115], v[52:55]
    ds_read_b128 v[88:91], v10 offset:4096
    v_mfma_f32_16x16x32_bf16 v[56:59], v[124:127], v[116:119], v[56:59]
    ds_read_b128 v[92:95], v10 offset:6144
    v_mfma_f32_16x16x32_bf16 v[60:63], v[128:131], v[116:119], v[60:63]
    v_mfma_f32_16x16x32_bf16 v[64:67], v[132:135], v[116:119], v[64:67]
    v_mfma_f32_16x16x32_bf16 v[68:71], v[124:127], v[120:123], v[68:71]
    v_mfma_f32_16x16x32_bf16 v[72:75], v[128:131], v[120:123], v[72:75]
    v_mfma_f32_16x16x32_bf16 v[76:79], v[132:135], v[120:123], v[76:79]
    s_waitcnt lgkmcnt(3)
    v_mfma_f32_16x16x32_bf16 v[32:35], v[96:99], v[80:83], v[32:35]
    ds_read_b128 v[108:111], v11 offset:0
    v_mfma_f32_16x16x32_bf16 v[36:39], v[100:103], v[80:83], v[36:39]
    ds_read_b128 v[124:127], v13 offset:0
    v_mfma_f32_16x16x32_bf16 v[40:43], v[104:107], v[80:83], v[40:43]
    ds_read_b128 v[128:131], v13 offset:1024
    s_waitcnt lgkmcnt(3)
    v_mfma_f32_16x16x32_bf16 v[44:47], v[96:99], v[84:87], v[44:47]
    ds_read_b128 v[132:135], v13 offset:2048
    v_mfma_f32_16x16x32_bf16 v[48:51], v[100:103], v[84:87], v[48:51]
    ds_read_b128 v[112:115], v11 offset:2048
    v_mfma_f32_16x16x32_bf16 v[52:55], v[104:107], v[84:87], v[52:55]
    ds_read_b128 v[116:119], v11 offset:4096
    s_add_u32 s26, s26, 28672
    v_mfma_f32_16x16x32_bf16 v[56:59], v[96:99], v[88:91], v[56:59]
    ds_read_b128 v[120:123], v11 offset:6144
    s_cmp_eq_u32 s26, 143360
    v_mfma_f32_16x16x32_bf16 v[60:63], v[100:103], v[88:91], v[60:63]
    s_cselect_b32 s26, 0, s26
    v_mfma_f32_16x16x32_bf16 v[64:67], v[104:107], v[88:91], v[64:67]
    v_add_u32 v10, s26, v200
    v_mfma_f32_16x16x32_bf16 v[68:71], v[96:99], v[92:95], v[68:71]
    v_add_u32 v11, s26, v201
    v_mfma_f32_16x16x32_bf16 v[72:75], v[100:103], v[92:95], v[72:75]
    v_add_u32 v12, s26, v202
    v_mfma_f32_16x16x32_bf16 v[76:79], v[104:107], v[92:95], v[76:79]
    v_add_u32 v13, s26, v203
    s_cmp_lg_u32 s20, 3
    s_cbranch_scc1 w3_7
    s_mov_b32 s59, 0
gw_8:
    s_waitcnt vmcnt(0)
    v_cmp_ne_u64 vcc, v[240:241], v[250:251]
    v_cmp_ne_u64 s[56:57], v[242:243], v[250:251]
    s_or_b64 vcc, vcc, s[56:57]
    v_cmp_ne_u64 s[56:57], v[244:245], v[250:251]
    s_or_b64 vcc, vcc, s[56:57]
    v_cmp_ne_u64 s[56:57], v[246:247], v[250:251]
    s_or_b64 vcc, vcc, s[56:57]
    s_cbranch_scc0 gw_9
    s_add_u32 s59, s59, 1
    s_cmp_gt_u32 s59, 16384
    s_cbranch_scc1 gw_9
    s_sleep 4
    v_lshlrev_b32 v249, 4, v2
    buffer_load_dwordx4 v[240:243], v249, s[16:19], 0 offen sc1
    buffer_load_dwordx4 v[244:247], v249, s[16:19], 0 offen offset:1024 sc1
    s_branch gw_8
gw_9:
w3_7:
    s_barrier
    s_waitcnt lgkmcnt(3)
    v_mfma_f32_16x16x32_bf16 v[32:35], v[124:127], v[108:111], v[32:35]
    ds_read_b128 v[80:83], v10 offset:0
    v_mfma_f32_16x16x32_bf16 v[36:39], v[128:131], v[108:111], v[36:39]
    ds_read_b128 v[96:99], v12 offset:0
    v_mfma_f32_16x16x32_bf16 v[40:43], v[132:135], v[108:111], v[40:43]
    ds_read_b128 v[100:103], v12 offset:1024
    s_waitcnt lgkmcnt(3)
    v_mfma_f32_16x16x32_bf16 v[44:47], v[124:127], v[112:115], v[44:47]
    ds_read_b128 v[104:107], v12 offset:2048
    v_mfma_f32_16x16x32_bf16 v[48:51], v[128:131], v[112:115], v[48:51]
    ds_read_b128 v[84:87], v10 offset:2048
    v_mfma_f32_16x16x32_bf16 v[52:55], v[132:135], v[112:115], v[52:55]
    ds_read_b128 v[88:91], v10 offset:4096
    v_mfma_f32_16x16x32_bf16 v[56:59], v[124:127], v[116:119], v[56:59]
    ds_read_b128 v[92:95], v10 offset:6144
    v_mfma_f32_16x16x32_bf16 v[60:63], v[128:131], v[116:119], v[60:63]
    v_mfma_f32_16x16x32_bf16 v[64:67], v[132:135], v[116:119], v[64:67]
    v_mfma_f32_16x16x32_bf16 v[68:71], v[124:127], v[120:123], v[68:71]
    v_mfma_f32_16x16x32_bf16 v[72:75], v[128:131], v[120:123], v[72:75]
    v_mfma_f32_16x16x32_bf16 v[76:79], v[132:135], v[120:123], v[76:79]
    s_waitcnt lgkmcnt(3)
    v_mfma_f32_16x16x32_bf16 v[32:35], v[96:99], v[80:83], v[32:35]
    ds_read_b128 v[108:111], v11 offset:0
    v_mfma_f32_16x16x32_bf16 v[36:39], v[100:103], v[80:83], v[36:39]
    ds_read_b128 v[124:127], v13 offset:0
    v_mfma_f32_16x16x32_bf16 v[40:43], v[104:107], v[80:83], v[40:43]
    ds_read_b128 v[128:131], v13 offset:1024
    s_waitcnt lgkmcnt(3)
    v_mfma_f32_16x16x32_bf16 v[44:47], v[96:99], v[84:87], v[44:47]
    ds_read_b128 v[132:135], v13 offset:2048
    v_mfma_f32_16x16x32_bf16 v[48:51], v[100:103], v[84:87], v[48:51]
    ds_read_b128 v[112:115], v11 offset:2048
    v_mfma_f32_16x16x32_bf16 v[52:55], v[104:107], v[84:87], v[52:55]
    ds_read_b128 v[116:119], v11 offset:4096
    s_add_u32 s26, s26, 28672
    v_mfma_f32_16x16x32_bf16 v[56:59], v[96:99], v[88:91], v[56:59]
    ds_read_b128 v[120:123], v11 offset:6144
    s_cmp_eq_u32 s26, 143360
    v_mfma_f32_16x16x32_bf16 v[60:63], v[100:103], v[88:91], v[60:63]
    s_cselect_b32 s26, 0, s26
    v_mfma_f32_16x16x32_bf16 v[64:67], v[104:107], v[88:91], v[64:67]
    v_add_u32 v10, s26, v200
    v_mfma_f32_16x16x32_bf16 v[68:71], v[96:99], v[92:95], v[68:71]
    v_add_u32 v11, s26, v201
    v_mfma_f32_16x16x32_bf16 v[72:75], v[100:103], v[92:95], v[72:75]
    v_add_u32 v12, s26, v202
    v_mfma_f32_16x16x32_bf16 v[76:79], v[104:107], v[92:95], v[76:79]
    v_add_u32 v13, s26, v203
    buffer_load_dwordx4 v[136:139], v219, s[12:15], s49 offen offset:0 sc1
    buffer_load_dwordx4 v[140:143], v219, s[12:15], s49 offen offset:256 sc1
    buffer_load_dwordx4 v[152:155], v20, s[12:15], s54 offen offset:0 sc1
    buffer_load_dwordx4 v[156:159], v20, s[12:15], s54 offen offset:64 sc1
    buffer_load_dwordx4 v[160:163], v20, s[12:15], s54 offen offset:128 sc1
    s_barrier
    s_waitcnt lgkmcnt(3)
    v_mfma_f32_16x16x32_bf16 v[32:35], v[124:127], v[108:111], v[32:35]
    ds_read_b128 v[80:83], v10 offset:0
    v_mfma_f32_16x16x32_bf16 v[36:39], v[128:131], v[108:111], v[36:39]
    ds_read_b128 v[96:99], v12 offset:0
    v_mfma_f32_16x16x32_bf16 v[40:43], v[132:135], v[108:111], v[40:43]
    ds_read_b128 v[100:103], v12 offset:1024
    s_waitcnt lgkmcnt(3)
    v_mfma_f32_16x16x32_bf16 v[44:47], v[124:127], v[112:115], v[44:47]
    ds_read_b128 v[104:107], v12 offset:2048
    v_mfma_f32_16x16x32_bf16 v[48:51], v[128:131], v[112:115], v[48:51]
    ds_read_b128 v[84:87], v10 offset:2048
    v_mfma_f32_16x16x32_bf16 v[52:55], v[132:135], v[112:115], v[52:55]
    ds_read_b128 v[88:91], v10 offset:4096
    v_mfma_f32_16x16x32_bf16 v[56:59], v[124:127], v[116:119], v[56:59]
    ds_read_b128 v[92:95], v10 offset:6144
    v_mfma_f32_16x16x32_bf16 v[60:63], v[128:131], v[116:119], v[60:63]
    v_mfma_f32_16x16x32_bf16 v[64:67], v[132:135], v[116:119], v[64:67]
    v_mfma_f32_16x16x32_bf16 v[68:71], v[124:127], v[120:123], v[68:71]
    v_mfma_f32_16x16x32_bf16 v[72:75], v[128:131], v[120:123], v[72:75]
    v_mfma_f32_16x16x32_bf16 v[76:79], v[132:135], v[120:123], v[76:79]
    s_waitcnt lgkmcnt(3)
    v_mfma_f32_16x16x32_bf16 v[32:35], v[96:99], v[80:83], v[32:35]
    ds_read_b128 v[108:111], v11 offset:0
    s_add_u32 s26, s26, 28672
    v_mfma_f32_16x16x32_bf16 v[36:39], v[100:103], v[80:83], v[36:39]
    ds_read_b128 v[124:127], v13 offset:0
    s_cmp_eq_u32 s26, 143360
    v_mfma_f32_16x16x32_bf16 v[40:43], v[104:107], v[80:83], v[40:43]
    ds_read_b128 v[128:131], v13 offset:1024
    s_cselect_b32 s26, 0, s26
    s_waitcnt lgkmcnt(3)
    v_mfma_f32_16x16x32_bf16 v[44:47], v[96:99], v[84:87], v[44:47]
    ds_read_b128 v[132:135], v13 offset:2048
    s_add_u32 s12, s96, 0xc00000
    v_mfma_f32_16x16x32_bf16 v[48:51], v[100:103], v[84:87], v[48:51]
    ds_read_b128 v[112:115], v11 offset:2048
    s_addc_u32 s13, s97, 0
    v_mfma_f32_16x16x32_bf16 v[52:55], v[104:107], v[84:87], v[52:55]
    ds_read_b128 v[116:119], v11 offset:4096
    s_mov_b32 s14, 0x480000
    v_mfma_f32_16x16x32_bf16 v[56:59], v[96:99], v[88:91], v[56:59]
    ds_read_b128 v[120:123], v11 offset:6144
    s_mov_b32 s15, 0x00020000
    v_mfma_f32_16x16x32_bf16 v[60:63], v[100:103], v[88:91], v[60:63]
    v_mfma_f32_16x16x32_bf16 v[64:67], v[104:107], v[88:91], v[64:67]
    v_mfma_f32_16x16x32_bf16 v[68:71], v[96:99], v[92:95], v[68:71]
    v_mfma_f32_16x16x32_bf16 v[72:75], v[100:103], v[92:95], v[72:75]
    v_mfma_f32_16x16x32_bf16 v[76:79], v[104:107], v[92:95], v[76:79]
    s_waitcnt lgkmcnt(3)
    v_mfma_f32_16x16x32_bf16 v[32:35], v[124:127], v[108:111], v[32:35]
    v_mfma_f32_16x16x32_bf16 v[36:39], v[128:131], v[108:111], v[36:39]
    v_mfma_f32_16x16x32_bf16 v[40:43], v[132:135], v[108:111], v[40:43]
    s_waitcnt lgkmcnt(0)
    v_mfma_f32_16x16x32_bf16 v[44:47], v[124:127], v[112:115], v[44:47]
    v_mfma_f32_16x16x32_bf16 v[48:51], v[128:131], v[112:115], v[48:51]
    v_mfma_f32_16x16x32_bf16 v[52:55], v[132:135], v[112:115], v[52:55]
    v_mfma_f32_16x16x32_bf16 v[56:59], v[124:127], v[116:119], v[56:59]
    v_mfma_f32_16x16x32_bf16 v[60:63], v[128:131], v[116:119], v[60:63]
    v_mfma_f32_16x16x32_bf16 v[64:67], v[132:135], v[116:119], v[64:67]
    v_mfma_f32_16x16x32_bf16 v[68:71], v[124:127], v[120:123], v[68:71]
    v_mfma_f32_16x16x32_bf16 v[72:75], v[128:131], v[120:123], v[72:75]
    v_mfma_f32_16x16x32_bf16 v[76:79], v[132:135], v[120:123], v[76:79]
    s_waitcnt vmcnt(0)
    v_sub_f32 v80, 0, v136
    v_mov_b32 v88, v137
    v_sub_f32 v81, 0, v136
    v_mov_b32 v89, v137
    v_sub_f32 v82, 0, v138
    v_mov_b32 v90, v139
    v_sub_f32 v83, 0, v138
    v_mov_b32 v91, v139
    v_sub_f32 v84, 0, v140
    v_mov_b32 v92, v141
    v_sub_f32 v85, 0, v140
    v_mov_b32 v93, v141
    v_sub_f32 v86, 0, v142
    v_mov_b32 v94, v143
    v_sub_f32 v87, 0, v142
    v_mov_b32 v95, v143
    v_pk_fma_f32 v[32:33], v[80:81], v[152:153], v[32:33]
    v_pk_fma_f32 v[34:35], v[80:81], v[154:155], v[34:35]
    v_pk_fma_f32 v[44:45], v[82:83], v[152:153], v[44:45]
    v_pk_fma_f32 v[46:47], v[82:83], v[154:155], v[46:47]
    v_pk_mul_f32 v[32:33], v[32:33], v[88:89]
    v_pk_mul_f32 v[34:35], v[34:35], v[88:89]
    v_pk_mul_f32 v[44:45], v[44:45], v[90:91]
    v_pk_mul_f32 v[46:47], v[46:47], v[90:91]
    v_cvt_pk_bf16_f32 v168, v32, v33
    v_cvt_pk_bf16_f32 v169, v34, v35
    v_cvt_pk_bf16_f32 v170, v44, v45
    v_cvt_pk_bf16_f32 v171, v46, v47
    buffer_store_dwordx4 v[168:171], v218, s[12:15], s42 offen offset:0 sc1
    v_pk_fma_f32 v[36:37], v[80:81], v[156:157], v[36:37]
    v_pk_fma_f32 v[38:39], v[80:81], v[158:159], v[38:39]
    v_pk_fma_f32 v[48:49], v[82:83], v[156:157], v[48:49]
    v_pk_fma_f32 v[50:51], v[82:83], v[158:159], v[50:51]
    v_pk_mul_f32 v[36:37], v[36:37], v[88:89]
    v_pk_mul_f32 v[38:39], v[38:39], v[88:89]
    v_pk_mul_f32 v[48:49], v[48:49], v[90:91]
    v_pk_mul_f32 v[50:51], v[50:51], v[90:91]
    v_cvt_pk_bf16_f32 v172, v36, v37
    v_cvt_pk_bf16_f32 v173, v38, v39
    v_cvt_pk_bf16_f32 v174, v48, v49
    v_cvt_pk_bf16_f32 v175, v50, v51
    buffer_store_dwordx4 v[172:175], v218, s[12:15], s43 offen offset:0 sc1
    v_pk_fma_f32 v[40:41], v[80:81], v[160:161], v[40:41]
    v_pk_fma_f32 v[42:43], v[80:81], v[162:163], v[42:43]
    v_pk_fma_f32 v[52:53], v[82:83], v[160:161], v[52:53]
    v_pk_fma_f32 v[54:55], v[82:83], v[162:163], v[54:55]
    v_pk_mul_f32 v[40:41], v[40:41], v[88:89]
    v_pk_mul_f32 v[42:43], v[42:43], v[88:89]
    v_pk_mul_f32 v[52:53], v[52:53], v[90:91]
    v_pk_mul_f32 v[54:55], v[54:55], v[90:91]
    v_cvt_pk_bf16_f32 v176, v40, v41
    v_cvt_pk_bf16_f32 v177, v42, v43
    v_cvt_pk_bf16_f32 v178, v52, v53
    v_cvt_pk_bf16_f32 v179, v54, v55
    buffer_store_dwordx4 v[176:179], v218, s[12:15], s48 offen offset:0 sc1
    v_pk_fma_f32 v[56:57], v[84:85], v[152:153], v[56:57]
    v_pk_fma_f32 v[58:59], v[84:85], v[154:155], v[58:59]
    v_pk_fma_f32 v[68:69], v[86:87], v[152:153], v[68:69]
    v_pk_fma_f32 v[70:71], v[86:87], v[154:155], v[70:71]
    v_pk_mul_f32 v[56:57], v[56:57], v[92:93]
    v_pk_mul_f32 v[58:59], v[58:59], v[92:93]
    v_pk_mul_f32 v[68:69], v[68:69], v[94:95]
    v_pk_mul_f32 v[70:71], v[70:71], v[94:95]
    v_cvt_pk_bf16_f32 v180, v56, v57
    v_cvt_pk_bf16_f32 v181, v58, v59
    v_cvt_pk_bf16_f32 v182, v68, v69
    v_cvt_pk_bf16_f32 v183, v70, v71
    buffer_store_dwordx4 v[180:183], v218, s[12:15], s42 offen offset:1024 sc1
    v_pk_fma_f32 v[60:61], v[84:85], v[156:157], v[60:61]
    v_pk_fma_f32 v[62:63], v[84:85], v[158:159], v[62:63]
    v_pk_fma_f32 v[72:73], v[86:87], v[156:157], v[72:73]
    v_pk_fma_f32 v[74:75], v[86:87], v[158:159], v[74:75]
    v_pk_mul_f32 v[60:61], v[60:61], v[92:93]
    v_pk_mul_f32 v[62:63], v[62:63], v[92:93]
    v_pk_mul_f32 v[72:73], v[72:73], v[94:95]
    v_pk_mul_f32 v[74:75], v[74:75], v[94:95]
    v_cvt_pk_bf16_f32 v184, v60, v61
    v_cvt_pk_bf16_f32 v185, v62, v63
    v_cvt_pk_bf16_f32 v186, v72, v73
    v_cvt_pk_bf16_f32 v187, v74, v75
    buffer_store_dwordx4 v[184:187], v218, s[12:15], s43 offen offset:1024 sc1
    v_pk_fma_f32 v[64:65], v[84:85], v[160:161], v[64:65]
    v_pk_fma_f32 v[66:67], v[84:85], v[162:163], v[66:67]
    v_pk_fma_f32 v[76:77], v[86:87], v[160:161], v[76:77]
    v_pk_fma_f32 v[78:79], v[86:87], v[162:163], v[78:79]
    v_pk_mul_f32 v[64:65], v[64:65], v[92:93]
    v_pk_mul_f32 v[66:67], v[66:67], v[92:93]
    v_pk_mul_f32 v[76:77], v[76:77], v[94:95]
    v_pk_mul_f32 v[78:79], v[78:79], v[94:95]
    v_cvt_pk_bf16_f32 v188, v64, v65
    v_cvt_pk_bf16_f32 v189, v66, v67
    v_cvt_pk_bf16_f32 v190, v76, v77
    v_cvt_pk_bf16_f32 v191, v78, v79
    buffer_store_dwordx4 v[188:191], v218, s[12:15], s48 offen offset:1024 sc1
    v_lshlrev_b32 v224, 16, v24
    v_and_b32 v225, 0xffff0000, v24
    v_lshlrev_b32 v226, 16, v25
    v_and_b32 v227, 0xffff0000, v25
    v_lshlrev_b32 v228, 16, v26
    v_and_b32 v229, 0xffff0000, v26
    v_lshlrev_b32 v230, 16, v27
    v_and_b32 v231, 0xffff0000, v27
    v_lshlrev_b32 v232, 16, v28
    v_and_b32 v233, 0xffff0000, v28
    v_lshlrev_b32 v234, 16, v29
    v_and_b32 v235, 0xffff0000, v29
    v_lshlrev_b32 v236, 16, v30
    v_and_b32 v237, 0xffff0000, v30
    v_lshlrev_b32 v238, 16, v31
    v_and_b32 v239, 0xffff0000, v31
    s_mov_b32 s53, 1
    s_mov_b32 s52, s50
    s_barrier
    s_waitcnt vmcnt(0)
    s_mov_b64 exec, 1
    buffer_store_dwordx2 v[250:251], v248, s[16:19], s52 offen sc1
    s_mov_b64 exec, -1
    s_mov_b32 s53, 0
    s_cmp_lt_u32 s21, 27
    s_cbranch_scc1 c2_main
    s_branch scan_entry
c2_entry:
    v_lshlrev_b32 v224, 16, v24
    v_and_b32 v225, 0xffff0000, v24
    v_lshlrev_b32 v226, 16, v25
    v_and_b32 v227, 0xffff0000, v25
    v_lshlrev_b32 v228, 16, v26
    v_and_b32 v229, 0xffff0000, v26
    v_lshlrev_b32 v230, 16, v27
    v_and_b32 v231, 0xffff0000, v27
    v_lshlrev_b32 v232, 16, v28
    v_and_b32 v233, 0xffff0000, v28
    v_lshlrev_b32 v234, 16, v29
    v_and_b32 v235, 0xffff0000, v29
    v_lshlrev_b32 v236, 16, v30
    v_and_b32 v237, 0xffff0000, v30
    v_lshlrev_b32 v238, 16, v31
    v_and_b32 v239, 0xffff0000, v31
    s_mov_b32 s53, 0
    s_barrier
c2_main:
    v_add_u32 v10, s26, v204
    v_add_u32 v11, s26, v205
    v_add_u32 v12, s26, v206
    v_add_u32 v13, s26, v207
    v_add_u32 v14, s26, v208
    s_barrier
    ds_read_b64_tr_b16 v[80:81], v10 offset:0
    ds_read_b64_tr_b16 v[82:83], v10 offset:4096
    ds_read_b128 v[96:99], v14 offset:0
    ds_read_b128 v[100:103], v14 offset:2048
    ds_read_b128 v[104:107], v14 offset:4096
    ds_read_b64_tr_b16 v[84:85], v11 offset:0
    ds_read_b64_tr_b16 v[86:87], v11 offset:4096
    ds_read_b64_tr_b16 v[88:89], v12 offset:0
    ds_read_b64_tr_b16 v[90:91], v12 offset:4096
    ds_read_b64_tr_b16 v[92:93], v13 offset:0
    ds_read_b64_tr_b16 v[94:95], v13 offset:4096
    s_waitcnt lgkmcnt(6)
    v_mfma_f32_16x16x32_bf16 v[32:35], v[80:83], v[96:99], v[224:227]
    ds_read_b64_tr_b16 v[108:109], v10 offset:8192
    s_add_u32 s26, s26, 28672
    v_mfma_f32_16x16x32_bf16 v[36:39], v[80:83], v[100:103], v[224:227]
    ds_read_b64_tr_b16 v[110:111], v10 offset:12288
    s_cmp_eq_u32 s26, 143360
    v_mfma_f32_16x16x32_bf16 v[40:43], v[80:83], v[104:107], v[224:227]
    ds_read_b128 v[124:127], v14 offset:1024
    s_cselect_b32 s26, 0, s26
    s_waitcnt lgkmcnt(7)
    v_mfma_f32_16x16x32_bf16 v[44:47], v[84:87], v[96:99], v[228:231]
    ds_read_b128 v[128:131], v14 offset:3072
    v_mfma_f32_16x16x32_bf16 v[48:51], v[84:87], v[100:103], v[228:231]
    ds_read_b128 v[132:135], v14 offset:5120
    v_add_u32 v10, s26, v204
    v_mfma_f32_16x16x32_bf16 v[52:55], v[84:87], v[104:107], v[228:231]
    ds_read_b64_tr_b16 v[112:113], v11 offset:8192
    v_add_u32 v14, s26, v208
    s_waitcnt lgkmcnt(6)
    v_mfma_f32_16x16x32_bf16 v[56:59], v[88:91], v[96:99], v[232:235]
    ds_read_b64_tr_b16 v[114:115], v11 offset:12288
    v_mfma_f32_16x16x32_bf16 v[60:63], v[88:91], v[100:103], v[232:235]
    ds_read_b64_tr_b16 v[116:117], v12 offset:8192
    v_add_u32 v11, s26, v205
    v_mfma_f32_16x16x32_bf16 v[64:67], v[88:91], v[104:107], v[232:235]
    ds_read_b64_tr_b16 v[118:119], v12 offset:12288
    v_mfma_f32_16x16x32_bf16 v[68:71], v[92:95], v[96:99], v[236:239]
    ds_read_b64_tr_b16 v[120:121], v13 offset:8192
    v_add_u32 v12, s26, v206
    v_mfma_f32_16x16x32_bf16 v[72:75], v[92:95], v[100:103], v[236:239]
    ds_read_b64_tr_b16 v[122:123], v13 offset:12288
    v_mfma_f32_16x16x32_bf16 v[76:79], v[92:95], v[104:107], v[236:239]
    v_add_u32 v13, s26, v207
    s_waitcnt lgkmcnt(6)
    v_mfma_f32_16x16x32_bf16 v[32:35], v[108:111], v[124:127], v[32:35]
    ds_read_b64_tr_b16 v[80:81], v10 offset:0
    v_mfma_f32_16x16x32_bf16 v[36:39], v[108:111], v[128:131], v[36:39]
    ds_read_b64_tr_b16 v[82:83], v10 offset:4096
    v_mfma_f32_16x16x32_bf16 v[40:43], v[108:111], v[132:135], v[40:43]
    ds_read_b128 v[96:99], v14 offset:0
    s_waitcnt lgkmcnt(7)
    v_mfma_f32_16x16x32_bf16 v[44:47], v[112:115], v[124:127], v[44:47]
    ds_read_b128 v[100:103], v14 offset:2048
    v_mfma_f32_16x16x32_bf16 v[48:51], v[112:115], v[128:131], v[48:51]
    ds_read_b128 v[104:107], v14 offset:4096
    v_mfma_f32_16x16x32_bf16 v[52:55], v[112:115], v[132:135], v[52:55]
    ds_read_b64_tr_b16 v[84:85], v11 offset:0
    s_waitcnt lgkmcnt(6)
    v_mfma_f32_16x16x32_bf16 v[56:59], v[116:119], v[124:127], v[56:59]
    ds_read_b64_tr_b16 v[86:87], v11 offset:4096
    v_mfma_f32_16x16x32_bf16 v[60:63], v[116:119], v[128:131], v[60:63]
    ds_read_b64_tr_b16 v[88:89], v12 offset:0
    v_mfma_f32_16x16x32_bf16 v[64:67], v[116:119], v[132:135], v[64:67]
    ds_read_b64_tr_b16 v[90:91], v12 offset:4096
    v_mfma_f32_16x16x32_bf16 v[68:71], v[120:123], v[124:127], v[68:71]
    ds_read_b64_tr_b16 v[92:93], v13 offset:0
    v_mfma_f32_16x16x32_bf16 v[72:75], v[120:123], v[128:131], v[72:75]
    ds_read_b64_tr_b16 v[94:95], v13 offset:4096
    v_mfma_f32_16x16x32_bf16 v[76:79], v[120:123], v[132:135], v[76:79]
    s_cmp_eq_u32 s53, 0
    s_cbranch_scc1 pg_10
    s_waitcnt vmcnt(0)
    s_mov_b64 exec, 1
    buffer_store_dwordx2 v[250:251], v248, s[16:19], s52 offen sc1
    s_mov_b64 exec, -1
pg_10:
    s_mov_b32 s27, 30
c2_loop:
    s_waitcnt lgkmcnt(6)
    v_mfma_f32_16x16x32_bf16 v[32:35], v[80:83], v[96:99], v[32:35]
    ds_read_b64_tr_b16 v[108:109], v10 offset:8192
    s_add_u32 s26, s26, 28672
    v_mfma_f32_16x16x32_bf16 v[36:39], v[80:83], v[100:103], v[36:39]
    ds_read_b64_tr_b16 v[110:111], v10 offset:12288
    s_cmp_eq_u32 s26, 143360
    v_mfma_f32_16x16x32_bf16 v[40:43], v[80:83], v[104:107], v[40:43]
    ds_read_b128 v[124:127], v14 offset:1024
    s_cselect_b32 s26, 0, s26
    s_waitcnt lgkmcnt(7)
    v_mfma_f32_16x16x32_bf16 v[44:47], v[84:87], v[96:99], v[44:47]
    ds_read_b128 v[128:131], v14 offset:3072
    v_mfma_f32_16x16x32_bf16 v[48:51], v[84:87], v[100:103], v[48:51]
    ds_read_b128 v[132:135], v14 offset:5120
    v_add_u32 v10, s26, v204
    v_mfma_f32_16x16x32_bf16 v[52:55], v[84:87], v[104:107], v[52:55]
    ds_read_b64_tr_b16 v[112:113], v11 offset:8192
    v_add_u32 v14, s26, v208
    s_waitcnt lgkmcnt(6)
    v_mfma_f32_16x16x32_bf16 v[56:59], v[88:91], v[96:99], v[56:59]
    ds_read_b64_tr_b16 v[114:115], v11 offset:12288
    v_mfma_f32_16x16x32_bf16 v[60:63], v[88:91], v[100:103], v[60:63]
    ds_read_b64_tr_b16 v[116:117], v12 offset:8192
    v_add_u32 v11, s26, v205
    v_mfma_f32_16x16x32_bf16 v[64:67], v[88:91], v[104:107], v[64:67]
    ds_read_b64_tr_b16 v[118:119], v12 offset:12288
    v_mfma_f32_16x16x32_bf16 v[68:71], v[92:95], v[96:99], v[68:71]
    ds_read_b64_tr_b16 v[120:121], v13 offset:8192
    v_add_u32 v12, s26, v206
    v_mfma_f32_16x16x32_bf16 v[72:75], v[92:95], v[100:103], v[72:75]
    ds_read_b64_tr_b16 v[122:123], v13 offset:12288
    v_mfma_f32_16x16x32_bf16 v[76:79], v[92:95], v[104:107], v[76:79]
    v_add_u32 v13, s26, v207
    s_barrier
    s_waitcnt lgkmcnt(6)
    v_mfma_f32_16x16x32_bf16 v[32:35], v[108:111], v[124:127], v[32:35]
    ds_read_b64_tr_b16 v[80:81], v10 offset:0
    v_mfma_f32_16x16x32_bf16 v[36:39], v[108:111], v[128:131], v[36:39]
    ds_read_b64_tr_b16 v[82:83], v10 offset:4096
    v_mfma_f32_16x16x32_bf16 v[40:43], v[108:111], v[132:135], v[40:43]
    ds_read_b128 v[96:99], v14 offset:0
    s_waitcnt lgkmcnt(7)
    v_mfma_f32_16x16x32_bf16 v[44:47], v[112:115], v[124:127], v[44:47]
    ds_read_b128 v[100:103], v14 offset:2048
    v_mfma_f32_16x16x32_bf16 v[48:51], v[112:115], v[128:131], v[48:51]
    ds_read_b128 v[104:107], v14 offset:4096
    v_mfma_f32_16x16x32_bf16 v[52:55], v[112:115], v[132:135], v[52:55]
    ds_read_b64_tr_b16 v[84:85], v11 offset:0
    s_waitcnt lgkmcnt(6)
    v_mfma_f32_16x16x32_bf16 v[56:59], v[116:119], v[124:127], v[56:59]
    ds_read_b64_tr_b16 v[86:87], v11 offset:4096
    v_mfma_f32_16x16x32_bf16 v[60:63], v[116:119], v[128:131], v[60:63]
    ds_read_b64_tr_b16 v[88:89], v12 offset:0
    v_mfma_f32_16x16x32_bf16 v[64:67], v[116:119], v[132:135], v[64:67]
    ds_read_b64_tr_b16 v[90:91], v12 offset:4096
    v_mfma_f32_16x16x32_bf16 v[68:71], v[120:123], v[124:127], v[68:71]
    ds_read_b64_tr_b16 v[92:93], v13 offset:0
    s_sub_u32 s27, s27, 1
    v_mfma_f32_16x16x32_bf16 v[72:75], v[120:123], v[128:131], v[72:75]
    ds_read_b64_tr_b16 v[94:95], v13 offset:4096
    s_cmp_lg_u32 s27, 0
    v_mfma_f32_16x16x32_bf16 v[76:79], v[120:123], v[132:135], v[76:79]
    s_cbranch_scc1 c2_loop
    s_waitcnt lgkmcnt(6)
    v_mfma_f32_16x16x32_bf16 v[32:35], v[80:83], v[96:99], v[32:35]
    ds_read_b64_tr_b16 v[108:109], v10 offset:8192
    s_add_u32 s26, s26, 28672
    v_mfma_f32_16x16x32_bf16 v[36:39], v[80:83], v[100:103], v[36:39]
    ds_read_b64_tr_b16 v[110:111], v10 offset:12288
    s_cmp_eq_u32 s26, 143360
    v_mfma_f32_16x16x32_bf16 v[40:43], v[80:83], v[104:107], v[40:43]
    ds_read_b128 v[124:127], v14 offset:1024
    s_cselect_b32 s26, 0, s26
    s_waitcnt lgkmcnt(7)
    v_mfma_f32_16x16x32_bf16 v[44:47], v[84:87], v[96:99], v[44:47]
    ds_read_b128 v[128:131], v14 offset:3072
    v_mov_b32 v28, 0xc0135761
    v_mfma_f32_16x16x32_bf16 v[48:51], v[84:87], v[100:103], v[48:51]
    ds_read_b128 v[132:135], v14 offset:5120
    v_mov_b32 v29, 0xc0135761
    v_mfma_f32_16x16x32_bf16 v[52:55], v[84:87], v[104:107], v[52:55]
    ds_read_b64_tr_b16 v[112:113], v11 offset:8192
    v_mov_b32 v136, 0xbdd2d3e8
    s_waitcnt lgkmcnt(6)
    v_mfma_f32_16x16x32_bf16 v[56:59], v[88:91], v[96:99], v[56:59]
    ds_read_b64_tr_b16 v[114:115], v11 offset:12288
    v_mov_b32 v137, 0xbdd2d3e8
    v_mfma_f32_16x16x32_bf16 v[60:63], v[88:91], v[100:103], v[60:63]
    ds_read_b64_tr_b16 v[116:117], v12 offset:8192
    v_mov_b32 v138, 0x3f800000
    v_mfma_f32_16x16x32_bf16 v[64:67], v[88:91], v[104:107], v[64:67]
    ds_read_b64_tr_b16 v[118:119], v12 offset:12288
    v_mov_b32 v139, 0x3f800000
    v_mfma_f32_16x16x32_bf16 v[68:71], v[92:95], v[96:99], v[68:71]
    ds_read_b64_tr_b16 v[120:121], v13 offset:8192
    s_add_u32 s12, s96, 0x400000
    v_mfma_f32_16x16x32_bf16 v[72:75], v[92:95], v[100:103], v[72:75]
    ds_read_b64_tr_b16 v[122:123], v13 offset:12288
    s_addc_u32 s13, s97, 0
    v_mfma_f32_16x16x32_bf16 v[76:79], v[92:95], v[104:107], v[76:79]
    s_mov_b32 s14, 0x3510080
    s_waitcnt lgkmcnt(6)
    v_mfma_f32_16x16x32_bf16 v[32:35], v[108:111], v[124:127], v[32:35]
    s_mov_b32 s15, 0x00020000
    s_lshl_b32 s44, s32, 1
    v_mfma_f32_16x16x32_bf16 v[36:39], v[108:111], v[128:131], v[36:39]
    s_add_u32 s44, s44, s40
    s_lshl_b32 s45, s33, 1
    v_mfma_f32_16x16x32_bf16 v[40:43], v[108:111], v[132:135], v[40:43]
    s_add_u32 s45, s45, s41
    s_mul_i32 s46, s44, 12
    s_waitcnt lgkmcnt(4)
    v_mfma_f32_16x16x32_bf16 v[44:47], v[112:115], v[124:127], v[44:47]
    s_add_u32 s46, s46, s45
    s_mul_i32 s46, s46, 6144
    v_mfma_f32_16x16x32_bf16 v[48:51], v[112:115], v[128:131], v[48:51]
    s_add_u32 s47, s46, 4096
    s_mul_i32 s48, s44, 3641
    v_mfma_f32_16x16x32_bf16 v[52:55], v[112:115], v[132:135], v[52:55]
    s_lshr_b32 s48, s48, 16
    s_mul_i32 s49, s45, 21846
    s_waitcnt lgkmcnt(0)
    v_mfma_f32_16x16x32_bf16 v[56:59], v[116:119], v[124:127], v[56:59]
    s_lshr_b32 s49, s49, 16
    s_mul_i32 s50, s48, 18
    v_mfma_f32_16x16x32_bf16 v[60:63], v[116:119], v[128:131], v[60:63]
    s_sub_u32 s50, s44, s50
    s_sub_u32 s50, s50, s49
    v_mfma_f32_16x16x32_bf16 v[64:67], v[116:119], v[132:135], v[64:67]
    s_mul_i32 s50, s50, 3
    s_add_u32 s50, s50, s45
    v_mfma_f32_16x16x32_bf16 v[68:71], v[120:123], v[124:127], v[68:71]
    s_lshl_b32 s50, s50, 3
    s_lshl_b32 s49, s49, 2
    v_mfma_f32_16x16x32_bf16 v[72:75], v[120:123], v[128:131], v[72:75]
    s_add_u32 s49, s49, s48
    s_lshl_b32 s49, s49, 9
    v_mfma_f32_16x16x32_bf16 v[76:79], v[120:123], v[132:135], v[76:79]
    s_add_u32 s52, s50, s49
    s_add_u32 s52, s52, 8192
    s_nop 7
    v_pk_mul_f32 v[80:81], v[32:33], v[32:33]
    v_pk_mul_f32 v[82:83], v[34:35], v[34:35]
    v_pk_mul_f32 v[84:85], v[44:45], v[44:45]
    v_pk_mul_f32 v[86:87], v[46:47], v[46:47]
    v_pk_fma_f32 v[80:81], v[80:81], v[136:137], v[28:29]
    v_pk_fma_f32 v[82:83], v[82:83], v[136:137], v[28:29]
    v_pk_fma_f32 v[84:85], v[84:85], v[136:137], v[28:29]
    v_pk_fma_f32 v[86:87], v[86:87], v[136:137], v[28:29]
    v_pk_mul_f32 v[80:81], v[80:81], v[32:33]
    v_pk_mul_f32 v[82:83], v[82:83], v[34:35]
    v_pk_mul_f32 v[84:85], v[84:85], v[44:45]
    v_pk_mul_f32 v[86:87], v[86:87], v[46:47]
    v_exp_f32 v80, v80
    v_exp_f32 v81, v81
    v_exp_f32 v82, v82
    v_exp_f32 v83, v83
    v_exp_f32 v84, v84
    v_exp_f32 v85, v85
    v_exp_f32 v86, v86
    v_exp_f32 v87, v87
    v_pk_add_f32 v[80:81], v[80:81], v[138:139]
    v_pk_add_f32 v[82:83], v[82:83], v[138:139]
    v_pk_add_f32 v[84:85], v[84:85], v[138:139]
    v_pk_add_f32 v[86:87], v[86:87], v[138:139]
    v_rcp_f32 v80, v80
    v_rcp_f32 v81, v81
    v_rcp_f32 v82, v82
    v_rcp_f32 v83, v83
    v_rcp_f32 v84, v84
    v_rcp_f32 v85, v85
    v_rcp_f32 v86, v86
    v_rcp_f32 v87, v87
    v_pk_mul_f32 v[80:81], v[80:81], v[32:33]
    v_pk_mul_f32 v[82:83], v[82:83], v[34:35]
    v_pk_mul_f32 v[84:85], v[84:85], v[44:45]
    v_pk_mul_f32 v[86:87], v[86:87], v[46:47]
    v_cvt_pk_bf16_f32 v140, v80, v81
    v_cvt_pk_bf16_f32 v141, v82, v83
    v_cvt_pk_bf16_f32 v142, v84, v85
    v_cvt_pk_bf16_f32 v143, v86, v87
    buffer_store_dwordx4 v[140:143], v215, s[12:15], s46 offen offset:0 sc1
    v_pk_mul_f32 v[80:81], v[36:37], v[36:37]
    v_pk_mul_f32 v[82:83], v[38:39], v[38:39]
    v_pk_mul_f32 v[84:85], v[48:49], v[48:49]
    v_pk_mul_f32 v[86:87], v[50:51], v[50:51]
    v_pk_fma_f32 v[80:81], v[80:81], v[136:137], v[28:29]
    v_pk_fma_f32 v[82:83], v[82:83], v[136:137], v[28:29]
    v_pk_fma_f32 v[84:85], v[84:85], v[136:137], v[28:29]
    v_pk_fma_f32 v[86:87], v[86:87], v[136:137], v[28:29]
    v_pk_mul_f32 v[80:81], v[80:81], v[36:37]
    v_pk_mul_f32 v[82:83], v[82:83], v[38:39]
    v_pk_mul_f32 v[84:85], v[84:85], v[48:49]
    v_pk_mul_f32 v[86:87], v[86:87], v[50:51]
    v_exp_f32 v80, v80
    v_exp_f32 v81, v81
    v_exp_f32 v82, v82
    v_exp_f32 v83, v83
    v_exp_f32 v84, v84
    v_exp_f32 v85, v85
    v_exp_f32 v86, v86
    v_exp_f32 v87, v87
    v_pk_add_f32 v[80:81], v[80:81], v[138:139]
    v_pk_add_f32 v[82:83], v[82:83], v[138:139]
    v_pk_add_f32 v[84:85], v[84:85], v[138:139]
    v_pk_add_f32 v[86:87], v[86:87], v[138:139]
    v_rcp_f32 v80, v80
    v_rcp_f32 v81, v81
    v_rcp_f32 v82, v82
    v_rcp_f32 v83, v83
    v_rcp_f32 v84, v84
    v_rcp_f32 v85, v85
    v_rcp_f32 v86, v86
    v_rcp_f32 v87, v87
    v_pk_mul_f32 v[80:81], v[80:81], v[36:37]
    v_pk_mul_f32 v[82:83], v[82:83], v[38:39]
    v_pk_mul_f32 v[84:85], v[84:85], v[48:49]
    v_pk_mul_f32 v[86:87], v[86:87], v[50:51]
    v_cvt_pk_bf16_f32 v144, v80, v81
    v_cvt_pk_bf16_f32 v145, v82, v83
    v_cvt_pk_bf16_f32 v146, v84, v85
    v_cvt_pk_bf16_f32 v147, v86, v87
    buffer_store_dwordx4 v[144:147], v215, s[12:15], s46 offen offset:2048 sc1
    s_barrier
    v_pk_mul_f32 v[80:81], v[40:41], v[40:41]
    v_pk_mul_f32 v[82:83], v[42:43], v[42:43]
    v_pk_mul_f32 v[84:85], v[52:53], v[52:53]
    v_pk_mul_f32 v[86:87], v[54:55], v[54:55]
    v_pk_fma_f32 v[80:81], v[80:81], v[136:137], v[28:29]
    v_pk_fma_f32 v[82:83], v[82:83], v[136:137], v[28:29]
    v_pk_fma_f32 v[84:85], v[84:85], v[136:137], v[28:29]
    v_pk_fma_f32 v[86:87], v[86:87], v[136:137], v[28:29]
    v_pk_mul_f32 v[80:81], v[80:81], v[40:41]
    v_pk_mul_f32 v[82:83], v[82:83], v[42:43]
    v_pk_mul_f32 v[84:85], v[84:85], v[52:53]
    v_pk_mul_f32 v[86:87], v[86:87], v[54:55]
    v_exp_f32 v80, v80
    v_exp_f32 v81, v81
    v_exp_f32 v82, v82
    v_exp_f32 v83, v83
    v_exp_f32 v84, v84
    v_exp_f32 v85, v85
    v_exp_f32 v86, v86
    v_exp_f32 v87, v87
    v_pk_add_f32 v[80:81], v[80:81], v[138:139]
    v_pk_add_f32 v[82:83], v[82:83], v[138:139]
    v_pk_add_f32 v[84:85], v[84:85], v[138:139]
    v_pk_add_f32 v[86:87], v[86:87], v[138:139]
    v_rcp_f32 v80, v80
    v_rcp_f32 v81, v81
    v_rcp_f32 v82, v82
    v_rcp_f32 v83, v83
    v_rcp_f32 v84, v84
    v_rcp_f32 v85, v85
    v_rcp_f32 v86, v86
    v_rcp_f32 v87, v87
    v_pk_mul_f32 v[80:81], v[80:81], v[40:41]
    v_pk_mul_f32 v[82:83], v[82:83], v[42:43]
    v_pk_mul_f32 v[84:85], v[84:85], v[52:53]
    v_pk_mul_f32 v[86:87], v[86:87], v[54:55]
    v_cvt_pk_bf16_f32 v148, v80, v81
    v_cvt_pk_bf16_f32 v149, v82, v83
    v_cvt_pk_bf16_f32 v150, v84, v85
    v_cvt_pk_bf16_f32 v151, v86, v87
    buffer_store_dwordx4 v[148:151], v215, s[12:15], s47 offen offset:0 sc1
    v_pk_mul_f32 v[80:81], v[56:57], v[56:57]
    v_pk_mul_f32 v[82:83], v[58:59], v[58:59]
    v_pk_mul_f32 v[84:85], v[68:69], v[68:69]
    v_pk_mul_f32 v[86:87], v[70:71], v[70:71]
    v_pk_fma_f32 v[80:81], v[80:81], v[136:137], v[28:29]
    v_pk_fma_f32 v[82:83], v[82:83], v[136:137], v[28:29]
    v_pk_fma_f32 v[84:85], v[84:85], v[136:137], v[28:29]
    v_pk_fma_f32 v[86:87], v[86:87], v[136:137], v[28:29]
    v_pk_mul_f32 v[80:81], v[80:81], v[56:57]
    v_pk_mul_f32 v[82:83], v[82:83], v[58:59]
    v_pk_mul_f32 v[84:85], v[84:85], v[68:69]
    v_pk_mul_f32 v[86:87], v[86:87], v[70:71]
    v_exp_f32 v80, v80
    v_exp_f32 v81, v81
    v_exp_f32 v82, v82
    v_exp_f32 v83, v83
    v_exp_f32 v84, v84
    v_exp_f32 v85, v85
    v_exp_f32 v86, v86
    v_exp_f32 v87, v87
    v_pk_add_f32 v[80:81], v[80:81], v[138:139]
    v_pk_add_f32 v[82:83], v[82:83], v[138:139]
    v_pk_add_f32 v[84:85], v[84:85], v[138:139]
    v_pk_add_f32 v[86:87], v[86:87], v[138:139]
    v_rcp_f32 v80, v80
    v_rcp_f32 v81, v81
    v_rcp_f32 v82, v82
    v_rcp_f32 v83, v83
    v_rcp_f32 v84, v84
    v_rcp_f32 v85, v85
    v_rcp_f32 v86, v86
    v_rcp_f32 v87, v87
    v_pk_mul_f32 v[80:81], v[80:81], v[56:57]
    v_pk_mul_f32 v[82:83], v[82:83], v[58:59]
    v_pk_mul_f32 v[84:85], v[84:85], v[68:69]
    v_pk_mul_f32 v[86:87], v[86:87], v[70:71]
    v_cvt_pk_bf16_f32 v152, v80, v81
    v_cvt_pk_bf16_f32 v153, v82, v83
    v_cvt_pk_bf16_f32 v154, v84, v85
    v_cvt_pk_bf16_f32 v155, v86, v87
    buffer_store_dwordx4 v[152:155], v215, s[12:15], s46 offen offset:1024 sc1
    v_pk_mul_f32 v[80:81], v[60:61], v[60:61]
    v_pk_mul_f32 v[82:83], v[62:63], v[62:63]
    v_pk_mul_f32 v[84:85], v[72:73], v[72:73]
    v_pk_mul_f32 v[86:87], v[74:75], v[74:75]
    v_pk_fma_f32 v[80:81], v[80:81], v[136:137], v[28:29]
    v_pk_fma_f32 v[82:83], v[82:83], v[136:137], v[28:29]
    v_pk_fma_f32 v[84:85], v[84:85], v[136:137], v[28:29]
    v_pk_fma_f32 v[86:87], v[86:87], v[136:137], v[28:29]
    v_pk_mul_f32 v[80:81], v[80:81], v[60:61]
    v_pk_mul_f32 v[82:83], v[82:83], v[62:63]
    v_pk_mul_f32 v[84:85], v[84:85], v[72:73]
    v_pk_mul_f32 v[86:87], v[86:87], v[74:75]
    v_exp_f32 v80, v80
    v_exp_f32 v81, v81
    v_exp_f32 v82, v82
    v_exp_f32 v83, v83
    v_exp_f32 v84, v84
    v_exp_f32 v85, v85
    v_exp_f32 v86, v86
    v_exp_f32 v87, v87
    v_pk_add_f32 v[80:81], v[80:81], v[138:139]
    v_pk_add_f32 v[82:83], v[82:83], v[138:139]
    v_pk_add_f32 v[84:85], v[84:85], v[138:139]
    v_pk_add_f32 v[86:87], v[86:87], v[138:139]
    v_rcp_f32 v80, v80
    v_rcp_f32 v81, v81
    v_rcp_f32 v82, v82
    v_rcp_f32 v83, v83
    v_rcp_f32 v84, v84
    v_rcp_f32 v85, v85
    v_rcp_f32 v86, v86
    v_rcp_f32 v87, v87
    v_pk_mul_f32 v[80:81], v[80:81], v[60:61]
    v_pk_mul_f32 v[82:83], v[82:83], v[62:63]
    v_pk_mul_f32 v[84:85], v[84:85], v[72:73]
    v_pk_mul_f32 v[86:87], v[86:87], v[74:75]
    v_cvt_pk_bf16_f32 v156, v80, v81
    v_cvt_pk_bf16_f32 v157, v82, v83
    v_cvt_pk_bf16_f32 v158, v84, v85
    v_cvt_pk_bf16_f32 v159, v86, v87
    buffer_store_dwordx4 v[156:159], v215, s[12:15], s46 offen offset:3072 sc1
    v_pk_mul_f32 v[80:81], v[64:65], v[64:65]
    v_pk_mul_f32 v[82:83], v[66:67], v[66:67]
    v_pk_mul_f32 v[84:85], v[76:77], v[76:77]
    v_pk_mul_f32 v[86:87], v[78:79], v[78:79]
    v_pk_fma_f32 v[80:81], v[80:81], v[136:137], v[28:29]
    v_pk_fma_f32 v[82:83], v[82:83], v[136:137], v[28:29]
    v_pk_fma_f32 v[84:85], v[84:85], v[136:137], v[28:29]
    v_pk_fma_f32 v[86:87], v[86:87], v[136:137], v[28:29]
    v_pk_mul_f32 v[80:81], v[80:81], v[64:65]
    v_pk_mul_f32 v[82:83], v[82:83], v[66:67]
    v_pk_mul_f32 v[84:85], v[84:85], v[76:77]
    v_pk_mul_f32 v[86:87], v[86:87], v[78:79]
    v_exp_f32 v80, v80
    v_exp_f32 v81, v81
    v_exp_f32 v82, v82
    v_exp_f32 v83, v83
    v_exp_f32 v84, v84
    v_exp_f32 v85, v85
    v_exp_f32 v86, v86
    v_exp_f32 v87, v87
    v_pk_add_f32 v[80:81], v[80:81], v[138:139]
    v_pk_add_f32 v[82:83], v[82:83], v[138:139]
    v_pk_add_f32 v[84:85], v[84:85], v[138:139]
    v_pk_add_f32 v[86:87], v[86:87], v[138:139]
    v_rcp_f32 v80, v80
    v_rcp_f32 v81, v81
    v_rcp_f32 v82, v82
    v_rcp_f32 v83, v83
    v_rcp_f32 v84, v84
    v_rcp_f32 v85, v85
    v_rcp_f32 v86, v86
    v_rcp_f32 v87, v87
    v_pk_mul_f32 v[80:81], v[80:81], v[64:65]
    v_pk_mul_f32 v[82:83], v[82:83], v[66:67]
    v_pk_mul_f32 v[84:85], v[84:85], v[76:77]
    v_pk_mul_f32 v[86:87], v[86:87], v[78:79]
    v_cvt_pk_bf16_f32 v160, v80, v81
    v_cvt_pk_bf16_f32 v161, v82, v83
    v_cvt_pk_bf16_f32 v162, v84, v85
    v_cvt_pk_bf16_f32 v163, v86, v87
    buffer_store_dwordx4 v[160:163], v215, s[12:15], s47 offen offset:1024 sc1
    s_mov_b32 s53, 1
    s_cmp_eq_u32 s53, 0
    s_cbranch_scc1 pg_11
    s_waitcnt vmcnt(0)
    s_mov_b64 exec, 1
    buffer_store_dwordx2 v[250:251], v248, s[16:19], s52 offen sc1
    s_mov_b64 exec, -1
pg_11:
    s_mov_b32 s53, 0
    s_branch c3_main
c3_entry:
    s_and_b32 s40, s20, 1
    s_lshr_b32 s41, s20, 1
    v_lshrrev_b32 v5, 2, v2
    v_and_b32 v6, 7, v5
    v_and_b32 v7, 3, v2
    v_lshlrev_b32 v7, 3, v7
    v_lshl_add_u32 v7, v5, 8, v7
    s_lshl_b32 s44, s40, 2
    s_add_u32 s45, s44, 0
    v_xor_b32 v8, s45, v6
    v_lshl_add_u32 v204, v8, 5, v7
    s_add_u32 s45, s44, 1
    v_xor_b32 v8, s45, v6
    v_lshl_add_u32 v205, v8, 5, v7
    s_add_u32 s45, s44, 2
    v_xor_b32 v8, s45, v6
    v_lshl_add_u32 v206, v8, 5, v7
    s_add_u32 s45, s44, 3
    v_xor_b32 v8, s45, v6
    v_lshl_add_u32 v207, v8, 5, v7
    s_mul_i32 s45, s41, 6144
    s_add_u32 s45, s45, 16384
    v_lshlrev_b32 v216, 4, v2
    v_add_u32 v208, s45, v216
    s_lshl_b32 s44, s20, 1
    s_add_u32 s45, s44, 0
    v_xor_b32 v8, s45, v6
    v_lshl_add_u32 v209, v8, 5, v7
    s_add_u32 s45, s44, 1
    v_xor_b32 v8, s45, v6
    v_lshl_add_u32 v210, v8, 5, v7
    v_and_b32 v3, 15, v2
    v_lshrrev_b32 v4, 4, v2
    v_and_b32 v5, 7, v3
    v_xor_b32 v5, v5, v4
    v_lshlrev_b32 v5, 4, v5
    v_lshl_add_u32 v5, v3, 7, v5
    v_add_u32 v211, 16384, v5
    v_xor_b32 v212, 64, v211
    v_add_u32 v213, 16384, v216
    v_add_u32 v214, 17408, v216
    v_lshlrev_b32 v217, 3, v4
    v_mov_b32 v215, v216
    v_lshrrev_b32 v5, 3, v2
    v_cmp_eq_u32 vcc, 3, v5
    v_add_u32 v5, 0x3000080, v215
    s_nop 0
    v_cndmask_b32 v215, v215, v5, vcc
    s_mov_b32 s53, 0
c3_main:
    s_barrier
    s_barrier
    v_add_u32 v10, s26, v209
    v_add_u32 v11, s26, v210
    v_add_u32 v12, s26, v211
    v_add_u32 v13, s26, v212
    ds_read_b128 v[104:107], v12 offset:0
    ds_read_b64_tr_b16 v[96:97], v10 offset:0
    ds_read_b64_tr_b16 v[98:99], v10 offset:4096
    ds_read_b64_tr_b16 v[100:101], v11 offset:0
    ds_read_b64_tr_b16 v[102:103], v11 offset:4096
    ds_read_b128 v[108:111], v12 offset:2048
    ds_read_b128 v[112:115], v12 offset:4096
    ds_read_b128 v[116:119], v12 offset:6144
    ds_read_b128 v[120:123], v12 offset:8192
    ds_read_b128 v[124:127], v12 offset:10240
    ds_read_b128 v[128:131], v12 offset:12288
    ds_read_b128 v[132:135], v12 offset:14336
    ds_read_b128 v[136:139], v12 offset:16384
    s_waitcnt lgkmcnt(6)
    v_mfma_f32_16x16x32_bf16 v[24:27], v[104:107], v[96:99], 0
    ds_read_b128 v[148:151], v13 offset:0
    v_mfma_f32_16x16x32_bf16 v[28:31], v[104:107], v[100:103], 0
    ds_read_b64_tr_b16 v[140:141], v10 offset:8192
    v_mfma_f32_16x16x32_bf16 v[32:35], v[108:111], v[96:99], 0
    ds_read_b64_tr_b16 v[142:143], v10 offset:12288
    v_mfma_f32_16x16x32_bf16 v[36:39], v[108:111], v[100:103], 0
    ds_read_b64_tr_b16 v[144:145], v11 offset:8192
    v_mfma_f32_16x16x32_bf16 v[40:43], v[112:115], v[96:99], 0
    ds_read_b64_tr_b16 v[146:147], v11 offset:12288
    v_mfma_f32_16x16x32_bf16 v[44:47], v[112:115], v[100:103], 0
    ds_read_b128 v[152:155], v13 offset:2048
    s_waitcnt lgkmcnt(6)
    v_mfma_f32_16x16x32_bf16 v[48:51], v[116:119], v[96:99], 0
    ds_read_b128 v[156:159], v13 offset:4096
    v_mfma_f32_16x16x32_bf16 v[52:55], v[116:119], v[100:103], 0
    ds_read_b128 v[160:163], v13 offset:6144
    s_add_u32 s26, s26, 34816
    v_mfma_f32_16x16x32_bf16 v[56:59], v[120:123], v[96:99], 0
    ds_read_b128 v[164:167], v13 offset:8192
    s_cmp_eq_u32 s26, 139264
    v_mfma_f32_16x16x32_bf16 v[60:63], v[120:123], v[100:103], 0
    ds_read_b128 v[168:171], v13 offset:10240
    s_cselect_b32 s26, 0, s26
    v_mfma_f32_16x16x32_bf16 v[64:67], v[124:127], v[96:99], 0
    ds_read_b128 v[172:175], v13 offset:12288
    v_mfma_f32_16x16x32_bf16 v[68:71], v[124:127], v[100:103], 0
    ds_read_b128 v[176:179], v13 offset:14336
    v_add_u32 v10, s26, v209
    v_mfma_f32_16x16x32_bf16 v[72:75], v[128:131], v[96:99], 0
    ds_read_b128 v[180:183], v13 offset:16384
    v_mfma_f32_16x16x32_bf16 v[76:79], v[128:131], v[100:103], 0
    v_add_u32 v11, s26, v210
    v_mfma_f32_16x16x32_bf16 v[80:83], v[132:135], v[96:99], 0
    v_add_u32 v12, s26, v211
    v_mfma_f32_16x16x32_bf16 v[84:87], v[132:135], v[100:103], 0
    v_add_u32 v13, s26, v212
    v_mfma_f32_16x16x32_bf16 v[88:91], v[136:139], v[96:99], 0
    v_mfma_f32_16x16x32_bf16 v[92:95], v[136:139], v[100:103], 0
    s_waitcnt lgkmcnt(6)
    v_mfma_f32_16x16x32_bf16 v[24:27], v[148:151], v[140:143], v[24:27]
    ds_read_b128 v[104:107], v12 offset:0
    v_mfma_f32_16x16x32_bf16 v[28:31], v[148:151], v[144:147], v[28:31]
    ds_read_b64_tr_b16 v[96:97], v10 offset:0
    v_mfma_f32_16x16x32_bf16 v[32:35], v[152:155], v[140:143], v[32:35]
    ds_read_b64_tr_b16 v[98:99], v10 offset:4096
    v_mfma_f32_16x16x32_bf16 v[36:39], v[152:155], v[144:147], v[36:39]
    ds_read_b64_tr_b16 v[100:101], v11 offset:0
    v_mfma_f32_16x16x32_bf16 v[40:43], v[156:159], v[140:143], v[40:43]
    ds_read_b64_tr_b16 v[102:103], v11 offset:4096
    v_mfma_f32_16x16x32_bf16 v[44:47], v[156:159], v[144:147], v[44:47]
    ds_read_b128 v[108:111], v12 offset:2048
    s_waitcnt lgkmcnt(6)
    v_mfma_f32_16x16x32_bf16 v[48:51], v[160:163], v[140:143], v[48:51]
    ds_read_b128 v[112:115], v12 offset:4096
    v_mfma_f32_16x16x32_bf16 v[52:55], v[160:163], v[144:147], v[52:55]
    ds_read_b128 v[116:119], v12 offset:6144
    v_mfma_f32_16x16x32_bf16 v[56:59], v[164:167], v[140:143], v[56:59]
    ds_read_b128 v[120:123], v12 offset:8192
    v_mfma_f32_16x16x32_bf16 v[60:63], v[164:167], v[144:147], v[60:63]
    ds_read_b128 v[124:127], v12 offset:10240
    v_mfma_f32_16x16x32_bf16 v[64:67], v[168:171], v[140:143], v[64:67]
    ds_read_b128 v[128:131], v12 offset:12288
    v_mfma_f32_16x16x32_bf16 v[68:71], v[168:171], v[144:147], v[68:71]
    ds_read_b128 v[132:135], v12 offset:14336
    v_mfma_f32_16x16x32_bf16 v[72:75], v[172:175], v[140:143], v[72:75]
    ds_read_b128 v[136:139], v12 offset:16384
    v_mfma_f32_16x16x32_bf16 v[76:79], v[172:175], v[144:147], v[76:79]
    v_mfma_f32_16x16x32_bf16 v[80:83], v[176:179], v[140:143], v[80:83]
    v_mfma_f32_16x16x32_bf16 v[84:87], v[176:179], v[144:147], v[84:87]
    v_mfma_f32_16x16x32_bf16 v[88:91], v[180:183], v[140:143], v[88:91]
    v_mfma_f32_16x16x32_bf16 v[92:95], v[180:183], v[144:147], v[92:95]
    s_cmp_eq_u32 s53, 0
    s_cbranch_scc1 pg_12
    s_waitcnt vmcnt(0)
    s_mov_b64 exec, 1
    buffer_store_dwordx2 v[250:251], v248, s[16:19], s52 offen sc1
    s_mov_b64 exec, -1
pg_12:
    s_sub_u32 s27, s38, 2
c3_f:
    s_waitcnt lgkmcnt(6)
    v_mfma_f32_16x16x32_bf16 v[24:27], v[104:107], v[96:99], v[24:27]
    ds_read_b128 v[148:151], v13 offset:0
    v_mfma_f32_16x16x32_bf16 v[28:31], v[104:107], v[100:103], v[28:31]
    ds_read_b64_tr_b16 v[140:141], v10 offset:8192
    v_mfma_f32_16x16x32_bf16 v[32:35], v[108:111], v[96:99], v[32:35]
    ds_read_b64_tr_b16 v[142:143], v10 offset:12288
    v_mfma_f32_16x16x32_bf16 v[36:39], v[108:111], v[100:103], v[36:39]
    ds_read_b64_tr_b16 v[144:145], v11 offset:8192
    v_mfma_f32_16x16x32_bf16 v[40:43], v[112:115], v[96:99], v[40:43]
    ds_read_b64_tr_b16 v[146:147], v11 offset:12288
    v_mfma_f32_16x16x32_bf16 v[44:47], v[112:115], v[100:103], v[44:47]
    ds_read_b128 v[152:155], v13 offset:2048
    s_waitcnt lgkmcnt(6)
    v_mfma_f32_16x16x32_bf16 v[48:51], v[116:119], v[96:99], v[48:51]
    ds_read_b128 v[156:159], v13 offset:4096
    v_mfma_f32_16x16x32_bf16 v[52:55], v[116:119], v[100:103], v[52:55]
    ds_read_b128 v[160:163], v13 offset:6144
    s_add_u32 s26, s26, 34816
    v_mfma_f32_16x16x32_bf16 v[56:59], v[120:123], v[96:99], v[56:59]
    ds_read_b128 v[164:167], v13 offset:8192
    s_cmp_eq_u32 s26, 139264
    v_mfma_f32_16x16x32_bf16 v[60:63], v[120:123], v[100:103], v[60:63]
    ds_read_b128 v[168:171], v13 offset:10240
    s_cselect_b32 s26, 0, s26
    v_mfma_f32_16x16x32_bf16 v[64:67], v[124:127], v[96:99], v[64:67]
    ds_read_b128 v[172:175], v13 offset:12288
    v_mfma_f32_16x16x32_bf16 v[68:71], v[124:127], v[100:103], v[68:71]
    ds_read_b128 v[176:179], v13 offset:14336
    v_add_u32 v10, s26, v209
    v_mfma_f32_16x16x32_bf16 v[72:75], v[128:131], v[96:99], v[72:75]
    ds_read_b128 v[180:183], v13 offset:16384
    v_mfma_f32_16x16x32_bf16 v[76:79], v[128:131], v[100:103], v[76:79]
    v_add_u32 v11, s26, v210
    v_mfma_f32_16x16x32_bf16 v[80:83], v[132:135], v[96:99], v[80:83]
    v_add_u32 v12, s26, v211
    v_mfma_f32_16x16x32_bf16 v[84:87], v[132:135], v[100:103], v[84:87]
    v_add_u32 v13, s26, v212
    v_mfma_f32_16x16x32_bf16 v[88:91], v[136:139], v[96:99], v[88:91]
    v_mfma_f32_16x16x32_bf16 v[92:95], v[136:139], v[100:103], v[92:95]
    s_barrier
    s_waitcnt lgkmcnt(6)
    v_mfma_f32_16x16x32_bf16 v[24:27], v[148:151], v[140:143], v[24:27]
    ds_read_b128 v[104:107], v12 offset:0
    v_mfma_f32_16x16x32_bf16 v[28:31], v[148:151], v[144:147], v[28:31]
    ds_read_b64_tr_b16 v[96:97], v10 offset:0
    v_mfma_f32_16x16x32_bf16 v[32:35], v[152:155], v[140:143], v[32:35]
    ds_read_b64_tr_b16 v[98:99], v10 offset:4096
    v_mfma_f32_16x16x32_bf16 v[36:39], v[152:155], v[144:147], v[36:39]
    ds_read_b64_tr_b16 v[100:101], v11 offset:0
    v_mfma_f32_16x16x32_bf16 v[40:43], v[156:159], v[140:143], v[40:43]
    ds_read_b64_tr_b16 v[102:103], v11 offset:4096
    v_mfma_f32_16x16x32_bf16 v[44:47], v[156:159], v[144:147], v[44:47]
    ds_read_b128 v[108:111], v12 offset:2048
    s_waitcnt lgkmcnt(6)
    v_mfma_f32_16x16x32_bf16 v[48:51], v[160:163], v[140:143], v[48:51]
    ds_read_b128 v[112:115], v12 offset:4096
    v_mfma_f32_16x16x32_bf16 v[52:55], v[160:163], v[144:147], v[52:55]
    ds_read_b128 v[116:119], v12 offset:6144
    v_mfma_f32_16x16x32_bf16 v[56:59], v[164:167], v[140:143], v[56:59]
    ds_read_b128 v[120:123], v12 offset:8192
    v_mfma_f32_16x16x32_bf16 v[60:63], v[164:167], v[144:147], v[60:63]
    ds_read_b128 v[124:127], v12 offset:10240
    v_mfma_f32_16x16x32_bf16 v[64:67], v[168:171], v[140:143], v[64:67]
    ds_read_b128 v[128:131], v12 offset:12288
    v_mfma_f32_16x16x32_bf16 v[68:71], v[168:171], v[144:147], v[68:71]
    ds_read_b128 v[132:135], v12 offset:14336
    v_mfma_f32_16x16x32_bf16 v[72:75], v[172:175], v[140:143], v[72:75]
    ds_read_b128 v[136:139], v12 offset:16384
    v_mfma_f32_16x16x32_bf16 v[76:79], v[172:175], v[144:147], v[76:79]
    v_mfma_f32_16x16x32_bf16 v[80:83], v[176:179], v[140:143], v[80:83]
    v_mfma_f32_16x16x32_bf16 v[84:87], v[176:179], v[144:147], v[84:87]
    s_sub_u32 s27, s27, 1
    v_mfma_f32_16x16x32_bf16 v[88:91], v[180:183], v[140:143], v[88:91]
    s_cmp_lg_u32 s27, 0
    v_mfma_f32_16x16x32_bf16 v[92:95], v[180:183], v[144:147], v[92:95]
    s_cbranch_scc1 c3_f
    s_waitcnt lgkmcnt(6)
    v_mfma_f32_16x16x32_bf16 v[24:27], v[104:107], v[96:99], v[24:27]
    ds_read_b128 v[148:151], v13 offset:0
    v_mfma_f32_16x16x32_bf16 v[28:31], v[104:107], v[100:103], v[28:31]
    ds_read_b64_tr_b16 v[140:141], v10 offset:8192
    v_mfma_f32_16x16x32_bf16 v[32:35], v[108:111], v[96:99], v[32:35]
    ds_read_b64_tr_b16 v[142:143], v10 offset:12288
    v_mfma_f32_16x16x32_bf16 v[36:39], v[108:111], v[100:103], v[36:39]
    ds_read_b64_tr_b16 v[144:145], v11 offset:8192
    v_mfma_f32_16x16x32_bf16 v[40:43], v[112:115], v[96:99], v[40:43]
    ds_read_b64_tr_b16 v[146:147], v11 offset:12288
    v_mfma_f32_16x16x32_bf16 v[44:47], v[112:115], v[100:103], v[44:47]
    ds_read_b128 v[152:155], v13 offset:2048
    s_waitcnt lgkmcnt(6)
    v_mfma_f32_16x16x32_bf16 v[48:51], v[116:119], v[96:99], v[48:51]
    ds_read_b128 v[156:159], v13 offset:4096
    v_mfma_f32_16x16x32_bf16 v[52:55], v[116:119], v[100:103], v[52:55]
    ds_read_b128 v[160:163], v13 offset:6144
    s_add_u32 s26, s26, 34816
    v_mfma_f32_16x16x32_bf16 v[56:59], v[120:123], v[96:99], v[56:59]
    ds_read_b128 v[164:167], v13 offset:8192
    s_cmp_eq_u32 s26, 139264
    v_mfma_f32_16x16x32_bf16 v[60:63], v[120:123], v[100:103], v[60:63]
    ds_read_b128 v[168:171], v13 offset:10240
    s_cselect_b32 s26, 0, s26
    v_mfma_f32_16x16x32_bf16 v[64:67], v[124:127], v[96:99], v[64:67]
    ds_read_b128 v[172:175], v13 offset:12288
    v_mfma_f32_16x16x32_bf16 v[68:71], v[124:127], v[100:103], v[68:71]
    ds_read_b128 v[176:179], v13 offset:14336
    v_add_u32 v10, s26, v209
    v_mfma_f32_16x16x32_bf16 v[72:75], v[128:131], v[96:99], v[72:75]
    ds_read_b128 v[180:183], v13 offset:16384
    v_mfma_f32_16x16x32_bf16 v[76:79], v[128:131], v[100:103], v[76:79]
    v_add_u32 v11, s26, v210
    v_mfma_f32_16x16x32_bf16 v[80:83], v[132:135], v[96:99], v[80:83]
    v_add_u32 v12, s26, v211
    v_mfma_f32_16x16x32_bf16 v[84:87], v[132:135], v[100:103], v[84:87]
    v_add_u32 v13, s26, v212
    v_mfma_f32_16x16x32_bf16 v[88:91], v[136:139], v[96:99], v[88:91]
    v_mfma_f32_16x16x32_bf16 v[92:95], v[136:139], v[100:103], v[92:95]
    v_mov_b32 v211, v213
    v_mov_b32 v212, v214
    v_add_u32 v12, s26, v213
    v_add_u32 v13, s26, v214
    s_barrier
    s_waitcnt lgkmcnt(6)
    v_mfma_f32_16x16x32_bf16 v[24:27], v[148:151], v[140:143], v[24:27]
    ds_read_b128 v[104:107], v12 offset:0
    v_mfma_f32_16x16x32_bf16 v[28:31], v[148:151], v[144:147], v[28:31]
    ds_read_b64_tr_b16 v[96:97], v10 offset:0
    v_mfma_f32_16x16x32_bf16 v[32:35], v[152:155], v[140:143], v[32:35]
    ds_read_b64_tr_b16 v[98:99], v10 offset:4096
    v_mfma_f32_16x16x32_bf16 v[36:39], v[152:155], v[144:147], v[36:39]
    ds_read_b64_tr_b16 v[100:101], v11 offset:0
    v_mfma_f32_16x16x32_bf16 v[40:43], v[156:159], v[140:143], v[40:43]
    ds_read_b64_tr_b16 v[102:103], v11 offset:4096
    v_mfma_f32_16x16x32_bf16 v[44:47], v[156:159], v[144:147], v[44:47]
    ds_read_b128 v[108:111], v12 offset:2048
    s_waitcnt lgkmcnt(6)
    v_mfma_f32_16x16x32_bf16 v[48:51], v[160:163], v[140:143], v[48:51]
    ds_read_b128 v[112:115], v12 offset:4096
    v_mfma_f32_16x16x32_bf16 v[52:55], v[160:163], v[144:147], v[52:55]
    ds_read_b128 v[116:119], v12 offset:6144
    v_mfma_f32_16x16x32_bf16 v[56:59], v[164:167], v[140:143], v[56:59]
    ds_read_b128 v[120:123], v12 offset:8192
    v_mfma_f32_16x16x32_bf16 v[60:63], v[164:167], v[144:147], v[60:63]
    ds_read_b128 v[124:127], v12 offset:10240
    v_mfma_f32_16x16x32_bf16 v[64:67], v[168:171], v[140:143], v[64:67]
    ds_read_b128 v[128:131], v12 offset:12288
    v_mfma_f32_16x16x32_bf16 v[68:71], v[168:171], v[144:147], v[68:71]
    ds_read_b128 v[132:135], v12 offset:14336
    v_mfma_f32_16x16x32_bf16 v[72:75], v[172:175], v[140:143], v[72:75]
    ds_read_b128 v[136:139], v12 offset:16384
    v_mfma_f32_16x16x32_bf16 v[76:79], v[172:175], v[144:147], v[76:79]
    v_mfma_f32_16x16x32_bf16 v[80:83], v[176:179], v[140:143], v[80:83]
    v_mfma_f32_16x16x32_bf16 v[84:87], v[176:179], v[144:147], v[84:87]
    v_mfma_f32_16x16x32_bf16 v[88:91], v[180:183], v[140:143], v[88:91]
    v_mfma_f32_16x16x32_bf16 v[92:95], v[180:183], v[144:147], v[92:95]
    s_mov_b32 s27, 17
c3_u:
    s_waitcnt lgkmcnt(6)
    v_mfma_f32_16x16x32_bf16 v[24:27], v[104:107], v[96:99], v[24:27]
    ds_read_b128 v[148:151], v13 offset:0
    v_mfma_f32_16x16x32_bf16 v[28:31], v[104:107], v[100:103], v[28:31]
    ds_read_b64_tr_b16 v[140:141], v10 offset:8192
    v_mfma_f32_16x16x32_bf16 v[32:35], v[108:111], v[96:99], v[32:35]
    ds_read_b64_tr_b16 v[142:143], v10 offset:12288
    v_mfma_f32_16x16x32_bf16 v[36:39], v[108:111], v[100:103], v[36:39]
    ds_read_b64_tr_b16 v[144:145], v11 offset:8192
    v_mfma_f32_16x16x32_bf16 v[40:43], v[112:115], v[96:99], v[40:43]
    ds_read_b64_tr_b16 v[146:147], v11 offset:12288
    v_mfma_f32_16x16x32_bf16 v[44:47], v[112:115], v[100:103], v[44:47]
    ds_read_b128 v[152:155], v13 offset:2048
    s_waitcnt lgkmcnt(6)
    v_mfma_f32_16x16x32_bf16 v[48:51], v[116:119], v[96:99], v[48:51]
    ds_read_b128 v[156:159], v13 offset:4096
    v_mfma_f32_16x16x32_bf16 v[52:55], v[116:119], v[100:103], v[52:55]
    ds_read_b128 v[160:163], v13 offset:6144
    s_add_u32 s26, s26, 34816
    v_mfma_f32_16x16x32_bf16 v[56:59], v[120:123], v[96:99], v[56:59]
    ds_read_b128 v[164:167], v13 offset:8192
    s_cmp_eq_u32 s26, 139264
    v_mfma_f32_16x16x32_bf16 v[60:63], v[120:123], v[100:103], v[60:63]
    ds_read_b128 v[168:171], v13 offset:10240
    s_cselect_b32 s26, 0, s26
    v_mfma_f32_16x16x32_bf16 v[64:67], v[124:127], v[96:99], v[64:67]
    ds_read_b128 v[172:175], v13 offset:12288
    v_mfma_f32_16x16x32_bf16 v[68:71], v[124:127], v[100:103], v[68:71]
    ds_read_b128 v[176:179], v13 offset:14336
    v_add_u32 v10, s26, v209
    v_mfma_f32_16x16x32_bf16 v[72:75], v[128:131], v[96:99], v[72:75]
    ds_read_b128 v[180:183], v13 offset:16384
    v_mfma_f32_16x16x32_bf16 v[76:79], v[128:131], v[100:103], v[76:79]
    v_add_u32 v11, s26, v210
    v_mfma_f32_16x16x32_bf16 v[80:83], v[132:135], v[96:99], v[80:83]
    v_add_u32 v12, s26, v211
    v_mfma_f32_16x16x32_bf16 v[84:87], v[132:135], v[100:103], v[84:87]
    v_add_u32 v13, s26, v212
    v_mfma_f32_16x16x32_bf16 v[88:91], v[136:139], v[96:99], v[88:91]
    v_mfma_f32_16x16x32_bf16 v[92:95], v[136:139], v[100:103], v[92:95]
    s_barrier
    s_waitcnt lgkmcnt(6)
    v_mfma_f32_16x16x32_bf16 v[24:27], v[148:151], v[140:143], v[24:27]
    ds_read_b128 v[104:107], v12 offset:0
    v_mfma_f32_16x16x32_bf16 v[28:31], v[148:151], v[144:147], v[28:31]
    ds_read_b64_tr_b16 v[96:97], v10 offset:0
    v_mfma_f32_16x16x32_bf16 v[32:35], v[152:155], v[140:143], v[32:35]
    ds_read_b64_tr_b16 v[98:99], v10 offset:4096
    v_mfma_f32_16x16x32_bf16 v[36:39], v[152:155], v[144:147], v[36:39]
    ds_read_b64_tr_b16 v[100:101], v11 offset:0
    v_mfma_f32_16x16x32_bf16 v[40:43], v[156:159], v[140:143], v[40:43]
    ds_read_b64_tr_b16 v[102:103], v11 offset:4096
    v_mfma_f32_16x16x32_bf16 v[44:47], v[156:159], v[144:147], v[44:47]
    ds_read_b128 v[108:111], v12 offset:2048
    s_waitcnt lgkmcnt(6)
    v_mfma_f32_16x16x32_bf16 v[48:51], v[160:163], v[140:143], v[48:51]
    ds_read_b128 v[112:115], v12 offset:4096
    v_mfma_f32_16x16x32_bf16 v[52:55], v[160:163], v[144:147], v[52:55]
    ds_read_b128 v[116:119], v12 offset:6144
    v_mfma_f32_16x16x32_bf16 v[56:59], v[164:167], v[140:143], v[56:59]
    ds_read_b128 v[120:123], v12 offset:8192
    v_mfma_f32_16x16x32_bf16 v[60:63], v[164:167], v[144:147], v[60:63]
    ds_read_b128 v[124:127], v12 offset:10240
    v_mfma_f32_16x16x32_bf16 v[64:67], v[168:171], v[140:143], v[64:67]
    ds_read_b128 v[128:131], v12 offset:12288
    v_mfma_f32_16x16x32_bf16 v[68:71], v[168:171], v[144:147], v[68:71]
    ds_read_b128 v[132:135], v12 offset:14336
    v_mfma_f32_16x16x32_bf16 v[72:75], v[172:175], v[140:143], v[72:75]
    ds_read_b128 v[136:139], v12 offset:16384
    v_mfma_f32_16x16x32_bf16 v[76:79], v[172:175], v[144:147], v[76:79]
    v_mfma_f32_16x16x32_bf16 v[80:83], v[176:179], v[140:143], v[80:83]
    v_mfma_f32_16x16x32_bf16 v[84:87], v[176:179], v[144:147], v[84:87]
    s_sub_u32 s27, s27, 1
    v_mfma_f32_16x16x32_bf16 v[88:91], v[180:183], v[140:143], v[88:91]
    s_cmp_lg_u32 s27, 0
    v_mfma_f32_16x16x32_bf16 v[92:95], v[180:183], v[144:147], v[92:95]
    s_cbranch_scc1 c3_u
    s_waitcnt lgkmcnt(6)
    v_mfma_f32_16x16x32_bf16 v[24:27], v[104:107], v[96:99], v[24:27]
    ds_read_b128 v[148:151], v13 offset:0
    s_add_u32 s12, s96, 0x2000000
    v_mfma_f32_16x16x32_bf16 v[28:31], v[104:107], v[100:103], v[28:31]
    ds_read_b64_tr_b16 v[140:141], v10 offset:8192
    s_addc_u32 s13, s97, 0
    v_mfma_f32_16x16x32_bf16 v[32:35], v[108:111], v[96:99], v[32:35]
    ds_read_b64_tr_b16 v[142:143], v10 offset:12288
    s_mov_b32 s14, 0x900000
    v_mfma_f32_16x16x32_bf16 v[36:39], v[108:111], v[100:103], v[36:39]
    ds_read_b64_tr_b16 v[144:145], v11 offset:8192
    s_mov_b32 s15, 0x00020000
    v_mfma_f32_16x16x32_bf16 v[40:43], v[112:115], v[96:99], v[40:43]
    ds_read_b64_tr_b16 v[146:147], v11 offset:12288
    s_lshl_b32 s44, s35, 2
    v_mfma_f32_16x16x32_bf16 v[44:47], v[112:115], v[100:103], v[44:47]
    ds_read_b128 v[152:155], v13 offset:2048
    s_add_u32 s44, s44, s36
    s_waitcnt lgkmcnt(6)
    v_mfma_f32_16x16x32_bf16 v[48:51], v[116:119], v[96:99], v[48:51]
    ds_read_b128 v[156:159], v13 offset:4096
    s_lshl_b32 s44, s44, 2
    v_mfma_f32_16x16x32_bf16 v[52:55], v[116:119], v[100:103], v[52:55]
    ds_read_b128 v[160:163], v13 offset:6144
    s_add_u32 s44, s44, s20
    v_mfma_f32_16x16x32_bf16 v[56:59], v[120:123], v[96:99], v[56:59]
    ds_read_b128 v[164:167], v13 offset:8192
    s_lshl_b32 s52, s44, 7
    v_mfma_f32_16x16x32_bf16 v[60:63], v[120:123], v[100:103], v[60:63]
    ds_read_b128 v[168:171], v13 offset:10240
    s_lshl_b32 s45, s34, 3
    v_mfma_f32_16x16x32_bf16 v[64:67], v[124:127], v[96:99], v[64:67]
    ds_read_b128 v[172:175], v13 offset:12288
    s_add_u32 s52, s52, s45
    v_mfma_f32_16x16x32_bf16 v[68:71], v[124:127], v[100:103], v[68:71]
    ds_read_b128 v[176:179], v13 offset:14336
    s_add_u32 s52, s52, 20480
    v_mfma_f32_16x16x32_bf16 v[72:75], v[128:131], v[96:99], v[72:75]
    ds_read_b128 v[180:183], v13 offset:16384
    s_lshl_b32 s44, s44, 2
    v_mfma_f32_16x16x32_bf16 v[76:79], v[128:131], v[100:103], v[76:79]
    s_add_u32 s44, s44, s34
    v_mfma_f32_16x16x32_bf16 v[80:83], v[132:135], v[96:99], v[80:83]
    s_mul_i32 s44, s44, 9216
    v_mfma_f32_16x16x32_bf16 v[84:87], v[132:135], v[100:103], v[84:87]
    v_add_u32 v16, 139264, v216
    v_mfma_f32_16x16x32_bf16 v[88:91], v[136:139], v[96:99], v[88:91]
    s_cmp_eq_u32 s20, s34
    v_mfma_f32_16x16x32_bf16 v[92:95], v[136:139], v[100:103], v[92:95]
    s_cbranch_scc1 c3_own
    s_waitcnt lgkmcnt(6)
    v_mfma_f32_16x16x32_bf16 v[24:27], v[148:151], v[140:143], v[24:27]
    v_mfma_f32_16x16x32_bf16 v[28:31], v[148:151], v[144:147], v[28:31]
    v_mfma_f32_16x16x32_bf16 v[32:35], v[152:155], v[140:143], v[32:35]
    v_mfma_f32_16x16x32_bf16 v[36:39], v[152:155], v[144:147], v[36:39]
    v_mfma_f32_16x16x32_bf16 v[40:43], v[156:159], v[140:143], v[40:43]
    v_mfma_f32_16x16x32_bf16 v[44:47], v[156:159], v[144:147], v[44:47]
    s_waitcnt lgkmcnt(0)
    v_mfma_f32_16x16x32_bf16 v[48:51], v[160:163], v[140:143], v[48:51]
    v_mfma_f32_16x16x32_bf16 v[52:55], v[160:163], v[144:147], v[52:55]
    v_mfma_f32_16x16x32_bf16 v[56:59], v[164:167], v[140:143], v[56:59]
    v_mfma_f32_16x16x32_bf16 v[60:63], v[164:167], v[144:147], v[60:63]
    v_cvt_pk_bf16_f32 v96, v24, v25
    v_cvt_pk_bf16_f32 v97, v26, v27
    v_cvt_pk_bf16_f32 v98, v28, v29
    v_cvt_pk_bf16_f32 v99, v30, v31
    buffer_store_dwordx4 v[96:99], v216, s[12:15], s44 offen offset:0 sc1
    v_mfma_f32_16x16x32_bf16 v[64:67], v[168:171], v[140:143], v[64:67]
    v_mfma_f32_16x16x32_bf16 v[68:71], v[168:171], v[144:147], v[68:71]
    v_cvt_pk_bf16_f32 v100, v32, v33
    v_cvt_pk_bf16_f32 v101, v34, v35
    v_cvt_pk_bf16_f32 v102, v36, v37
    v_cvt_pk_bf16_f32 v103, v38, v39
    buffer_store_dwordx4 v[100:103], v216, s[12:15], s44 offen offset:1024 sc1
    v_mfma_f32_16x16x32_bf16 v[72:75], v[172:175], v[140:143], v[72:75]
    v_mfma_f32_16x16x32_bf16 v[76:79], v[172:175], v[144:147], v[76:79]
    v_cvt_pk_bf16_f32 v104, v40, v41
    v_cvt_pk_bf16_f32 v105, v42, v43
    v_cvt_pk_bf16_f32 v106, v44, v45
    v_cvt_pk_bf16_f32 v107, v46, v47
    buffer_store_dwordx4 v[104:107], v216, s[12:15], s44 offen offset:2048 sc1
    v_mfma_f32_16x16x32_bf16 v[80:83], v[176:179], v[140:143], v[80:83]
    v_mfma_f32_16x16x32_bf16 v[84:87], v[176:179], v[144:147], v[84:87]
    v_cvt_pk_bf16_f32 v108, v48, v49
    v_cvt_pk_bf16_f32 v109, v50, v51
    v_cvt_pk_bf16_f32 v110, v52, v53
    v_cvt_pk_bf16_f32 v111, v54, v55
    buffer_store_dwordx4 v[108:111], v216, s[12:15], s44 offen offset:3072 sc1
    s_add_u32 s44, s44, 4096
    v_mfma_f32_16x16x32_bf16 v[88:91], v[180:183], v[140:143], v[88:91]
    v_mfma_f32_16x16x32_bf16 v[92:95], v[180:183], v[144:147], v[92:95]
    v_cvt_pk_bf16_f32 v112, v56, v57
    v_cvt_pk_bf16_f32 v113, v58, v59
    v_cvt_pk_bf16_f32 v114, v60, v61
    v_cvt_pk_bf16_f32 v115, v62, v63
    buffer_store_dwordx4 v[112:115], v216, s[12:15], s44 offen offset:0 sc1
    v_cvt_pk_bf16_f32 v116, v64, v65
    v_cvt_pk_bf16_f32 v117, v66, v67
    v_cvt_pk_bf16_f32 v118, v68, v69
    v_cvt_pk_bf16_f32 v119, v70, v71
    buffer_store_dwordx4 v[116:119], v216, s[12:15], s44 offen offset:1024 sc1
    v_cvt_pk_bf16_f32 v120, v72, v73
    v_cvt_pk_bf16_f32 v121, v74, v75
    v_cvt_pk_bf16_f32 v122, v76, v77
    v_cvt_pk_bf16_f32 v123, v78, v79
    buffer_store_dwordx4 v[120:123], v216, s[12:15], s44 offen offset:2048 sc1
    v_cvt_pk_bf16_f32 v124, v80, v81
    v_cvt_pk_bf16_f32 v125, v82, v83
    v_cvt_pk_bf16_f32 v126, v84, v85
    v_cvt_pk_bf16_f32 v127, v86, v87
    buffer_store_dwordx4 v[124:127], v216, s[12:15], s44 offen offset:3072 sc1
    s_add_u32 s44, s44, 4096
    s_nop 3
    v_cvt_pk_bf16_f32 v128, v88, v89
    v_cvt_pk_bf16_f32 v129, v90, v91
    v_cvt_pk_bf16_f32 v130, v92, v93
    v_cvt_pk_bf16_f32 v131, v94, v95
    buffer_store_dwordx4 v[128:131], v216, s[12:15], s44 offen offset:0 sc1
    s_waitcnt vmcnt(0)
    s_mov_b64 exec, 1
    buffer_store_dwordx2 v[250:251], v248, s[16:19], s52 offen sc1
    s_mov_b64 exec, -1
    s_endpgm
c3_own:
    s_waitcnt lgkmcnt(6)
    v_mfma_f32_16x16x32_bf16 v[24:27], v[148:151], v[140:143], v[24:27]
    v_mfma_f32_16x16x32_bf16 v[28:31], v[148:151], v[144:147], v[28:31]
    v_mfma_f32_16x16x32_bf16 v[32:35], v[152:155], v[140:143], v[32:35]
    v_mfma_f32_16x16x32_bf16 v[36:39], v[152:155], v[144:147], v[36:39]
    v_mfma_f32_16x16x32_bf16 v[40:43], v[156:159], v[140:143], v[40:43]
    v_mfma_f32_16x16x32_bf16 v[44:47], v[156:159], v[144:147], v[44:47]
    s_waitcnt lgkmcnt(0)
    v_mfma_f32_16x16x32_bf16 v[48:51], v[160:163], v[140:143], v[48:51]
    v_mfma_f32_16x16x32_bf16 v[52:55], v[160:163], v[144:147], v[52:55]
    v_mfma_f32_16x16x32_bf16 v[56:59], v[164:167], v[140:143], v[56:59]
    v_mfma_f32_16x16x32_bf16 v[60:63], v[164:167], v[144:147], v[60:63]
    ds_write_b128 v16, v[24:27] offset:0
    ds_write_b128 v16, v[28:31] offset:1024
    v_mfma_f32_16x16x32_bf16 v[64:67], v[168:171], v[140:143], v[64:67]
    v_mfma_f32_16x16x32_bf16 v[68:71], v[168:171], v[144:147], v[68:71]
    ds_write_b128 v16, v[32:35] offset:2048
    ds_write_b128 v16, v[36:39] offset:3072
    v_mfma_f32_16x16x32_bf16 v[72:75], v[172:175], v[140:143], v[72:75]
    v_mfma_f32_16x16x32_bf16 v[76:79], v[172:175], v[144:147], v[76:79]
    ds_write_b128 v16, v[40:43] offset:4096
    ds_write_b128 v16, v[44:47] offset:5120
    v_mfma_f32_16x16x32_bf16 v[80:83], v[176:179], v[140:143], v[80:83]
    v_mfma_f32_16x16x32_bf16 v[84:87], v[176:179], v[144:147], v[84:87]
    ds_write_b128 v16, v[48:51] offset:6144
    ds_write_b128 v16, v[52:55] offset:7168
    v_mfma_f32_16x16x32_bf16 v[88:91], v[180:183], v[140:143], v[88:91]
    v_mfma_f32_16x16x32_bf16 v[92:95], v[180:183], v[144:147], v[92:95]
    ds_write_b128 v16, v[56:59] offset:8192
    ds_write_b128 v16, v[60:63] offset:9216
    ds_write_b128 v16, v[64:67] offset:10240
    ds_write_b128 v16, v[68:71] offset:11264
    ds_write_b128 v16, v[72:75] offset:12288
    ds_write_b128 v16, v[76:79] offset:13312
    s_nop 3
    ds_write_b128 v16, v[80:83] offset:14336
    ds_write_b128 v16, v[84:87] offset:15360
    s_nop 3
    ds_write_b128 v16, v[88:91] offset:16384
    ds_write_b128 v16, v[92:95] offset:17408
    s_waitcnt lgkmcnt(0)
    s_barrier
    s_branch k_done
hi_entry:
    s_sub_u32 s3, s21, 19
    s_cmp_lt_u32 s3, 8
    s_cbranch_scc1 ln_hi
    s_sub_u32 s23, s20, 4
    v_lshrrev_b32 v3, 3, v2
    v_and_b32 v4, 7, v2
    v_xor_b32 v6, v4, v3
    s_movk_i32 s44, 1152
    v_mul_lo_u32 v5, v3, s44
    v_lshlrev_b32 v8, 1, v5
    v_lshl_add_u32 v10, v6, 4, v8
    s_lshr_b32 s44, s23, 1
    v_and_b32 v7, 6, v3
    v_or_b32 v7, s44, v7
    v_xor_b32 v7, v4, v7
    v_lshl_add_u32 v14, v7, 4, v5
    v_add_u32 v11, 0x4400, v10
    v_add_u32 v12, 0x480, v10
    v_add_u32 v13, 0x4880, v10
    v_add_u32 v15, 0x2000, v14
    v_add_u32 v16, 0x4000, v14
    s_lshl_b32 s42, s30, 7
    s_lshl_b32 s45, s23, 5
    s_add_u32 s42, s42, s45
    s_mul_i32 s42, s42, 1152
    s_mul_i32 s43, s31, 48
    s_and_b32 s45, s23, 1
    s_mul_i32 s45, s45, 24
    s_add_u32 s43, s43, s45
    s_mul_i32 s43, s43, 1152
    s_lshl_b32 s40, s23, 12
    s_mul_i32 s41, s23, 3072
    s_add_u32 s41, s41, 16384
    s_lshl_b32 s46, s30, 2
    s_add_u32 s46, s46, s31
    s_mul_i32 s47, s46, 7282
    s_lshr_b32 s47, s47, 16
    s_mul_i32 s47, s47, 9
    s_sub_u32 s46, s46, s47
    s_lshl_b32 s47, s46, 7
    s_add_u32 s42, s42, s47
    s_add_u32 s43, s43, s47
    s_waitcnt lgkmcnt(0)
    s_mov_b32 s4, s64
    s_mov_b32 s5, s65
    s_mov_b32 s6, 0x240000
    s_mov_b32 s7, 0x00020000
    s_cmp_ge_u32 s23, 2
    s_cselect_b32 s8, s72, s70
    s_cselect_b32 s9, s73, s71
    s_mov_b32 s10, 663552
    s_mov_b32 s11, 0x00020000
    s_add_u32 m0, s26, s40
    s_add_u32 s45, s26, s41
    buffer_load_dwordx4 v10, s[4:7], s42 offen offset:0 lds
    buffer_load_dwordx4 v11, s[4:7], s42 offen offset:1024 lds
    s_add_u32 m0, m0, 2048
    s_nop 0
    buffer_load_dwordx4 v12, s[4:7], s42 offen offset:0 lds
    buffer_load_dwordx4 v13, s[4:7], s42 offen offset:1024 lds
    s_mov_b32 m0, s45
    s_add_u32 s42, s42, 128
    buffer_load_dwordx4 v14, s[8:11], s43 offen offset:0 lds
    buffer_load_dwordx4 v15, s[8:11], s43 offen offset:1024 lds
    buffer_load_dwordx4 v16, s[8:11], s43 offen offset:2048 lds
    s_add_u32 s43, s43, 128
    s_add_u32 s46, s46, 1
    s_cmp_eq_u32 s46, 9
    s_cselect_b32 s47, 1152, 0
    s_sub_u32 s42, s42, s47
    s_sub_u32 s43, s43, s47
    s_add_u32 s26, s26, 28672
    s_cmp_eq_u32 s26, 143360
    s_cselect_b32 s26, 0, s26
    s_add_u32 m0, s26, s40
    s_add_u32 s45, s26, s41
    buffer_load_dwordx4 v10, s[4:7], s42 offen offset:0 lds
    buffer_load_dwordx4 v11, s[4:7], s42 offen offset:1024 lds
    s_add_u32 m0, m0, 2048
    s_nop 0
    buffer_load_dwordx4 v12, s[4:7], s42 offen offset:0 lds
    buffer_load_dwordx4 v13, s[4:7], s42 offen offset:1024 lds
    s_mov_b32 m0, s45
    s_add_u32 s42, s42, 128
    buffer_load_dwordx4 v14, s[8:11], s43 offen offset:0 lds
    buffer_load_dwordx4 v15, s[8:11], s43 offen offset:1024 lds
    buffer_load_dwordx4 v16, s[8:11], s43 offen offset:2048 lds
    s_add_u32 s43, s43, 128
    s_add_u32 s46, s46, 1
    s_cmp_eq_u32 s46, 9
    s_cselect_b32 s47, 1152, 0
    s_sub_u32 s42, s42, s47
    s_sub_u32 s43, s43, s47
    s_add_u32 s26, s26, 28672
    s_cmp_eq_u32 s26, 143360
    s_cselect_b32 s26, 0, s26
    s_lshl_b32 s3, s22, 3
    s_mov_b32 s32, 0x206090c
    s_mov_b32 s33, 0xf121518
    s_lshr_b64 s[32:33], s[32:33], s3
    s_and_b32 s32, s32, 0xff
    s_add_u32 s32, s32, s21
    s_cmp_ge_u32 s32, 27
    s_cselect_b32 s3, 27, 0
    s_sub_u32 s32, s32, s3
    s_mul_i32 s3, s22, 27
    s_add_u32 s3, s3, s32
    s_mul_i32 s32, s3, 43691
    s_lshr_b32 s32, s32, 18
    s_mul_i32 s33, s32, 6
    s_sub_u32 s33, s3, s33
    s_lshr_b32 s34, s22, 1
    s_and_b32 s3, s22, 1
    s_lshl_b32 s3, s3, 3
    s_lshr_b32 s35, s21, 2
    s_add_u32 s35, s35, s3
    s_and_b32 s36, s21, 3
    s_cmp_ge_u32 s34, 2
    s_cselect_b32 s38, 4, 5
    s_add_u32 s37, s38, 18
    s_mul_i32 s39, s34, 5
    s_cmp_eq_u32 s34, 3
    s_cselect_b32 s39, 14, s39
    v_lshrrev_b32 v3, 4, v2
    v_and_b32 v4, 15, v2
    v_lshlrev_b32 v6, 1, v3
    v_xor_b32 v7, v4, v6
    v_xor_b32 v8, 8, v7
    s_movk_i32 s44, 9216
    v_mul_lo_u32 v5, v3, s44
    v_lshl_add_u32 v20, v7, 4, v5
    v_lshl_add_u32 v21, v8, 4, v5
    v_add_u32 v22, 0x11800, v20
    v_add_u32 v23, 0x1a400, v21
    v_add_u32 v21, 0x8c00, v21
    s_movk_i32 s44, 4096
    v_mul_lo_u32 v5, v3, s44
    v_lshl_add_u32 v24, v7, 4, v5
    v_lshl_add_u32 v25, v8, 4, v5
    v_add_u32 v26, 0x7800, v24
    v_add_u32 v27, 0xb400, v25
    v_add_u32 v25, 0x3c00, v25
    v_lshlrev_b32 v28, 4, v2
    v_lshrrev_b32 v5, 3, v2
    v_cmp_eq_u32 vcc, 3, v5
    v_add_u32 v5, 0x3000080, v28
    s_nop 0
    v_cndmask_b32 v28, v28, v5, vcc
    v_lshrrev_b32 v3, 3, v2
    v_and_b32 v4, 7, v2
    v_xor_b32 v4, v4, v3
    s_movk_i32 s44, 1152
    v_mul_lo_u32 v5, v3, s44
    v_lshl_add_u32 v30, v4, 4, v5
    v_add_u32 v31, 0x2000, v30
    v_add_u32 v32, 0x4000, v30
    v_add_u32 v33, 0x6000, v30
    s_mul_i32 s48, s23, 147456
    s_lshl_b32 s44, s32, 8
    s_add_u32 s48, s48, s44
    s_mul_i32 s49, s33, 12
    s_mul_i32 s44, s23, 3
    s_add_u32 s49, s49, s44
    s_lshl_b32 s49, s49, 10
    s_mov_b32 s50, 0
    s_mov_b32 s51, 0
    s_mov_b32 s56, 0x75436210
    s_mov_b32 s57, 0xfedba9c8
    s_cmp_eq_u32 s33, 1
    s_cselect_b32 s56, 0x65473210, s56
    s_cselect_b32 s57, 0xfecbad98, s57
    s_cmp_eq_u32 s33, 2
    s_cselect_b32 s56, 0x65843210, s56
    s_cselect_b32 s57, 0xfdcbea97, s57
    s_cmp_eq_u32 s33, 3
    s_cselect_b32 s56, 0x69542103, s56
    s_cselect_b32 s57, 0xedcfba87, s57
    s_cmp_eq_u32 s33, 4
    s_cselect_b32 s56, 0xa6532140, s56
    s_cselect_b32 s57, 0xfedcb987, s57
    s_cmp_eq_u32 s33, 5
    s_cselect_b32 s56, 0x76432510, s56
    s_cselect_b32 s57, 0xfedca98b, s57
    s_add_u32 m0, s26, s40
    s_add_u32 s45, s26, s41
    buffer_load_dwordx4 v10, s[4:7], s42 offen offset:0 lds
    buffer_load_dwordx4 v11, s[4:7], s42 offen offset:1024 lds
    s_add_u32 m0, m0, 2048
    s_nop 0
    buffer_load_dwordx4 v12, s[4:7], s42 offen offset:0 lds
    buffer_load_dwordx4 v13, s[4:7], s42 offen offset:1024 lds
    s_mov_b32 m0, s45
    s_add_u32 s42, s42, 128
    buffer_load_dwordx4 v14, s[8:11], s43 offen offset:0 lds
    buffer_load_dwordx4 v15, s[8:11], s43 offen offset:1024 lds
    buffer_load_dwordx4 v16, s[8:11], s43 offen offset:2048 lds
    s_add_u32 s43, s43, 128
    s_add_u32 s46, s46, 1
    s_cmp_eq_u32 s46, 9
    s_cselect_b32 s47, 1152, 0
    s_sub_u32 s42, s42, s47
    s_sub_u32 s43, s43, s47
    s_add_u32 s26, s26, 28672
    s_cmp_eq_u32 s26, 143360
    s_cselect_b32 s26, 0, s26
    s_add_u32 m0, s26, s40
    s_add_u32 s45, s26, s41
    s_waitcnt vmcnt(14)
    s_barrier
    buffer_load_dwordx4 v10, s[4:7], s42 offen offset:0 lds
    buffer_load_dwordx4 v11, s[4:7], s42 offen offset:1024 lds
    s_add_u32 m0, m0, 2048
    s_nop 0
    buffer_load_dwordx4 v12, s[4:7], s42 offen offset:0 lds
    buffer_load_dwordx4 v13, s[4:7], s42 offen offset:1024 lds
    s_mov_b32 m0, s45
    s_add_u32 s42, s42, 128
    buffer_load_dwordx4 v14, s[8:11], s43 offen offset:0 lds
    buffer_load_dwordx4 v15, s[8:11], s43 offen offset:1024 lds
    buffer_load_dwordx4 v16, s[8:11], s43 offen offset:2048 lds
    s_add_u32 s43, s43, 128
    s_add_u32 s46, s46, 1
    s_cmp_eq_u32 s46, 9
    s_cselect_b32 s47, 1152, 0
    s_sub_u32 s42, s42, s47
    s_sub_u32 s43, s43, s47
    s_add_u32 s26, s26, 28672
    s_cmp_eq_u32 s26, 143360
    s_cselect_b32 s26, 0, s26
    s_add_u32 m0, s26, s40
    s_add_u32 s45, s26, s41
    s_waitcnt vmcnt(14)
    s_barrier
    buffer_load_dwordx4 v10, s[4:7], s42 offen offset:0 lds
    buffer_load_dwordx4 v11, s[4:7], s42 offen offset:1024 lds
    s_add_u32 m0, m0, 2048
    s_nop 0
    buffer_load_dwordx4 v12, s[4:7], s42 offen offset:0 lds
    buffer_load_dwordx4 v13, s[4:7], s42 offen offset:1024 lds
    s_mov_b32 m0, s45
    s_add_u32 s42, s42, 128
    buffer_load_dwordx4 v14, s[8:11], s43 offen offset:0 lds
    buffer_load_dwordx4 v15, s[8:11], s43 offen offset:1024 lds
    buffer_load_dwordx4 v16, s[8:11], s43 offen offset:2048 lds
    s_add_u32 s43, s43, 128
    s_add_u32 s46, s46, 1
    s_cmp_eq_u32 s46, 9
    s_cselect_b32 s47, 1152, 0
    s_sub_u32 s42, s42, s47
    s_sub_u32 s43, s43, s47
    s_add_u32 s26, s26, 28672
    s_cmp_eq_u32 s26, 143360
    s_cselect_b32 s26, 0, s26
    s_mov_b32 s27, 4
l1_loop:
    s_add_u32 m0, s26, s40
    s_add_u32 s45, s26, s41
    s_waitcnt vmcnt(14)
    s_barrier
    buffer_load_dwordx4 v10, s[4:7], s42 offen offset:0 lds
    buffer_load_dwordx4 v11, s[4:7], s42 offen offset:1024 lds
    s_add_u32 m0, m0, 2048
    s_nop 0
    buffer_load_dwordx4 v12, s[4:7], s42 offen offset:0 lds
    buffer_load_dwordx4 v13, s[4:7], s42 offen offset:1024 lds
    s_mov_b32 m0, s45
    s_add_u32 s42, s42, 128
    buffer_load_dwordx4 v14, s[8:11], s43 offen offset:0 lds
    buffer_load_dwordx4 v15, s[8:11], s43 offen offset:1024 lds
    buffer_load_dwordx4 v16, s[8:11], s43 offen offset:2048 lds
    s_add_u32 s43, s43, 128
    s_add_u32 s46, s46, 1
    s_cmp_eq_u32 s46, 9
    s_cselect_b32 s47, 1152, 0
    s_sub_u32 s42, s42, s47
    s_sub_u32 s43, s43, s47
    s_add_u32 s26, s26, 28672
    s_cmp_eq_u32 s26, 143360
    s_cselect_b32 s26, 0, s26
    s_sub_u32 s27, s27, 1
    s_cmp_lg_u32 s27, 0
    s_cbranch_scc1 l1_loop
    s_cmp_ge_u32 s21, 27
    s_cbranch_scc1 l1_c
    s_mov_b32 s4, s84
    s_mov_b32 s5, s85
    s_mov_b32 s6, 0x1200000
    s_mov_b32 s7, 0x00020000
    s_mov_b32 s8, s96
    s_mov_b32 s9, s97
    s_mov_b32 s10, 0x3240080
    s_mov_b32 s11, 0x00020000
    s_and_b32 s44, s56, 15
    s_lshl_b32 s44, s44, 1
    s_mul_i32 s42, s44, 589824
    s_add_u32 s42, s42, s48
    s_mul_i32 s43, s44, 73728
    s_add_u32 s43, s43, s49
    s_add_u32 m0, s26, s40
    s_nop 0
    s_waitcnt vmcnt(14)
    s_barrier
    buffer_load_dwordx4 v20, s[4:7], s42 offen offset:0 lds
    buffer_load_dwordx4 v21, s[4:7], s42 offen offset:1024 lds
    buffer_load_dwordx4 v22, s[4:7], s42 offen offset:2048 lds
    buffer_load_dwordx4 v23, s[4:7], s42 offen offset:3072 lds
    s_and_b32 s44, s56, 15
    s_lshl_b32 s44, s44, 1
    s_mul_i32 s42, s44, 589824
    s_add_u32 s42, s42, s48
    s_mul_i32 s43, s44, 73728
    s_add_u32 s43, s43, s49
    s_add_u32 m0, s26, s41
    s_nop 0
    s_waitcnt vmcnt(11)
    s_barrier
    buffer_load_dwordx4 v28, s[8:11], s43 offen offset:0 sc1 lds
    buffer_load_dwordx4 v28, s[8:11], s43 offen offset:1024 sc1 lds
    buffer_load_dwordx4 v28, s[8:11], s43 offen offset:2048 sc1 lds
    s_add_u32 s50, s50, 1
    s_add_u32 s51, s51, 1
    s_cmp_eq_u32 s51, 6
    s_cselect_b32 s51, 0, s51
    s_add_u32 s26, s26, 28672
    s_cmp_eq_u32 s26, 143360
    s_cselect_b32 s26, 0, s26
    s_and_b32 s44, s56, 15
    s_lshl_b32 s44, s44, 1
    s_add_u32 s44, s44, 1
    s_mul_i32 s42, s44, 589824
    s_add_u32 s42, s42, s48
    s_mul_i32 s43, s44, 73728
    s_add_u32 s43, s43, s49
    s_add_u32 m0, s26, s40
    s_nop 0
    s_waitcnt vmcnt(7)
    s_barrier
    buffer_load_dwordx4 v20, s[4:7], s42 offen offset:0 lds
    buffer_load_dwordx4 v21, s[4:7], s42 offen offset:1024 lds
    buffer_load_dwordx4 v22, s[4:7], s42 offen offset:2048 lds
    buffer_load_dwordx4 v23, s[4:7], s42 offen offset:3072 lds
    s_add_u32 m0, s26, s41
    s_nop 0
    buffer_load_dwordx4 v28, s[8:11], s43 offen offset:0 sc1 lds
    buffer_load_dwordx4 v28, s[8:11], s43 offen offset:1024 sc1 lds
    buffer_load_dwordx4 v28, s[8:11], s43 offen offset:2048 sc1 lds
    s_lshr_b64 s[56:57], s[56:57], 4
    s_add_u32 s50, s50, 1
    s_add_u32 s51, s51, 1
    s_cmp_eq_u32 s51, 6
    s_cselect_b32 s51, 0, s51
    s_add_u32 s26, s26, 28672
    s_cmp_eq_u32 s26, 143360
    s_cselect_b32 s26, 0, s26
    s_and_b32 s44, s56, 15
    s_lshl_b32 s44, s44, 1
    s_mul_i32 s42, s44, 589824
    s_add_u32 s42, s42, s48
    s_mul_i32 s43, s44, 73728
    s_add_u32 s43, s43, s49
    s_add_u32 m0, s26, s41
    s_nop 0
    buffer_load_dwordx4 v28, s[8:11], s43 offen offset:0 sc1 lds
    buffer_load_dwordx4 v28, s[8:11], s43 offen offset:1024 sc1 lds
    buffer_load_dwordx4 v28, s[8:11], s43 offen offset:2048 sc1 lds
    s_add_u32 m0, s26, s40
    s_nop 0
    buffer_load_dwordx4 v20, s[4:7], s42 offen offset:0 lds
    buffer_load_dwordx4 v21, s[4:7], s42 offen offset:1024 lds
    buffer_load_dwordx4 v22, s[4:7], s42 offen offset:2048 lds
    buffer_load_dwordx4 v23, s[4:7], s42 offen offset:3072 lds
    s_add_u32 s50, s50, 1
    s_add_u32 s51, s51, 1
    s_cmp_eq_u32 s51, 6
    s_cselect_b32 s51, 0, s51
    s_add_u32 s26, s26, 28672
    s_cmp_eq_u32 s26, 143360
    s_cselect_b32 s26, 0, s26
    s_lshl_b32 s52, s23, 16
    s_lshl_b32 s44, s35, 8
    s_add_u32 s52, s52, s44
    s_mul_i32 s53, s36, 165888
    s_mul_i32 s54, s36, 18432
    s_mul_i32 s44, s34, 1327104
    s_add_u32 s54, s54, s44
    s_mov_b32 s55, s39
    s_add_u32 s46, s36, s35
    s_and_b32 s46, s46, 3
    s_lshl_b32 s47, s23, 10
    s_add_u32 s47, s47, 32768
    s_add_u32 s29, s40, 16384
    s_and_b32 s44, s56, 15
    s_lshl_b32 s44, s44, 1
    s_add_u32 s44, s44, 1
    s_mul_i32 s42, s44, 589824
    s_add_u32 s42, s42, s48
    s_mul_i32 s43, s44, 73728
    s_add_u32 s43, s43, s49
    s_add_u32 m0, s26, s40
    s_nop 0
    s_waitcnt vmcnt(14)
    s_barrier
    buffer_load_dwordx4 v20, s[4:7], s42 offen offset:0 lds
    buffer_load_dwordx4 v21, s[4:7], s42 offen offset:1024 lds
    buffer_load_dwordx4 v22, s[4:7], s42 offen offset:2048 lds
    buffer_load_dwordx4 v23, s[4:7], s42 offen offset:3072 lds
    s_add_u32 m0, s26, s41
    s_nop 0
    buffer_load_dwordx4 v28, s[8:11], s43 offen offset:0 sc1 lds
    buffer_load_dwordx4 v28, s[8:11], s43 offen offset:1024 sc1 lds
    buffer_load_dwordx4 v28, s[8:11], s43 offen offset:2048 sc1 lds
    s_lshr_b64 s[56:57], s[56:57], 4
    s_add_u32 s50, s50, 1
    s_add_u32 s51, s51, 1
    s_cmp_eq_u32 s51, 6
    s_cselect_b32 s51, 0, s51
    s_add_u32 s26, s26, 28672
    s_cmp_eq_u32 s26, 143360
    s_cselect_b32 s26, 0, s26
    s_and_b32 s44, s56, 15
    s_lshl_b32 s44, s44, 1
    s_mul_i32 s42, s44, 589824
    s_add_u32 s42, s42, s48
    s_mul_i32 s43, s44, 73728
    s_add_u32 s43, s43, s49
    s_add_u32 m0, s26, s41
    s_nop 0
    s_waitcnt vmcnt(14)
    s_barrier
    buffer_load_dwordx4 v28, s[8:11], s43 offen offset:0 sc1 lds
    buffer_load_dwordx4 v28, s[8:11], s43 offen offset:1024 sc1 lds
    buffer_load_dwordx4 v28, s[8:11], s43 offen offset:2048 sc1 lds
    s_add_u32 m0, s26, s40
    s_nop 0
    buffer_load_dwordx4 v20, s[4:7], s42 offen offset:0 lds
    buffer_load_dwordx4 v21, s[4:7], s42 offen offset:1024 lds
    buffer_load_dwordx4 v22, s[4:7], s42 offen offset:2048 lds
    buffer_load_dwordx4 v23, s[4:7], s42 offen offset:3072 lds
    s_add_u32 s50, s50, 1
    s_add_u32 s51, s51, 1
    s_cmp_eq_u32 s51, 6
    s_cselect_b32 s51, 0, s51
    s_add_u32 s26, s26, 28672
    s_cmp_eq_u32 s26, 143360
    s_cselect_b32 s26, 0, s26
    s_branch l2_main
l1_c:
    s_waitcnt vmcnt(14)
    s_barrier
    s_waitcnt vmcnt(7)
    s_barrier
    s_waitcnt vmcnt(0)
    s_barrier
    v_mov_b32 v41, 163776
    ds_read_b64 v[250:251], v41
    s_add_u32 s16, s96, 0x1910000
    s_addc_u32 s17, s97, 0
    s_mov_b32 s18, 0x10000
    s_mov_b32 s19, 0x00020000
    s_add_u32 s12, s96, 0x1900000
    s_addc_u32 s13, s97, 0
    s_mov_b32 s14, 0x6000
    s_mov_b32 s15, 0x00020000
    s_waitcnt lgkmcnt(0)
    s_barrier
    s_branch scan_entry
l2_entry:
    s_sub_u32 s23, s20, 4
    s_lshl_b32 s40, s23, 12
    s_mul_i32 s41, s23, 3072
    s_add_u32 s41, s41, 16384
    v_lshrrev_b32 v3, 4, v2
    v_and_b32 v4, 15, v2
    v_lshlrev_b32 v6, 1, v3
    v_xor_b32 v7, v4, v6
    v_xor_b32 v8, 8, v7
    s_movk_i32 s44, 9216
    v_mul_lo_u32 v5, v3, s44
    v_lshl_add_u32 v20, v7, 4, v5
    v_lshl_add_u32 v21, v8, 4, v5
    v_add_u32 v22, 0x11800, v20
    v_add_u32 v23, 0x1a400, v21
    v_add_u32 v21, 0x8c00, v21
    s_movk_i32 s44, 4096
    v_mul_lo_u32 v5, v3, s44
    v_lshl_add_u32 v24, v7, 4, v5
    v_lshl_add_u32 v25, v8, 4, v5
    v_add_u32 v26, 0x7800, v24
    v_add_u32 v27, 0xb400, v25
    v_add_u32 v25, 0x3c00, v25
    v_lshlrev_b32 v28, 4, v2
    v_lshrrev_b32 v5, 3, v2
    v_cmp_eq_u32 vcc, 3, v5
    v_add_u32 v5, 0x3000080, v28
    s_nop 0
    v_cndmask_b32 v28, v28, v5, vcc
    v_lshrrev_b32 v3, 3, v2
    v_and_b32 v4, 7, v2
    v_xor_b32 v4, v4, v3
    s_movk_i32 s44, 1152
    v_mul_lo_u32 v5, v3, s44
    v_lshl_add_u32 v30, v4, 4, v5
    v_add_u32 v31, 0x2000, v30
    v_add_u32 v32, 0x4000, v30
    v_add_u32 v33, 0x6000, v30
    s_mul_i32 s48, s23, 147456
    s_lshl_b32 s44, s32, 8
    s_add_u32 s48, s48, s44
    s_mul_i32 s49, s33, 12
    s_mul_i32 s44, s23, 3
    s_add_u32 s49, s49, s44
    s_lshl_b32 s49, s49, 10
    s_mov_b32 s50, 0
    s_mov_b32 s51, 0
    s_mov_b32 s56, 0x75436210
    s_mov_b32 s57, 0xfedba9c8
    s_cmp_eq_u32 s33, 1
    s_cselect_b32 s56, 0x65473210, s56
    s_cselect_b32 s57, 0xfecbad98, s57
    s_cmp_eq_u32 s33, 2
    s_cselect_b32 s56, 0x65843210, s56
    s_cselect_b32 s57, 0xfdcbea97, s57
    s_cmp_eq_u32 s33, 3
    s_cselect_b32 s56, 0x69542103, s56
    s_cselect_b32 s57, 0xedcfba87, s57
    s_cmp_eq_u32 s33, 4
    s_cselect_b32 s56, 0xa6532140, s56
    s_cselect_b32 s57, 0xfedcb987, s57
    s_cmp_eq_u32 s33, 5
    s_cselect_b32 s56, 0x76432510, s56
    s_cselect_b32 s57, 0xfedca98b, s57
    s_mov_b32 s4, s84
    s_mov_b32 s5, s85
    s_mov_b32 s6, 0x1200000
    s_mov_b32 s7, 0x00020000
    s_mov_b32 s8, s96
    s_mov_b32 s9, s97
    s_mov_b32 s10, 0x3240080
    s_mov_b32 s11, 0x00020000
    s_mov_b32 s62, s26
    s_waitcnt vmcnt(0)
    s_and_b32 s44, s56, 15
    s_lshl_b32 s44, s44, 1
    s_mul_i32 s42, s44, 589824
    s_add_u32 s42, s42, s48
    s_mul_i32 s43, s44, 73728
    s_add_u32 s43, s43, s49
    s_add_u32 m0, s26, s40
    s_nop 0
    buffer_load_dwordx4 v20, s[4:7], s42 offen offset:0 lds
    buffer_load_dwordx4 v21, s[4:7], s42 offen offset:1024 lds
    buffer_load_dwordx4 v22, s[4:7], s42 offen offset:2048 lds
    buffer_load_dwordx4 v23, s[4:7], s42 offen offset:3072 lds
    s_add_u32 s50, s50, 1
    s_add_u32 s51, s51, 1
    s_cmp_eq_u32 s51, 6
    s_cselect_b32 s51, 0, s51
    s_add_u32 s26, s26, 28672
    s_cmp_eq_u32 s26, 143360
    s_cselect_b32 s26, 0, s26
    s_and_b32 s44, s56, 15
    s_lshl_b32 s44, s44, 1
    s_add_u32 s44, s44, 1
    s_mul_i32 s42, s44, 589824
    s_add_u32 s42, s42, s48
    s_mul_i32 s43, s44, 73728
    s_add_u32 s43, s43, s49
    s_add_u32 m0, s26, s40
    s_nop 0
    buffer_load_dwordx4 v20, s[4:7], s42 offen offset:0 lds
    buffer_load_dwordx4 v21, s[4:7], s42 offen offset:1024 lds
    buffer_load_dwordx4 v22, s[4:7], s42 offen offset:2048 lds
    buffer_load_dwordx4 v23, s[4:7], s42 offen offset:3072 lds
    s_lshr_b64 s[56:57], s[56:57], 4
    s_add_u32 s50, s50, 1
    s_add_u32 s51, s51, 1
    s_cmp_eq_u32 s51, 6
    s_cselect_b32 s51, 0, s51
    s_add_u32 s26, s26, 28672
    s_cmp_eq_u32 s26, 143360
    s_cselect_b32 s26, 0, s26
    s_and_b32 s44, s56, 15
    s_lshl_b32 s44, s44, 1
    s_mul_i32 s42, s44, 589824
    s_add_u32 s42, s42, s48
    s_mul_i32 s43, s44, 73728
    s_add_u32 s43, s43, s49
    s_add_u32 m0, s26, s40
    s_nop 0
    buffer_load_dwordx4 v20, s[4:7], s42 offen offset:0 lds
    buffer_load_dwordx4 v21, s[4:7], s42 offen offset:1024 lds
    buffer_load_dwordx4 v22, s[4:7], s42 offen offset:2048 lds
    buffer_load_dwordx4 v23, s[4:7], s42 offen offset:3072 lds
    s_add_u32 s50, s50, 1
    s_add_u32 s51, s51, 1
    s_cmp_eq_u32 s51, 6
    s_cselect_b32 s51, 0, s51
    s_add_u32 s26, s26, 28672
    s_cmp_eq_u32 s26, 143360
    s_cselect_b32 s26, 0, s26
    s_mov_b32 s26, s62
    s_mov_b32 s50, 0
    s_mov_b32 s51, 0
    s_mov_b32 s56, 0x75436210
    s_mov_b32 s57, 0xfedba9c8
    s_cmp_eq_u32 s33, 1
    s_cselect_b32 s56, 0x65473210, s56
    s_cselect_b32 s57, 0xfecbad98, s57
    s_cmp_eq_u32 s33, 2
    s_cselect_b32 s56, 0x65843210, s56
    s_cselect_b32 s57, 0xfdcbea97, s57
    s_cmp_eq_u32 s33, 3
    s_cselect_b32 s56, 0x69542103, s56
    s_cselect_b32 s57, 0xedcfba87, s57
    s_cmp_eq_u32 s33, 4
    s_cselect_b32 s56, 0xa6532140, s56
    s_cselect_b32 s57, 0xfedcb987, s57
    s_cmp_eq_u32 s33, 5
    s_cselect_b32 s56, 0x76432510, s56
    s_cselect_b32 s57, 0xfedca98b, s57
    s_lshl_b32 s52, s23, 16
    s_lshl_b32 s44, s35, 8
    s_add_u32 s52, s52, s44
    s_mul_i32 s53, s36, 165888
    s_mul_i32 s54, s36, 18432
    s_mul_i32 s44, s34, 1327104
    s_add_u32 s54, s54, s44
    s_mov_b32 s55, s39
    s_add_u32 s46, s36, s35
    s_and_b32 s46, s46, 3
    s_lshl_b32 s47, s23, 10
    s_add_u32 s47, s47, 32768
    s_add_u32 s29, s40, 16384
    s_barrier
    s_and_b32 s44, s56, 15
    s_lshl_b32 s44, s44, 1
    s_mul_i32 s42, s44, 589824
    s_add_u32 s42, s42, s48
    s_mul_i32 s43, s44, 73728
    s_add_u32 s43, s43, s49
    s_add_u32 m0, s26, s41
    s_nop 0
    buffer_load_dwordx4 v28, s[8:11], s43 offen offset:0 sc1 lds
    buffer_load_dwordx4 v28, s[8:11], s43 offen offset:1024 sc1 lds
    buffer_load_dwordx4 v28, s[8:11], s43 offen offset:2048 sc1 lds
    s_add_u32 s50, s50, 1
    s_add_u32 s51, s51, 1
    s_cmp_eq_u32 s51, 6
    s_cselect_b32 s51, 0, s51
    s_add_u32 s26, s26, 28672
    s_cmp_eq_u32 s26, 143360
    s_cselect_b32 s26, 0, s26
    s_and_b32 s44, s56, 15
    s_lshl_b32 s44, s44, 1
    s_add_u32 s44, s44, 1
    s_mul_i32 s42, s44, 589824
    s_add_u32 s42, s42, s48
    s_mul_i32 s43, s44, 73728
    s_add_u32 s43, s43, s49
    s_add_u32 m0, s26, s41
    s_nop 0
    buffer_load_dwordx4 v28, s[8:11], s43 offen offset:0 sc1 lds
    buffer_load_dwordx4 v28, s[8:11], s43 offen offset:1024 sc1 lds
    buffer_load_dwordx4 v28, s[8:11], s43 offen offset:2048 sc1 lds
    s_lshr_b64 s[56:57], s[56:57], 4
    s_add_u32 s50, s50, 1
    s_add_u32 s51, s51, 1
    s_cmp_eq_u32 s51, 6
    s_cselect_b32 s51, 0, s51
    s_add_u32 s26, s26, 28672
    s_cmp_eq_u32 s26, 143360
    s_cselect_b32 s26, 0, s26
    s_and_b32 s44, s56, 15
    s_lshl_b32 s44, s44, 1
    s_mul_i32 s42, s44, 589824
    s_add_u32 s42, s42, s48
    s_mul_i32 s43, s44, 73728
    s_add_u32 s43, s43, s49
    s_add_u32 m0, s26, s41
    s_nop 0
    buffer_load_dwordx4 v28, s[8:11], s43 offen offset:0 sc1 lds
    buffer_load_dwordx4 v28, s[8:11], s43 offen offset:1024 sc1 lds
    buffer_load_dwordx4 v28, s[8:11], s43 offen offset:2048 sc1 lds
    s_add_u32 s50, s50, 1
    s_add_u32 s51, s51, 1
    s_cmp_eq_u32 s51, 6
    s_cselect_b32 s51, 0, s51
    s_add_u32 s26, s26, 28672
    s_cmp_eq_u32 s26, 143360
    s_cselect_b32 s26, 0, s26
    s_and_b32 s44, s56, 15
    s_lshl_b32 s44, s44, 1
    s_add_u32 s44, s44, 1
    s_mul_i32 s42, s44, 589824
    s_add_u32 s42, s42, s48
    s_mul_i32 s43, s44, 73728
    s_add_u32 s43, s43, s49
    s_add_u32 m0, s26, s40
    s_nop 0
    s_waitcnt vmcnt(6)
    s_barrier
    buffer_load_dwordx4 v20, s[4:7], s42 offen offset:0 lds
    buffer_load_dwordx4 v21, s[4:7], s42 offen offset:1024 lds
    buffer_load_dwordx4 v22, s[4:7], s42 offen offset:2048 lds
    buffer_load_dwordx4 v23, s[4:7], s42 offen offset:3072 lds
    s_add_u32 m0, s26, s41
    s_nop 0
    buffer_load_dwordx4 v28, s[8:11], s43 offen offset:0 sc1 lds
    buffer_load_dwordx4 v28, s[8:11], s43 offen offset:1024 sc1 lds
    buffer_load_dwordx4 v28, s[8:11], s43 offen offset:2048 sc1 lds
    s_lshr_b64 s[56:57], s[56:57], 4
    s_add_u32 s50, s50, 1
    s_add_u32 s51, s51, 1
    s_cmp_eq_u32 s51, 6
    s_cselect_b32 s51, 0, s51
    s_add_u32 s26, s26, 28672
    s_cmp_eq_u32 s26, 143360
    s_cselect_b32 s26, 0, s26
    s_and_b32 s44, s56, 15
    s_lshl_b32 s44, s44, 1
    s_mul_i32 s42, s44, 589824
    s_add_u32 s42, s42, s48
    s_mul_i32 s43, s44, 73728
    s_add_u32 s43, s43, s49
    s_add_u32 m0, s26, s41
    s_nop 0
    s_waitcnt vmcnt(10)
    s_barrier
    buffer_load_dwordx4 v28, s[8:11], s43 offen offset:0 sc1 lds
    buffer_load_dwordx4 v28, s[8:11], s43 offen offset:1024 sc1 lds
    buffer_load_dwordx4 v28, s[8:11], s43 offen offset:2048 sc1 lds
    s_add_u32 m0, s26, s40
    s_nop 0
    buffer_load_dwordx4 v20, s[4:7], s42 offen offset:0 lds
    buffer_load_dwordx4 v21, s[4:7], s42 offen offset:1024 lds
    buffer_load_dwordx4 v22, s[4:7], s42 offen offset:2048 lds
    buffer_load_dwordx4 v23, s[4:7], s42 offen offset:3072 lds
    s_add_u32 s50, s50, 1
    s_add_u32 s51, s51, 1
    s_cmp_eq_u32 s51, 6
    s_cselect_b32 s51, 0, s51
    s_add_u32 s26, s26, 28672
    s_cmp_eq_u32 s26, 143360
    s_cselect_b32 s26, 0, s26
l2_main:
    s_and_b32 s44, s56, 15
    s_lshl_b32 s44, s44, 1
    s_add_u32 s44, s44, 1
    s_mul_i32 s42, s44, 589824
    s_add_u32 s42, s42, s48
    s_mul_i32 s43, s44, 73728
    s_add_u32 s43, s43, s49
    s_add_u32 m0, s26, s40
    s_nop 0
    s_waitcnt vmcnt(14)
    s_barrier
    buffer_load_dwordx4 v20, s[4:7], s42 offen offset:0 lds
    buffer_load_dwordx4 v21, s[4:7], s42 offen offset:1024 lds
    buffer_load_dwordx4 v22, s[4:7], s42 offen offset:2048 lds
    buffer_load_dwordx4 v23, s[4:7], s42 offen offset:3072 lds
    s_add_u32 m0, s26, s41
    s_nop 0
    buffer_load_dwordx4 v28, s[8:11], s43 offen offset:0 sc1 lds
    buffer_load_dwordx4 v28, s[8:11], s43 offen offset:1024 sc1 lds
    buffer_load_dwordx4 v28, s[8:11], s43 offen offset:2048 sc1 lds
    s_lshr_b64 s[56:57], s[56:57], 4
    s_add_u32 s50, s50, 1
    s_add_u32 s51, s51, 1
    s_cmp_eq_u32 s51, 6
    s_cselect_b32 s51, 0, s51
    s_add_u32 s26, s26, 28672
    s_cmp_eq_u32 s26, 143360
    s_cselect_b32 s26, 0, s26
    s_mov_b32 s27, 12
l2_loop:
    s_and_b32 s44, s56, 15
    s_lshl_b32 s44, s44, 1
    s_mul_i32 s42, s44, 589824
    s_add_u32 s42, s42, s48
    s_mul_i32 s43, s44, 73728
    s_add_u32 s43, s43, s49
    s_add_u32 m0, s26, s41
    s_nop 0
    s_waitcnt vmcnt(14)
    s_barrier
    buffer_load_dwordx4 v28, s[8:11], s43 offen offset:0 sc1 lds
    buffer_load_dwordx4 v28, s[8:11], s43 offen offset:1024 sc1 lds
    buffer_load_dwordx4 v28, s[8:11], s43 offen offset:2048 sc1 lds
    s_add_u32 m0, s26, s40
    s_nop 0
    buffer_load_dwordx4 v20, s[4:7], s42 offen offset:0 lds
    buffer_load_dwordx4 v21, s[4:7], s42 offen offset:1024 lds
    buffer_load_dwordx4 v22, s[4:7], s42 offen offset:2048 lds
    buffer_load_dwordx4 v23, s[4:7], s42 offen offset:3072 lds
    s_add_u32 s50, s50, 1
    s_add_u32 s51, s51, 1
    s_cmp_eq_u32 s51, 6
    s_cselect_b32 s51, 0, s51
    s_add_u32 s26, s26, 28672
    s_cmp_eq_u32 s26, 143360
    s_cselect_b32 s26, 0, s26
    s_and_b32 s44, s56, 15
    s_lshl_b32 s44, s44, 1
    s_add_u32 s44, s44, 1
    s_mul_i32 s42, s44, 589824
    s_add_u32 s42, s42, s48
    s_mul_i32 s43, s44, 73728
    s_add_u32 s43, s43, s49
    s_add_u32 m0, s26, s40
    s_nop 0
    s_waitcnt vmcnt(14)
    s_barrier
    buffer_load_dwordx4 v20, s[4:7], s42 offen offset:0 lds
    buffer_load_dwordx4 v21, s[4:7], s42 offen offset:1024 lds
    buffer_load_dwordx4 v22, s[4:7], s42 offen offset:2048 lds
    buffer_load_dwordx4 v23, s[4:7], s42 offen offset:3072 lds
    s_add_u32 m0, s26, s41
    s_nop 0
    buffer_load_dwordx4 v28, s[8:11], s43 offen offset:0 sc1 lds
    buffer_load_dwordx4 v28, s[8:11], s43 offen offset:1024 sc1 lds
    buffer_load_dwordx4 v28, s[8:11], s43 offen offset:2048 sc1 lds
    s_lshr_b64 s[56:57], s[56:57], 4
    s_add_u32 s50, s50, 1
    s_add_u32 s51, s51, 1
    s_cmp_eq_u32 s51, 6
    s_cselect_b32 s51, 0, s51
    s_add_u32 s26, s26, 28672
    s_cmp_eq_u32 s26, 143360
    s_cselect_b32 s26, 0, s26
    s_sub_u32 s27, s27, 1
    s_cmp_lg_u32 s27, 0
    s_cbranch_scc1 l2_loop
    v_mov_b32 v41, 163776
    ds_read_b64 v[250:251], v41
    s_add_u32 s16, s96, 0x1910000
    s_addc_u32 s17, s97, 0
    s_mov_b32 s18, 0x10000
    s_mov_b32 s19, 0x00020000
    s_lshr_b32 s60, s35, 1
    s_lshl_b32 s60, s60, 9
    s_add_u32 s60, s60, 16384
    s_lshl_b32 s61, s36, 2
    s_add_u32 s61, s61, s34
    s_lshl_b32 s61, s61, 9
    s_add_u32 s61, s61, 8192
    s_waitcnt lgkmcnt(0)
    s_and_b32 s44, s56, 15
    s_lshl_b32 s44, s44, 1
    s_mul_i32 s42, s44, 589824
    s_add_u32 s42, s42, s48
    s_mul_i32 s43, s44, 73728
    s_add_u32 s43, s43, s49
    s_add_u32 m0, s26, s41
    s_nop 0
    s_waitcnt vmcnt(14)
    s_barrier
    buffer_load_dwordx4 v28, s[8:11], s43 offen offset:0 sc1 lds
    buffer_load_dwordx4 v28, s[8:11], s43 offen offset:1024 sc1 lds
    buffer_load_dwordx4 v28, s[8:11], s43 offen offset:2048 sc1 lds
    s_add_u32 m0, s26, s40
    s_nop 0
    buffer_load_dwordx4 v20, s[4:7], s42 offen offset:0 lds
    buffer_load_dwordx4 v21, s[4:7], s42 offen offset:1024 lds
    buffer_load_dwordx4 v22, s[4:7], s42 offen offset:2048 lds
    buffer_load_dwordx4 v23, s[4:7], s42 offen offset:3072 lds
    s_add_u32 s50, s50, 1
    s_add_u32 s51, s51, 1
    s_cmp_eq_u32 s51, 6
    s_cselect_b32 s51, 0, s51
    s_add_u32 s26, s26, 28672
    s_cmp_eq_u32 s26, 143360
    s_cselect_b32 s26, 0, s26
    s_and_b32 s44, s56, 15
    s_lshl_b32 s44, s44, 1
    s_add_u32 s44, s44, 1
    s_mul_i32 s42, s44, 589824
    s_add_u32 s42, s42, s48
    s_mul_i32 s43, s44, 73728
    s_add_u32 s43, s43, s49
    s_add_u32 m0, s26, s40
    s_nop 0
    s_waitcnt vmcnt(14)
    s_barrier
    buffer_load_dwordx4 v20, s[4:7], s42 offen offset:0 lds
    buffer_load_dwordx4 v21, s[4:7], s42 offen offset:1024 lds
    buffer_load_dwordx4 v22, s[4:7], s42 offen offset:2048 lds
    buffer_load_dwordx4 v23, s[4:7], s42 offen offset:3072 lds
    s_add_u32 m0, s26, s41
    s_nop 0
    buffer_load_dwordx4 v28, s[8:11], s43 offen offset:0 sc1 lds
    buffer_load_dwordx4 v28, s[8:11], s43 offen offset:1024 sc1 lds
    buffer_load_dwordx4 v28, s[8:11], s43 offen offset:2048 sc1 lds
    s_lshr_b64 s[56:57], s[56:57], 4
    s_add_u32 s50, s50, 1
    s_add_u32 s51, s51, 1
    s_cmp_eq_u32 s51, 6
    s_cselect_b32 s51, 0, s51
    s_add_u32 s26, s26, 28672
    s_cmp_eq_u32 s26, 143360
    s_cselect_b32 s26, 0, s26
    v_and_b32 v42, 15, v2
    v_lshrrev_b32 v43, 4, v2
    v_mul_u32_u24 v46, 1152, v42
    v_lshl_add_u32 v46, v43, 3, v46
    v_lshlrev_b32 v47, 1, v46
    v_lshlrev_b32 v43, 3, v43
    v_lshlrev_b32 v45, 3, v42
    v_lshlrev_b32 v42, 1, v42
    s_lshl_b32 s44, s35, 3
    s_lshl_b32 s45, s34, 1
    s_add_u32 s44, s44, s45
    s_mul_i32 s45, s36, 9
    s_add_u32 s45, s45, s23
    s_lshl_b32 s45, s45, 5
    s_mul_i32 s50, s44, 18432
    s_add_u32 s50, s50, s45
    s_add_u32 s51, s50, 18432
    s_lshl_b32 s48, s44, 7
    s_lshl_b32 s49, s44, 5
    s_add_u32 s12, s96, 0x1900000
    s_addc_u32 s13, s97, 0
    s_mov_b32 s14, 0x6000
    s_mov_b32 s15, 0x00020000
    buffer_load_dwordx2 v[168:169], v45, s[12:15], s48 offen offset:0 sc1
    buffer_load_dwordx2 v[170:171], v45, s[12:15], s48 offen offset:128 sc1
    s_mov_b32 s12, s90
    s_mov_b32 s13, s91
    s_mov_b32 s14, 0x1000
    s_mov_b32 s15, 0x00020000
    buffer_load_ushort v172, v42, s[12:15], s49 offen offset:0
    buffer_load_ushort v174, v42, s[12:15], s49 offen offset:32
    s_mov_b32 s12, s80
    s_mov_b32 s13, s81
    s_mov_b32 s14, 0x480
    s_mov_b32 s15, 0x00020000
    buffer_load_dwordx2 v[162:163], v43, s[12:15], s45 offen offset:0
    buffer_load_dwordx2 v[164:165], v43, s[12:15], s45 offen offset:128
    buffer_load_dwordx2 v[166:167], v43, s[12:15], s45 offen offset:256
    s_mov_b32 s12, s64
    s_mov_b32 s13, s65
    s_mov_b32 s14, 0x240000
    s_mov_b32 s15, 0x00020000
    buffer_load_dwordx2 v[150:151], v46, s[12:15], s50 offen offset:0
    buffer_load_dwordx2 v[152:153], v46, s[12:15], s51 offen offset:0
    buffer_load_dwordx2 v[154:155], v46, s[12:15], s50 offen offset:128
    buffer_load_dwordx2 v[156:157], v46, s[12:15], s51 offen offset:128
    s_cmp_lg_u32 s23, 0
    s_cbranch_scc1 bl_13
    buffer_load_dwordx2 v[158:159], v46, s[12:15], s50 offen offset:256
    buffer_load_dwordx2 v[160:161], v46, s[12:15], s51 offen offset:256
bl_13:
    s_lshl_b32 s50, s50, 1
    s_lshl_b32 s51, s51, 1
    s_cmp_lg_u32 s23, 0
    s_waitcnt vmcnt(25)
    s_barrier
    s_cbranch_scc1 lg_14
    buffer_load_dwordx2 v[252:253], v248, s[16:19], s60 offen sc1
lg_14:
    s_waitcnt vmcnt(18)
    s_barrier
    s_cmp_lg_u32 s23, 0
    s_cbranch_scc1 l2_e1
    s_waitcnt vmcnt(0)
    v_cmp_ne_u64 vcc, v[252:253], v[250:251]
    s_and_b32 vcc_hi, vcc_hi, 15
    s_cmp_lg_u64 vcc, 0
    s_cbranch_scc1 l2_e1
    v_mov_b32 v40, 1
    ds_write_b32 v41, v40 offset:8
    s_waitcnt lgkmcnt(0)
l2_e1:
    s_waitcnt vmcnt(11)
    s_barrier
    ds_read_b32 v40, v41 offset:8
    s_waitcnt lgkmcnt(0)
    v_readfirstlane_b32 s58, v40
    s_cmp_lg_u32 s58, 0
    s_cbranch_scc1 l3_early
    s_cmp_lg_u32 s23, 0
    s_cbranch_scc1 lg_15
    buffer_load_dwordx2 v[252:253], v248, s[16:19], s60 offen sc1
lg_15:
    s_barrier
l3_main:
    s_cmp_lg_u32 s23, 0
    s_cbranch_scc1 lg_16
    s_mov_b32 s59, 0
    s_mov_b32 s56, 0xffffffff
    s_mov_b32 s57, 0xf
    s_waitcnt vmcnt(0)
gt_19:
    v_cmp_ne_u64 vcc, v[252:253], v[250:251]
    s_add_u32 s59, s59, 1
    s_and_b64 vcc, vcc, s[56:57]
    s_cbranch_scc0 gt_20
    s_cmp_gt_u32 s59, 16384
    s_cbranch_scc1 gt_20
    s_sleep 4
    buffer_load_dwordx2 v[252:253], v248, s[16:19], s60 offen sc1
    s_waitcnt vmcnt(0)
    s_branch gt_19
gt_20:
    v_mov_b32 v40, 1
    ds_write_b32 v41, v40 offset:8
    s_branch lg_17
lg_16:
    s_mov_b32 s59, 0
lg_18:
    ds_read_b32 v40, v41 offset:8
    s_add_u32 s59, s59, 1
    s_waitcnt lgkmcnt(0)
    v_readfirstlane_b32 s58, v40
    s_cmp_gt_u32 s59, 1048576
    s_cbranch_scc1 lg_17
    s_cmp_eq_u32 s58, 0
    s_cbranch_scc1 lg_18
lg_17:
l3_main2:
    s_cmp_ge_u32 s23, 2
    s_cbranch_scc1 l3b
    s_branch l3a
l3_early:
    s_cmp_ge_u32 s23, 2
    s_cbranch_scc1 l3b_early
l3a_early:
    s_add_u32 s4, s96, 0x1400000
    s_addc_u32 s5, s97, 0
    s_mov_b32 s6, 0x480000
    s_mov_b32 s7, 0x00020000
    s_cmp_ge_u32 s55, 9
    s_cselect_b32 s8, s76, s74
    s_cselect_b32 s9, s77, s75
    s_cselect_b32 s44, 9, 0
    s_mov_b32 s10, 663552
    s_mov_b32 s11, 0x00020000
    s_lshl_b32 s42, s55, 18
    s_add_u32 s42, s42, s52
    s_add_u32 m0, s26, s40
    s_sub_u32 s44, s55, s44
    buffer_load_dwordx4 v24, s[4:7], s42 offen offset:0 sc1 lds
    buffer_load_dwordx4 v25, s[4:7], s42 offen offset:1024 sc1 lds
    buffer_load_dwordx4 v26, s[4:7], s42 offen offset:2048 sc1 lds
    buffer_load_dwordx4 v27, s[4:7], s42 offen offset:3072 sc1 lds
    s_lshl_b32 s44, s44, 7
    s_add_u32 s44, s44, s53
    s_mul_i32 s43, s23, 36864
    s_add_u32 m0, s26, s29
    s_add_u32 s43, s43, s44
    buffer_load_dwordx4 v30, s[8:11], s43 offen offset:0 lds
    buffer_load_dwordx4 v31, s[8:11], s43 offen offset:1024 lds
    buffer_load_dwordx4 v32, s[8:11], s43 offen offset:2048 lds
    buffer_load_dwordx4 v33, s[8:11], s43 offen offset:3072 lds
    s_mul_i32 s43, s23, 9216
    s_add_u32 s44, s44, 147456
    s_add_u32 m0, s26, s47
    s_add_u32 s43, s43, s44
    buffer_load_dwordx4 v30, s[8:11], s43 offen lds
    s_add_u32 s55, s55, 1
    s_add_u32 s26, s26, 34816
    s_cmp_eq_u32 s26, 139264
    s_cselect_b32 s26, 0, s26
    s_add_u32 s4, s96, 0x1400000
    s_addc_u32 s5, s97, 0
    s_mov_b32 s6, 0x480000
    s_mov_b32 s7, 0x00020000
    s_cmp_ge_u32 s55, 9
    s_cselect_b32 s8, s76, s74
    s_cselect_b32 s9, s77, s75
    s_cselect_b32 s44, 9, 0
    s_mov_b32 s10, 663552
    s_mov_b32 s11, 0x00020000
    s_lshl_b32 s42, s55, 18
    s_add_u32 s42, s42, s52
    s_add_u32 m0, s26, s40
    s_sub_u32 s44, s55, s44
    buffer_load_dwordx4 v24, s[4:7], s42 offen offset:0 sc1 lds
    buffer_load_dwordx4 v25, s[4:7], s42 offen offset:1024 sc1 lds
    buffer_load_dwordx4 v26, s[4:7], s42 offen offset:2048 sc1 lds
    buffer_load_dwordx4 v27, s[4:7], s42 offen offset:3072 sc1 lds
    s_lshl_b32 s44, s44, 7
    s_add_u32 s44, s44, s53
    s_mul_i32 s43, s23, 36864
    s_add_u32 m0, s26, s29
    s_add_u32 s43, s43, s44
    buffer_load_dwordx4 v30, s[8:11], s43 offen offset:0 lds
    buffer_load_dwordx4 v31, s[8:11], s43 offen offset:1024 lds
    buffer_load_dwordx4 v32, s[8:11], s43 offen offset:2048 lds
    buffer_load_dwordx4 v33, s[8:11], s43 offen offset:3072 lds
    s_mul_i32 s43, s23, 9216
    s_add_u32 s44, s44, 147456
    s_add_u32 m0, s26, s47
    s_add_u32 s43, s43, s44
    buffer_load_dwordx4 v30, s[8:11], s43 offen lds
    s_add_u32 s55, s55, 1
    s_add_u32 s26, s26, 34816
    s_cmp_eq_u32 s26, 139264
    s_cselect_b32 s26, 0, s26
    s_barrier
    s_branch l3a_j
l3a:
    s_add_u32 s4, s96, 0x1400000
    s_addc_u32 s5, s97, 0
    s_mov_b32 s6, 0x480000
    s_mov_b32 s7, 0x00020000
    s_cmp_ge_u32 s55, 9
    s_cselect_b32 s8, s76, s74
    s_cselect_b32 s9, s77, s75
    s_cselect_b32 s44, 9, 0
    s_mov_b32 s10, 663552
    s_mov_b32 s11, 0x00020000
    s_lshl_b32 s42, s55, 18
    s_add_u32 s42, s42, s52
    s_add_u32 m0, s26, s40
    s_sub_u32 s44, s55, s44
    buffer_load_dwordx4 v24, s[4:7], s42 offen offset:0 sc1 lds
    buffer_load_dwordx4 v25, s[4:7], s42 offen offset:1024 sc1 lds
    buffer_load_dwordx4 v26, s[4:7], s42 offen offset:2048 sc1 lds
    buffer_load_dwordx4 v27, s[4:7], s42 offen offset:3072 sc1 lds
    s_lshl_b32 s44, s44, 7
    s_add_u32 s44, s44, s53
    s_mul_i32 s43, s23, 36864
    s_add_u32 m0, s26, s29
    s_add_u32 s43, s43, s44
    buffer_load_dwordx4 v30, s[8:11], s43 offen offset:0 lds
    buffer_load_dwordx4 v31, s[8:11], s43 offen offset:1024 lds
    buffer_load_dwordx4 v32, s[8:11], s43 offen offset:2048 lds
    buffer_load_dwordx4 v33, s[8:11], s43 offen offset:3072 lds
    s_mul_i32 s43, s23, 9216
    s_add_u32 s44, s44, 147456
    s_add_u32 m0, s26, s47
    s_add_u32 s43, s43, s44
    buffer_load_dwordx4 v30, s[8:11], s43 offen lds
    s_add_u32 s55, s55, 1
    s_add_u32 s26, s26, 34816
    s_cmp_eq_u32 s26, 139264
    s_cselect_b32 s26, 0, s26
    s_add_u32 s4, s96, 0x1400000
    s_addc_u32 s5, s97, 0
    s_mov_b32 s6, 0x480000
    s_mov_b32 s7, 0x00020000
    s_cmp_ge_u32 s55, 9
    s_cselect_b32 s8, s76, s74
    s_cselect_b32 s9, s77, s75
    s_cselect_b32 s44, 9, 0
    s_mov_b32 s10, 663552
    s_mov_b32 s11, 0x00020000
    s_lshl_b32 s42, s55, 18
    s_add_u32 s42, s42, s52
    s_add_u32 m0, s26, s40
    s_sub_u32 s44, s55, s44
    buffer_load_dwordx4 v24, s[4:7], s42 offen offset:0 sc1 lds
    buffer_load_dwordx4 v25, s[4:7], s42 offen offset:1024 sc1 lds
    buffer_load_dwordx4 v26, s[4:7], s42 offen offset:2048 sc1 lds
    buffer_load_dwordx4 v27, s[4:7], s42 offen offset:3072 sc1 lds
    s_lshl_b32 s44, s44, 7
    s_add_u32 s44, s44, s53
    s_mul_i32 s43, s23, 36864
    s_add_u32 m0, s26, s29
    s_add_u32 s43, s43, s44
    buffer_load_dwordx4 v30, s[8:11], s43 offen offset:0 lds
    buffer_load_dwordx4 v31, s[8:11], s43 offen offset:1024 lds
    buffer_load_dwordx4 v32, s[8:11], s43 offen offset:2048 lds
    buffer_load_dwordx4 v33, s[8:11], s43 offen offset:3072 lds
    s_mul_i32 s43, s23, 9216
    s_add_u32 s44, s44, 147456
    s_add_u32 m0, s26, s47
    s_add_u32 s43, s43, s44
    buffer_load_dwordx4 v30, s[8:11], s43 offen lds
    s_add_u32 s55, s55, 1
    s_add_u32 s26, s26, 34816
    s_cmp_eq_u32 s26, 139264
    s_cselect_b32 s26, 0, s26
l3a_j:
    s_add_u32 s4, s96, 0x1400000
    s_addc_u32 s5, s97, 0
    s_mov_b32 s6, 0x480000
    s_mov_b32 s7, 0x00020000
    s_cmp_ge_u32 s55, 9
    s_cselect_b32 s8, s76, s74
    s_cselect_b32 s9, s77, s75
    s_cselect_b32 s44, 9, 0
    s_mov_b32 s10, 663552
    s_mov_b32 s11, 0x00020000
    s_lshl_b32 s42, s55, 18
    s_add_u32 s42, s42, s52
    s_add_u32 m0, s26, s40
    s_sub_u32 s44, s55, s44
    buffer_load_dwordx4 v24, s[4:7], s42 offen offset:0 sc1 lds
    buffer_load_dwordx4 v25, s[4:7], s42 offen offset:1024 sc1 lds
    buffer_load_dwordx4 v26, s[4:7], s42 offen offset:2048 sc1 lds
    buffer_load_dwordx4 v27, s[4:7], s42 offen offset:3072 sc1 lds
    s_lshl_b32 s44, s44, 7
    s_add_u32 s44, s44, s53
    s_mul_i32 s43, s23, 36864
    s_add_u32 m0, s26, s29
    s_add_u32 s43, s43, s44
    buffer_load_dwordx4 v30, s[8:11], s43 offen offset:0 lds
    buffer_load_dwordx4 v31, s[8:11], s43 offen offset:1024 lds
    buffer_load_dwordx4 v32, s[8:11], s43 offen offset:2048 lds
    buffer_load_dwordx4 v33, s[8:11], s43 offen offset:3072 lds
    s_mul_i32 s43, s23, 9216
    s_add_u32 s44, s44, 147456
    s_add_u32 m0, s26, s47
    s_add_u32 s43, s43, s44
    buffer_load_dwordx4 v30, s[8:11], s43 offen lds
    s_add_u32 s55, s55, 1
    s_add_u32 s26, s26, 34816
    s_cmp_eq_u32 s26, 139264
    s_cselect_b32 s26, 0, s26
    s_waitcnt vmcnt(27)
    v_lshlrev_b32 v172, 16, v172
    v_lshlrev_b32 v174, 16, v174
    v_lshlrev_b32 v76, 16, v162
    v_and_b32 v77, 0xffff0000, v162
    v_lshlrev_b32 v78, 16, v163
    v_and_b32 v79, 0xffff0000, v163
    v_lshlrev_b32 v116, 16, v150
    v_and_b32 v117, 0xffff0000, v150
    v_lshlrev_b32 v118, 16, v151
    v_and_b32 v119, 0xffff0000, v151
    v_mul_f32 v144, v76, v169
    v_mul_f32 v145, v77, v169
    v_mul_f32 v146, v78, v169
    v_mul_f32 v147, v79, v169
    v_add_f32 v48, v116, v172
    v_add_f32 v49, v117, v172
    v_add_f32 v50, v118, v172
    v_add_f32 v51, v119, v172
    v_sub_f32 v116, v116, v168
    v_sub_f32 v117, v117, v168
    v_sub_f32 v118, v118, v168
    v_sub_f32 v119, v119, v168
    v_fmac_f32 v48, v116, v144
    v_fmac_f32 v49, v117, v145
    v_fmac_f32 v50, v118, v146
    v_fmac_f32 v51, v119, v147
    v_lshlrev_b32 v116, 16, v152
    v_and_b32 v117, 0xffff0000, v152
    v_lshlrev_b32 v118, 16, v153
    v_and_b32 v119, 0xffff0000, v153
    v_mul_f32 v144, v76, v171
    v_mul_f32 v145, v77, v171
    v_mul_f32 v146, v78, v171
    v_mul_f32 v147, v79, v171
    v_add_f32 v52, v116, v174
    v_add_f32 v53, v117, v174
    v_add_f32 v54, v118, v174
    v_add_f32 v55, v119, v174
    v_sub_f32 v116, v116, v170
    v_sub_f32 v117, v117, v170
    v_sub_f32 v118, v118, v170
    v_sub_f32 v119, v119, v170
    v_fmac_f32 v52, v116, v144
    v_fmac_f32 v53, v117, v145
    v_fmac_f32 v54, v118, v146
    v_fmac_f32 v55, v119, v147
    v_lshlrev_b32 v76, 16, v164
    v_and_b32 v77, 0xffff0000, v164
    v_lshlrev_b32 v78, 16, v165
    v_and_b32 v79, 0xffff0000, v165
    v_lshlrev_b32 v116, 16, v154
    v_and_b32 v117, 0xffff0000, v154
    v_lshlrev_b32 v118, 16, v155
    v_and_b32 v119, 0xffff0000, v155
    v_mul_f32 v144, v76, v169
    v_mul_f32 v145, v77, v169
    v_mul_f32 v146, v78, v169
    v_mul_f32 v147, v79, v169
    v_add_f32 v56, v116, v172
    v_add_f32 v57, v117, v172
    v_add_f32 v58, v118, v172
    v_add_f32 v59, v119, v172
    v_sub_f32 v116, v116, v168
    v_sub_f32 v117, v117, v168
    v_sub_f32 v118, v118, v168
    v_sub_f32 v119, v119, v168
    v_fmac_f32 v56, v116, v144
    v_fmac_f32 v57, v117, v145
    v_fmac_f32 v58, v118, v146
    v_fmac_f32 v59, v119, v147
    v_lshlrev_b32 v116, 16, v156
    v_and_b32 v117, 0xffff0000, v156
    v_lshlrev_b32 v118, 16, v157
    v_and_b32 v119, 0xffff0000, v157
    v_mul_f32 v144, v76, v171
    v_mul_f32 v145, v77, v171
    v_mul_f32 v146, v78, v171
    v_mul_f32 v147, v79, v171
    v_add_f32 v60, v116, v174
    v_add_f32 v61, v117, v174
    v_add_f32 v62, v118, v174
    v_add_f32 v63, v119, v174
    v_sub_f32 v116, v116, v170
    v_sub_f32 v117, v117, v170
    v_sub_f32 v118, v118, v170
    v_sub_f32 v119, v119, v170
    v_fmac_f32 v60, v116, v144
    v_fmac_f32 v61, v117, v145
    v_fmac_f32 v62, v118, v146
    v_fmac_f32 v63, v119, v147
    v_lshlrev_b32 v76, 16, v166
    v_and_b32 v77, 0xffff0000, v166
    v_lshlrev_b32 v78, 16, v167
    v_and_b32 v79, 0xffff0000, v167
    v_lshlrev_b32 v116, 16, v158
    v_and_b32 v117, 0xffff0000, v158
    v_lshlrev_b32 v118, 16, v159
    v_and_b32 v119, 0xffff0000, v159
    v_mul_f32 v144, v76, v169
    v_mul_f32 v145, v77, v169
    v_mul_f32 v146, v78, v169
    v_mul_f32 v147, v79, v169
    v_add_f32 v64, v116, v172
    v_add_f32 v65, v117, v172
    v_add_f32 v66, v118, v172
    v_add_f32 v67, v119, v172
    v_sub_f32 v116, v116, v168
    v_sub_f32 v117, v117, v168
    v_sub_f32 v118, v118, v168
    v_sub_f32 v119, v119, v168
    v_fmac_f32 v64, v116, v144
    v_fmac_f32 v65, v117, v145
    v_fmac_f32 v66, v118, v146
    v_fmac_f32 v67, v119, v147
    v_lshlrev_b32 v116, 16, v160
    v_and_b32 v117, 0xffff0000, v160
    v_lshlrev_b32 v118, 16, v161
    v_and_b32 v119, 0xffff0000, v161
    v_mul_f32 v144, v76, v171
    v_mul_f32 v145, v77, v171
    v_mul_f32 v146, v78, v171
    v_mul_f32 v147, v79, v171
    v_add_f32 v68, v116, v174
    v_add_f32 v69, v117, v174
    v_add_f32 v70, v118, v174
    v_add_f32 v71, v119, v174
    v_sub_f32 v116, v116, v170
    v_sub_f32 v117, v117, v170
    v_sub_f32 v118, v118, v170
    v_sub_f32 v119, v119, v170
    v_fmac_f32 v68, v116, v144
    v_fmac_f32 v69, v117, v145
    v_fmac_f32 v70, v118, v146
    v_fmac_f32 v71, v119, v147
    s_add_u32 s4, s96, 0x1400000
    s_addc_u32 s5, s97, 0
    s_mov_b32 s6, 0x480000
    s_mov_b32 s7, 0x00020000
    s_cmp_ge_u32 s55, 9
    s_cselect_b32 s8, s76, s74
    s_cselect_b32 s9, s77, s75
    s_cselect_b32 s44, 9, 0
    s_mov_b32 s10, 663552
    s_mov_b32 s11, 0x00020000
    s_lshl_b32 s42, s55, 18
    s_add_u32 s42, s42, s52
    s_add_u32 m0, s26, s40
    s_sub_u32 s44, s55, s44
    s_waitcnt vmcnt(18)
    s_barrier
    buffer_load_dwordx4 v24, s[4:7], s42 offen offset:0 sc1 lds
    buffer_load_dwordx4 v25, s[4:7], s42 offen offset:1024 sc1 lds
    buffer_load_dwordx4 v26, s[4:7], s42 offen offset:2048 sc1 lds
    buffer_load_dwordx4 v27, s[4:7], s42 offen offset:3072 sc1 lds
    s_lshl_b32 s44, s44, 7
    s_add_u32 s44, s44, s53
    s_mul_i32 s43, s23, 36864
    s_add_u32 m0, s26, s29
    s_add_u32 s43, s43, s44
    buffer_load_dwordx4 v30, s[8:11], s43 offen offset:0 lds
    buffer_load_dwordx4 v31, s[8:11], s43 offen offset:1024 lds
    buffer_load_dwordx4 v32, s[8:11], s43 offen offset:2048 lds
    buffer_load_dwordx4 v33, s[8:11], s43 offen offset:3072 lds
    s_mul_i32 s43, s23, 9216
    s_add_u32 s44, s44, 147456
    s_add_u32 m0, s26, s47
    s_add_u32 s43, s43, s44
    buffer_load_dwordx4 v30, s[8:11], s43 offen lds
    s_add_u32 s55, s55, 1
    s_add_u32 s26, s26, 34816
    s_cmp_eq_u32 s26, 139264
    s_cselect_b32 s26, 0, s26
    s_waitcnt vmcnt(18)
    s_barrier
    s_cmp_eq_u32 s38, 4
    s_cbranch_scc1 nf_21
    s_add_u32 s4, s96, 0x1400000
    s_addc_u32 s5, s97, 0
    s_mov_b32 s6, 0x480000
    s_mov_b32 s7, 0x00020000
    s_cmp_ge_u32 s55, 9
    s_cselect_b32 s8, s76, s74
    s_cselect_b32 s9, s77, s75
    s_cselect_b32 s44, 9, 0
    s_mov_b32 s10, 663552
    s_mov_b32 s11, 0x00020000
    s_lshl_b32 s42, s55, 18
    s_add_u32 s42, s42, s52
    s_add_u32 m0, s26, s40
    s_sub_u32 s44, s55, s44
    s_waitcnt vmcnt(9)
    s_barrier
    buffer_load_dwordx4 v24, s[4:7], s42 offen offset:0 sc1 lds
    buffer_load_dwordx4 v25, s[4:7], s42 offen offset:1024 sc1 lds
    buffer_load_dwordx4 v26, s[4:7], s42 offen offset:2048 sc1 lds
    buffer_load_dwordx4 v27, s[4:7], s42 offen offset:3072 sc1 lds
    s_lshl_b32 s44, s44, 7
    s_add_u32 s44, s44, s53
    s_mul_i32 s43, s23, 36864
    s_add_u32 m0, s26, s29
    s_add_u32 s43, s43, s44
    buffer_load_dwordx4 v30, s[8:11], s43 offen offset:0 lds
    buffer_load_dwordx4 v31, s[8:11], s43 offen offset:1024 lds
    buffer_load_dwordx4 v32, s[8:11], s43 offen offset:2048 lds
    buffer_load_dwordx4 v33, s[8:11], s43 offen offset:3072 lds
    s_mul_i32 s43, s23, 9216
    s_add_u32 s44, s44, 147456
    s_add_u32 m0, s26, s47
    s_add_u32 s43, s43, s44
    buffer_load_dwordx4 v30, s[8:11], s43 offen lds
    s_add_u32 s55, s55, 1
    s_add_u32 s26, s26, 34816
    s_cmp_eq_u32 s26, 139264
    s_cselect_b32 s26, 0, s26
nf_21:
    s_mov_b32 s4, s88
    s_mov_b32 s5, s89
    s_mov_b32 s6, 0x1200000
    s_mov_b32 s7, 0x00020000
    s_add_u32 s8, s96, 0x400000
    s_addc_u32 s9, s97, 0
    s_mov_b32 s10, 0x3510080
    s_mov_b32 s11, 0x00020000
    s_mul_i32 s44, s34, 4718592
    s_add_u32 s52, s52, s44
    s_mov_b32 s55, 0
    s_mov_b32 s62, s26
    s_and_b32 s45, s55, 3
    s_add_u32 s44, s55, 4
    s_cmp_lt_u32 s44, 18
    s_cselect_b32 s44, s44, s45
    s_cmp_eq_u32 s45, s46
    s_cselect_b32 s44, s44, s55
    s_lshl_b32 s42, s44, 18
    s_add_u32 s42, s42, s52
    s_mul_i32 s45, s44, 73728
    s_add_u32 s45, s45, s54
    s_add_u32 s43, s45, s40
    s_add_u32 s45, s45, s47
    s_sub_u32 s45, s45, 16384
    s_add_u32 m0, s26, s40
    s_nop 0
    s_waitcnt vmcnt(9)
    s_barrier
    buffer_load_dwordx4 v24, s[4:7], s42 offen offset:0 lds
    buffer_load_dwordx4 v25, s[4:7], s42 offen offset:1024 lds
    buffer_load_dwordx4 v26, s[4:7], s42 offen offset:2048 lds
    buffer_load_dwordx4 v27, s[4:7], s42 offen offset:3072 lds
    s_add_u32 s55, s55, 1
    s_add_u32 s26, s26, 34816
    s_cmp_eq_u32 s26, 139264
    s_cselect_b32 s26, 0, s26
    s_cmp_lg_u32 s23, 0
    s_waitcnt vmcnt(4)
    s_barrier
    s_cbranch_scc1 lg_22
    buffer_load_dwordx2 v[252:253], v248, s[16:19], s61 offen sc1
lg_22:
    s_and_b32 s45, s55, 3
    s_add_u32 s44, s55, 4
    s_cmp_lt_u32 s44, 18
    s_cselect_b32 s44, s44, s45
    s_cmp_eq_u32 s45, s46
    s_cselect_b32 s44, s44, s55
    s_lshl_b32 s42, s44, 18
    s_add_u32 s42, s42, s52
    s_mul_i32 s45, s44, 73728
    s_add_u32 s45, s45, s54
    s_add_u32 s43, s45, s40
    s_add_u32 s45, s45, s47
    s_sub_u32 s45, s45, 16384
    s_add_u32 m0, s26, s40
    s_nop 0
    buffer_load_dwordx4 v24, s[4:7], s42 offen offset:0 lds
    buffer_load_dwordx4 v25, s[4:7], s42 offen offset:1024 lds
    buffer_load_dwordx4 v26, s[4:7], s42 offen offset:2048 lds
    buffer_load_dwordx4 v27, s[4:7], s42 offen offset:3072 lds
    s_add_u32 s55, s55, 1
    s_add_u32 s26, s26, 34816
    s_cmp_eq_u32 s26, 139264
    s_cselect_b32 s26, 0, s26
    s_cmp_lg_u32 s23, 0
    s_cbranch_scc1 lg_23
    s_mov_b32 s59, 0
    s_mov_b32 s56, 0xffffffff
    s_mov_b32 s57, 0x3fffff
    s_waitcnt vmcnt(4)
gt_26:
    v_cmp_ne_u64 vcc, v[252:253], v[250:251]
    s_add_u32 s59, s59, 1
    s_and_b64 vcc, vcc, s[56:57]
    s_cbranch_scc0 gt_27
    s_cmp_gt_u32 s59, 16384
    s_cbranch_scc1 gt_27
    s_sleep 4
    buffer_load_dwordx2 v[252:253], v248, s[16:19], s61 offen sc1
    s_waitcnt vmcnt(0)
    s_branch gt_26
gt_27:
    v_mov_b32 v40, 1
    ds_write_b32 v41, v40 offset:12
    s_branch lg_24
lg_23:
    s_mov_b32 s59, 0
lg_25:
    ds_read_b32 v40, v41 offset:12
    s_add_u32 s59, s59, 1
    s_waitcnt lgkmcnt(0)
    v_readfirstlane_b32 s58, v40
    s_cmp_gt_u32 s59, 1048576
    s_cbranch_scc1 lg_24
    s_cmp_eq_u32 s58, 0
    s_cbranch_scc1 lg_25
lg_24:
    s_mov_b32 s26, s62
    s_mov_b32 s55, 0
    s_and_b32 s45, s55, 3
    s_add_u32 s44, s55, 4
    s_cmp_lt_u32 s44, 18
    s_cselect_b32 s44, s44, s45
    s_cmp_eq_u32 s45, s46
    s_cselect_b32 s44, s44, s55
    s_lshl_b32 s42, s44, 18
    s_add_u32 s42, s42, s52
    s_mul_i32 s45, s44, 73728
    s_add_u32 s45, s45, s54
    s_add_u32 s43, s45, s40
    s_add_u32 s45, s45, s47
    s_sub_u32 s45, s45, 16384
    s_add_u32 m0, s26, s29
    s_nop 0
    buffer_load_dwordx4 v28, s[8:11], s43 offen offset:0 sc1 lds
    buffer_load_dwordx4 v28, s[8:11], s43 offen offset:1024 sc1 lds
    buffer_load_dwordx4 v28, s[8:11], s43 offen offset:2048 sc1 lds
    buffer_load_dwordx4 v28, s[8:11], s43 offen offset:3072 sc1 lds
    s_add_u32 m0, s26, s47
    s_nop 0
    buffer_load_dwordx4 v28, s[8:11], s45 offen sc1 lds
    s_add_u32 s55, s55, 1
    s_add_u32 s26, s26, 34816
    s_cmp_eq_u32 s26, 139264
    s_cselect_b32 s26, 0, s26
    s_and_b32 s45, s55, 3
    s_add_u32 s44, s55, 4
    s_cmp_lt_u32 s44, 18
    s_cselect_b32 s44, s44, s45
    s_cmp_eq_u32 s45, s46
    s_cselect_b32 s44, s44, s55
    s_lshl_b32 s42, s44, 18
    s_add_u32 s42, s42, s52
    s_mul_i32 s45, s44, 73728
    s_add_u32 s45, s45, s54
    s_add_u32 s43, s45, s40
    s_add_u32 s45, s45, s47
    s_sub_u32 s45, s45, 16384
    s_add_u32 m0, s26, s29
    s_nop 0
    buffer_load_dwordx4 v28, s[8:11], s43 offen offset:0 sc1 lds
    buffer_load_dwordx4 v28, s[8:11], s43 offen offset:1024 sc1 lds
    buffer_load_dwordx4 v28, s[8:11], s43 offen offset:2048 sc1 lds
    buffer_load_dwordx4 v28, s[8:11], s43 offen offset:3072 sc1 lds
    s_add_u32 m0, s26, s47
    s_nop 0
    buffer_load_dwordx4 v28, s[8:11], s45 offen sc1 lds
    s_add_u32 s55, s55, 1
    s_add_u32 s26, s26, 34816
    s_cmp_eq_u32 s26, 139264
    s_cselect_b32 s26, 0, s26
    s_and_b32 s45, s55, 3
    s_add_u32 s44, s55, 4
    s_cmp_lt_u32 s44, 18
    s_cselect_b32 s44, s44, s45
    s_cmp_eq_u32 s45, s46
    s_cselect_b32 s44, s44, s55
    s_lshl_b32 s42, s44, 18
    s_add_u32 s42, s42, s52
    s_mul_i32 s45, s44, 73728
    s_add_u32 s45, s45, s54
    s_add_u32 s43, s45, s40
    s_add_u32 s45, s45, s47
    s_sub_u32 s45, s45, 16384
    s_add_u32 m0, s26, s40
    s_nop 0
    s_waitcnt vmcnt(5)
    s_barrier
    buffer_load_dwordx4 v24, s[4:7], s42 offen offset:0 lds
    buffer_load_dwordx4 v25, s[4:7], s42 offen offset:1024 lds
    buffer_load_dwordx4 v26, s[4:7], s42 offen offset:2048 lds
    buffer_load_dwordx4 v27, s[4:7], s42 offen offset:3072 lds
    s_add_u32 m0, s26, s29
    s_nop 0
    buffer_load_dwordx4 v28, s[8:11], s43 offen offset:0 sc1 lds
    buffer_load_dwordx4 v28, s[8:11], s43 offen offset:1024 sc1 lds
    buffer_load_dwordx4 v28, s[8:11], s43 offen offset:2048 sc1 lds
    buffer_load_dwordx4 v28, s[8:11], s43 offen offset:3072 sc1 lds
    s_add_u32 m0, s26, s47
    s_nop 0
    buffer_load_dwordx4 v28, s[8:11], s45 offen sc1 lds
    s_add_u32 s55, s55, 1
    s_add_u32 s26, s26, 34816
    s_cmp_eq_u32 s26, 139264
    s_cselect_b32 s26, 0, s26
    s_and_b32 s45, s55, 3
    s_add_u32 s44, s55, 4
    s_cmp_lt_u32 s44, 18
    s_cselect_b32 s44, s44, s45
    s_cmp_eq_u32 s45, s46
    s_cselect_b32 s44, s44, s55
    s_lshl_b32 s42, s44, 18
    s_add_u32 s42, s42, s52
    s_mul_i32 s45, s44, 73728
    s_add_u32 s45, s45, s54
    s_add_u32 s43, s45, s40
    s_add_u32 s45, s45, s47
    s_sub_u32 s45, s45, 16384
    s_add_u32 m0, s26, s40
    s_nop 0
    s_waitcnt vmcnt(9)
    s_barrier
    buffer_load_dwordx4 v24, s[4:7], s42 offen offset:0 lds
    buffer_load_dwordx4 v25, s[4:7], s42 offen offset:1024 lds
    buffer_load_dwordx4 v26, s[4:7], s42 offen offset:2048 lds
    buffer_load_dwordx4 v27, s[4:7], s42 offen offset:3072 lds
    s_add_u32 m0, s26, s29
    s_nop 0
    buffer_load_dwordx4 v28, s[8:11], s43 offen offset:0 sc1 lds
    buffer_load_dwordx4 v28, s[8:11], s43 offen offset:1024 sc1 lds
    buffer_load_dwordx4 v28, s[8:11], s43 offen offset:2048 sc1 lds
    buffer_load_dwordx4 v28, s[8:11], s43 offen offset:3072 sc1 lds
    s_add_u32 m0, s26, s47
    s_nop 0
    buffer_load_dwordx4 v28, s[8:11], s45 offen sc1 lds
    s_add_u32 s55, s55, 1
    s_add_u32 s26, s26, 34816
    s_cmp_eq_u32 s26, 139264
    s_cselect_b32 s26, 0, s26
    s_mov_b32 s27, 7
l3a_u:
    s_and_b32 s45, s55, 3
    s_add_u32 s44, s55, 4
    s_cmp_lt_u32 s44, 18
    s_cselect_b32 s44, s44, s45
    s_cmp_eq_u32 s45, s46
    s_cselect_b32 s44, s44, s55
    s_lshl_b32 s42, s44, 18
    s_add_u32 s42, s42, s52
    s_mul_i32 s45, s44, 73728
    s_add_u32 s45, s45, s54
    s_add_u32 s43, s45, s40
    s_add_u32 s45, s45, s47
    s_sub_u32 s45, s45, 16384
    s_add_u32 m0, s26, s40
    s_nop 0
    s_waitcnt vmcnt(9)
    s_barrier
    buffer_load_dwordx4 v24, s[4:7], s42 offen offset:0 lds
    buffer_load_dwordx4 v25, s[4:7], s42 offen offset:1024 lds
    buffer_load_dwordx4 v26, s[4:7], s42 offen offset:2048 lds
    buffer_load_dwordx4 v27, s[4:7], s42 offen offset:3072 lds
    s_add_u32 m0, s26, s29
    s_nop 0
    buffer_load_dwordx4 v28, s[8:11], s43 offen offset:0 sc1 lds
    buffer_load_dwordx4 v28, s[8:11], s43 offen offset:1024 sc1 lds
    buffer_load_dwordx4 v28, s[8:11], s43 offen offset:2048 sc1 lds
    buffer_load_dwordx4 v28, s[8:11], s43 offen offset:3072 sc1 lds
    s_add_u32 m0, s26, s47
    s_nop 0
    buffer_load_dwordx4 v28, s[8:11], s45 offen sc1 lds
    s_add_u32 s55, s55, 1
    s_add_u32 s26, s26, 34816
    s_cmp_eq_u32 s26, 139264
    s_cselect_b32 s26, 0, s26
    s_and_b32 s45, s55, 3
    s_add_u32 s44, s55, 4
    s_cmp_lt_u32 s44, 18
    s_cselect_b32 s44, s44, s45
    s_cmp_eq_u32 s45, s46
    s_cselect_b32 s44, s44, s55
    s_lshl_b32 s42, s44, 18
    s_add_u32 s42, s42, s52
    s_mul_i32 s45, s44, 73728
    s_add_u32 s45, s45, s54
    s_add_u32 s43, s45, s40
    s_add_u32 s45, s45, s47
    s_sub_u32 s45, s45, 16384
    s_add_u32 m0, s26, s40
    s_nop 0
    s_waitcnt vmcnt(9)
    s_barrier
    buffer_load_dwordx4 v24, s[4:7], s42 offen offset:0 lds
    buffer_load_dwordx4 v25, s[4:7], s42 offen offset:1024 lds
    buffer_load_dwordx4 v26, s[4:7], s42 offen offset:2048 lds
    buffer_load_dwordx4 v27, s[4:7], s42 offen offset:3072 lds
    s_add_u32 m0, s26, s29
    s_nop 0
    buffer_load_dwordx4 v28, s[8:11], s43 offen offset:0 sc1 lds
    buffer_load_dwordx4 v28, s[8:11], s43 offen offset:1024 sc1 lds
    buffer_load_dwordx4 v28, s[8:11], s43 offen offset:2048 sc1 lds
    buffer_load_dwordx4 v28, s[8:11], s43 offen offset:3072 sc1 lds
    s_add_u32 m0, s26, s47
    s_nop 0
    buffer_load_dwordx4 v28, s[8:11], s45 offen sc1 lds
    s_add_u32 s55, s55, 1
    s_add_u32 s26, s26, 34816
    s_cmp_eq_u32 s26, 139264
    s_cselect_b32 s26, 0, s26
    s_sub_u32 s27, s27, 1
    s_cmp_lg_u32 s27, 0
    s_cbranch_scc1 l3a_u
    s_waitcnt vmcnt(9)
    s_barrier
    s_waitcnt vmcnt(0)
    s_barrier
    s_branch fin
l3b_early:
    s_add_u32 s4, s96, 0x1400000
    s_addc_u32 s5, s97, 0
    s_mov_b32 s6, 0x480000
    s_mov_b32 s7, 0x00020000
    s_cmp_ge_u32 s55, 9
    s_cselect_b32 s8, s76, s74
    s_cselect_b32 s9, s77, s75
    s_cselect_b32 s44, 9, 0
    s_mov_b32 s10, 663552
    s_mov_b32 s11, 0x00020000
    s_lshl_b32 s42, s55, 18
    s_add_u32 s42, s42, s52
    s_add_u32 m0, s26, s40
    s_sub_u32 s44, s55, s44
    buffer_load_dwordx4 v24, s[4:7], s42 offen offset:0 sc1 lds
    buffer_load_dwordx4 v25, s[4:7], s42 offen offset:1024 sc1 lds
    buffer_load_dwordx4 v26, s[4:7], s42 offen offset:2048 sc1 lds
    buffer_load_dwordx4 v27, s[4:7], s42 offen offset:3072 sc1 lds
    s_lshl_b32 s44, s44, 7
    s_add_u32 s44, s44, s53
    s_mul_i32 s43, s23, 36864
    s_add_u32 m0, s26, s29
    s_add_u32 s43, s43, s44
    buffer_load_dwordx4 v30, s[8:11], s43 offen offset:0 lds
    buffer_load_dwordx4 v31, s[8:11], s43 offen offset:1024 lds
    buffer_load_dwordx4 v32, s[8:11], s43 offen offset:2048 lds
    buffer_load_dwordx4 v33, s[8:11], s43 offen offset:3072 lds
    s_add_u32 s55, s55, 1
    s_add_u32 s26, s26, 34816
    s_cmp_eq_u32 s26, 139264
    s_cselect_b32 s26, 0, s26
    s_add_u32 s4, s96, 0x1400000
    s_addc_u32 s5, s97, 0
    s_mov_b32 s6, 0x480000
    s_mov_b32 s7, 0x00020000
    s_cmp_ge_u32 s55, 9
    s_cselect_b32 s8, s76, s74
    s_cselect_b32 s9, s77, s75
    s_cselect_b32 s44, 9, 0
    s_mov_b32 s10, 663552
    s_mov_b32 s11, 0x00020000
    s_lshl_b32 s42, s55, 18
    s_add_u32 s42, s42, s52
    s_add_u32 m0, s26, s40
    s_sub_u32 s44, s55, s44
    buffer_load_dwordx4 v24, s[4:7], s42 offen offset:0 sc1 lds
    buffer_load_dwordx4 v25, s[4:7], s42 offen offset:1024 sc1 lds
    buffer_load_dwordx4 v26, s[4:7], s42 offen offset:2048 sc1 lds
    buffer_load_dwordx4 v27, s[4:7], s42 offen offset:3072 sc1 lds
    s_lshl_b32 s44, s44, 7
    s_add_u32 s44, s44, s53
    s_mul_i32 s43, s23, 36864
    s_add_u32 m0, s26, s29
    s_add_u32 s43, s43, s44
    buffer_load_dwordx4 v30, s[8:11], s43 offen offset:0 lds
    buffer_load_dwordx4 v31, s[8:11], s43 offen offset:1024 lds
    buffer_load_dwordx4 v32, s[8:11], s43 offen offset:2048 lds
    buffer_load_dwordx4 v33, s[8:11], s43 offen offset:3072 lds
    s_add_u32 s55, s55, 1
    s_add_u32 s26, s26, 34816
    s_cmp_eq_u32 s26, 139264
    s_cselect_b32 s26, 0, s26
    s_barrier
    s_branch l3b_j
l3b:
    s_add_u32 s4, s96, 0x1400000
    s_addc_u32 s5, s97, 0
    s_mov_b32 s6, 0x480000
    s_mov_b32 s7, 0x00020000
    s_cmp_ge_u32 s55, 9
    s_cselect_b32 s8, s76, s74
    s_cselect_b32 s9, s77, s75
    s_cselect_b32 s44, 9, 0
    s_mov_b32 s10, 663552
    s_mov_b32 s11, 0x00020000
    s_lshl_b32 s42, s55, 18
    s_add_u32 s42, s42, s52
    s_add_u32 m0, s26, s40
    s_sub_u32 s44, s55, s44
    buffer_load_dwordx4 v24, s[4:7], s42 offen offset:0 sc1 lds
    buffer_load_dwordx4 v25, s[4:7], s42 offen offset:1024 sc1 lds
    buffer_load_dwordx4 v26, s[4:7], s42 offen offset:2048 sc1 lds
    buffer_load_dwordx4 v27, s[4:7], s42 offen offset:3072 sc1 lds
    s_lshl_b32 s44, s44, 7
    s_add_u32 s44, s44, s53
    s_mul_i32 s43, s23, 36864
    s_add_u32 m0, s26, s29
    s_add_u32 s43, s43, s44
    buffer_load_dwordx4 v30, s[8:11], s43 offen offset:0 lds
    buffer_load_dwordx4 v31, s[8:11], s43 offen offset:1024 lds
    buffer_load_dwordx4 v32, s[8:11], s43 offen offset:2048 lds
    buffer_load_dwordx4 v33, s[8:11], s43 offen offset:3072 lds
    s_add_u32 s55, s55, 1
    s_add_u32 s26, s26, 34816
    s_cmp_eq_u32 s26, 139264
    s_cselect_b32 s26, 0, s26
    s_add_u32 s4, s96, 0x1400000
    s_addc_u32 s5, s97, 0
    s_mov_b32 s6, 0x480000
    s_mov_b32 s7, 0x00020000
    s_cmp_ge_u32 s55, 9
    s_cselect_b32 s8, s76, s74
    s_cselect_b32 s9, s77, s75
    s_cselect_b32 s44, 9, 0
    s_mov_b32 s10, 663552
    s_mov_b32 s11, 0x00020000
    s_lshl_b32 s42, s55, 18
    s_add_u32 s42, s42, s52
    s_add_u32 m0, s26, s40
    s_sub_u32 s44, s55, s44
    buffer_load_dwordx4 v24, s[4:7], s42 offen offset:0 sc1 lds
    buffer_load_dwordx4 v25, s[4:7], s42 offen offset:1024 sc1 lds
    buffer_load_dwordx4 v26, s[4:7], s42 offen offset:2048 sc1 lds
    buffer_load_dwordx4 v27, s[4:7], s42 offen offset:3072 sc1 lds
    s_lshl_b32 s44, s44, 7
    s_add_u32 s44, s44, s53
    s_mul_i32 s43, s23, 36864
    s_add_u32 m0, s26, s29
    s_add_u32 s43, s43, s44
    buffer_load_dwordx4 v30, s[8:11], s43 offen offset:0 lds
    buffer_load_dwordx4 v31, s[8:11], s43 offen offset:1024 lds
    buffer_load_dwordx4 v32, s[8:11], s43 offen offset:2048 lds
    buffer_load_dwordx4 v33, s[8:11], s43 offen offset:3072 lds
    s_add_u32 s55, s55, 1
    s_add_u32 s26, s26, 34816
    s_cmp_eq_u32 s26, 139264
    s_cselect_b32 s26, 0, s26
l3b_j:
    s_add_u32 s4, s96, 0x1400000
    s_addc_u32 s5, s97, 0
    s_mov_b32 s6, 0x480000
    s_mov_b32 s7, 0x00020000
    s_cmp_ge_u32 s55, 9
    s_cselect_b32 s8, s76, s74
    s_cselect_b32 s9, s77, s75
    s_cselect_b32 s44, 9, 0
    s_mov_b32 s10, 663552
    s_mov_b32 s11, 0x00020000
    s_lshl_b32 s42, s55, 18
    s_add_u32 s42, s42, s52
    s_add_u32 m0, s26, s40
    s_sub_u32 s44, s55, s44
    buffer_load_dwordx4 v24, s[4:7], s42 offen offset:0 sc1 lds
    buffer_load_dwordx4 v25, s[4:7], s42 offen offset:1024 sc1 lds
    buffer_load_dwordx4 v26, s[4:7], s42 offen offset:2048 sc1 lds
    buffer_load_dwordx4 v27, s[4:7], s42 offen offset:3072 sc1 lds
    s_lshl_b32 s44, s44, 7
    s_add_u32 s44, s44, s53
    s_mul_i32 s43, s23, 36864
    s_add_u32 m0, s26, s29
    s_add_u32 s43, s43, s44
    buffer_load_dwordx4 v30, s[8:11], s43 offen offset:0 lds
    buffer_load_dwordx4 v31, s[8:11], s43 offen offset:1024 lds
    buffer_load_dwordx4 v32, s[8:11], s43 offen offset:2048 lds
    buffer_load_dwordx4 v33, s[8:11], s43 offen offset:3072 lds
    s_add_u32 s55, s55, 1
    s_add_u32 s26, s26, 34816
    s_cmp_eq_u32 s26, 139264
    s_cselect_b32 s26, 0, s26
    s_waitcnt vmcnt(24)
    v_lshlrev_b32 v172, 16, v172
    v_lshlrev_b32 v174, 16, v174
    v_lshlrev_b32 v76, 16, v162
    v_and_b32 v77, 0xffff0000, v162
    v_lshlrev_b32 v78, 16, v163
    v_and_b32 v79, 0xffff0000, v163
    v_lshlrev_b32 v116, 16, v150
    v_and_b32 v117, 0xffff0000, v150
    v_lshlrev_b32 v118, 16, v151
    v_and_b32 v119, 0xffff0000, v151
    v_mul_f32 v144, v76, v169
    v_mul_f32 v145, v77, v169
    v_mul_f32 v146, v78, v169
    v_mul_f32 v147, v79, v169
    v_add_f32 v48, v116, v172
    v_add_f32 v49, v117, v172
    v_add_f32 v50, v118, v172
    v_add_f32 v51, v119, v172
    v_sub_f32 v116, v116, v168
    v_sub_f32 v117, v117, v168
    v_sub_f32 v118, v118, v168
    v_sub_f32 v119, v119, v168
    v_fmac_f32 v48, v116, v144
    v_fmac_f32 v49, v117, v145
    v_fmac_f32 v50, v118, v146
    v_fmac_f32 v51, v119, v147
    v_lshlrev_b32 v116, 16, v152
    v_and_b32 v117, 0xffff0000, v152
    v_lshlrev_b32 v118, 16, v153
    v_and_b32 v119, 0xffff0000, v153
    v_mul_f32 v144, v76, v171
    v_mul_f32 v145, v77, v171
    v_mul_f32 v146, v78, v171
    v_mul_f32 v147, v79, v171
    v_add_f32 v52, v116, v174
    v_add_f32 v53, v117, v174
    v_add_f32 v54, v118, v174
    v_add_f32 v55, v119, v174
    v_sub_f32 v116, v116, v170
    v_sub_f32 v117, v117, v170
    v_sub_f32 v118, v118, v170
    v_sub_f32 v119, v119, v170
    v_fmac_f32 v52, v116, v144
    v_fmac_f32 v53, v117, v145
    v_fmac_f32 v54, v118, v146
    v_fmac_f32 v55, v119, v147
    v_lshlrev_b32 v76, 16, v164
    v_and_b32 v77, 0xffff0000, v164
    v_lshlrev_b32 v78, 16, v165
    v_and_b32 v79, 0xffff0000, v165
    v_lshlrev_b32 v116, 16, v154
    v_and_b32 v117, 0xffff0000, v154
    v_lshlrev_b32 v118, 16, v155
    v_and_b32 v119, 0xffff0000, v155
    v_mul_f32 v144, v76, v169
    v_mul_f32 v145, v77, v169
    v_mul_f32 v146, v78, v169
    v_mul_f32 v147, v79, v169
    v_add_f32 v56, v116, v172
    v_add_f32 v57, v117, v172
    v_add_f32 v58, v118, v172
    v_add_f32 v59, v119, v172
    v_sub_f32 v116, v116, v168
    v_sub_f32 v117, v117, v168
    v_sub_f32 v118, v118, v168
    v_sub_f32 v119, v119, v168
    v_fmac_f32 v56, v116, v144
    v_fmac_f32 v57, v117, v145
    v_fmac_f32 v58, v118, v146
    v_fmac_f32 v59, v119, v147
    v_lshlrev_b32 v116, 16, v156
    v_and_b32 v117, 0xffff0000, v156
    v_lshlrev_b32 v118, 16, v157
    v_and_b32 v119, 0xffff0000, v157
    v_mul_f32 v144, v76, v171
    v_mul_f32 v145, v77, v171
    v_mul_f32 v146, v78, v171
    v_mul_f32 v147, v79, v171
    v_add_f32 v60, v116, v174
    v_add_f32 v61, v117, v174
    v_add_f32 v62, v118, v174
    v_add_f32 v63, v119, v174
    v_sub_f32 v116, v116, v170
    v_sub_f32 v117, v117, v170
    v_sub_f32 v118, v118, v170
    v_sub_f32 v119, v119, v170
    v_fmac_f32 v60, v116, v144
    v_fmac_f32 v61, v117, v145
    v_fmac_f32 v62, v118, v146
    v_fmac_f32 v63, v119, v147
    v_lshlrev_b32 v76, 16, v166
    v_and_b32 v77, 0xffff0000, v166
    v_lshlrev_b32 v78, 16, v167
    v_and_b32 v79, 0xffff0000, v167
    v_lshlrev_b32 v116, 16, v158
    v_and_b32 v117, 0xffff0000, v158
    v_lshlrev_b32 v118, 16, v159
    v_and_b32 v119, 0xffff0000, v159
    v_mul_f32 v144, v76, v169
    v_mul_f32 v145, v77, v169
    v_mul_f32 v146, v78, v169
    v_mul_f32 v147, v79, v169
    v_add_f32 v64, v116, v172
    v_add_f32 v65, v117, v172
    v_add_f32 v66, v118, v172
    v_add_f32 v67, v119, v172
    v_sub_f32 v116, v116, v168
    v_sub_f32 v117, v117, v168
    v_sub_f32 v118, v118, v168
    v_sub_f32 v119, v119, v168
    v_fmac_f32 v64, v116, v144
    v_fmac_f32 v65, v117, v145
    v_fmac_f32 v66, v118, v146
    v_fmac_f32 v67, v119, v147
    v_lshlrev_b32 v116, 16, v160
    v_and_b32 v117, 0xffff0000, v160
    v_lshlrev_b32 v118, 16, v161
    v_and_b32 v119, 0xffff0000, v161
    v_mul_f32 v144, v76, v171
    v_mul_f32 v145, v77, v171
    v_mul_f32 v146, v78, v171
    v_mul_f32 v147, v79, v171
    v_add_f32 v68, v116, v174
    v_add_f32 v69, v117, v174
    v_add_f32 v70, v118, v174
    v_add_f32 v71, v119, v174
    v_sub_f32 v116, v116, v170
    v_sub_f32 v117, v117, v170
    v_sub_f32 v118, v118, v170
    v_sub_f32 v119, v119, v170
    v_fmac_f32 v68, v116, v144
    v_fmac_f32 v69, v117, v145
    v_fmac_f32 v70, v118, v146
    v_fmac_f32 v71, v119, v147
    s_add_u32 s4, s96, 0x1400000
    s_addc_u32 s5, s97, 0
    s_mov_b32 s6, 0x480000
    s_mov_b32 s7, 0x00020000
    s_cmp_ge_u32 s55, 9
    s_cselect_b32 s8, s76, s74
    s_cselect_b32 s9, s77, s75
    s_cselect_b32 s44, 9, 0
    s_mov_b32 s10, 663552
    s_mov_b32 s11, 0x00020000
    s_lshl_b32 s42, s55, 18
    s_add_u32 s42, s42, s52
    s_add_u32 m0, s26, s40
    s_sub_u32 s44, s55, s44
    s_waitcnt vmcnt(16)
    s_barrier
    buffer_load_dwordx4 v24, s[4:7], s42 offen offset:0 sc1 lds
    buffer_load_dwordx4 v25, s[4:7], s42 offen offset:1024 sc1 lds
    buffer_load_dwordx4 v26, s[4:7], s42 offen offset:2048 sc1 lds
    buffer_load_dwordx4 v27, s[4:7], s42 offen offset:3072 sc1 lds
    s_lshl_b32 s44, s44, 7
    s_add_u32 s44, s44, s53
    s_mul_i32 s43, s23, 36864
    s_add_u32 m0, s26, s29
    s_add_u32 s43, s43, s44
    buffer_load_dwordx4 v30, s[8:11], s43 offen offset:0 lds
    buffer_load_dwordx4 v31, s[8:11], s43 offen offset:1024 lds
    buffer_load_dwordx4 v32, s[8:11], s43 offen offset:2048 lds
    buffer_load_dwordx4 v33, s[8:11], s43 offen offset:3072 lds
    s_add_u32 s55, s55, 1
    s_add_u32 s26, s26, 34816
    s_cmp_eq_u32 s26, 139264
    s_cselect_b32 s26, 0, s26
    s_waitcnt vmcnt(16)
    s_barrier
    s_cmp_eq_u32 s38, 4
    s_cbranch_scc1 nf_28
    s_add_u32 s4, s96, 0x1400000
    s_addc_u32 s5, s97, 0
    s_mov_b32 s6, 0x480000
    s_mov_b32 s7, 0x00020000
    s_cmp_ge_u32 s55, 9
    s_cselect_b32 s8, s76, s74
    s_cselect_b32 s9, s77, s75
    s_cselect_b32 s44, 9, 0
    s_mov_b32 s10, 663552
    s_mov_b32 s11, 0x00020000
    s_lshl_b32 s42, s55, 18
    s_add_u32 s42, s42, s52
    s_add_u32 m0, s26, s40
    s_sub_u32 s44, s55, s44
    s_waitcnt vmcnt(8)
    s_barrier
    buffer_load_dwordx4 v24, s[4:7], s42 offen offset:0 sc1 lds
    buffer_load_dwordx4 v25, s[4:7], s42 offen offset:1024 sc1 lds
    buffer_load_dwordx4 v26, s[4:7], s42 offen offset:2048 sc1 lds
    buffer_load_dwordx4 v27, s[4:7], s42 offen offset:3072 sc1 lds
    s_lshl_b32 s44, s44, 7
    s_add_u32 s44, s44, s53
    s_mul_i32 s43, s23, 36864
    s_add_u32 m0, s26, s29
    s_add_u32 s43, s43, s44
    buffer_load_dwordx4 v30, s[8:11], s43 offen offset:0 lds
    buffer_load_dwordx4 v31, s[8:11], s43 offen offset:1024 lds
    buffer_load_dwordx4 v32, s[8:11], s43 offen offset:2048 lds
    buffer_load_dwordx4 v33, s[8:11], s43 offen offset:3072 lds
    s_add_u32 s55, s55, 1
    s_add_u32 s26, s26, 34816
    s_cmp_eq_u32 s26, 139264
    s_cselect_b32 s26, 0, s26
nf_28:
    s_mov_b32 s4, s88
    s_mov_b32 s5, s89
    s_mov_b32 s6, 0x1200000
    s_mov_b32 s7, 0x00020000
    s_add_u32 s8, s96, 0x400000
    s_addc_u32 s9, s97, 0
    s_mov_b32 s10, 0x3510080
    s_mov_b32 s11, 0x00020000
    s_mul_i32 s44, s34, 4718592
    s_add_u32 s52, s52, s44
    s_mov_b32 s55, 0
    s_mov_b32 s62, s26
    s_and_b32 s45, s55, 3
    s_add_u32 s44, s55, 4
    s_cmp_lt_u32 s44, 18
    s_cselect_b32 s44, s44, s45
    s_cmp_eq_u32 s45, s46
    s_cselect_b32 s44, s44, s55
    s_lshl_b32 s42, s44, 18
    s_add_u32 s42, s42, s52
    s_mul_i32 s45, s44, 73728
    s_add_u32 s45, s45, s54
    s_add_u32 s43, s45, s40
    s_add_u32 m0, s26, s40
    s_nop 0
    s_waitcnt vmcnt(8)
    s_barrier
    buffer_load_dwordx4 v24, s[4:7], s42 offen offset:0 lds
    buffer_load_dwordx4 v25, s[4:7], s42 offen offset:1024 lds
    buffer_load_dwordx4 v26, s[4:7], s42 offen offset:2048 lds
    buffer_load_dwordx4 v27, s[4:7], s42 offen offset:3072 lds
    s_add_u32 s55, s55, 1
    s_add_u32 s26, s26, 34816
    s_cmp_eq_u32 s26, 139264
    s_cselect_b32 s26, 0, s26
    s_cmp_lg_u32 s23, 0
    s_waitcnt vmcnt(4)
    s_barrier
    s_cbranch_scc1 lg_29
    buffer_load_dwordx2 v[252:253], v248, s[16:19], s61 offen sc1
lg_29:
    s_and_b32 s45, s55, 3
    s_add_u32 s44, s55, 4
    s_cmp_lt_u32 s44, 18
    s_cselect_b32 s44, s44, s45
    s_cmp_eq_u32 s45, s46
    s_cselect_b32 s44, s44, s55
    s_lshl_b32 s42, s44, 18
    s_add_u32 s42, s42, s52
    s_mul_i32 s45, s44, 73728
    s_add_u32 s45, s45, s54
    s_add_u32 s43, s45, s40
    s_add_u32 m0, s26, s40
    s_nop 0
    buffer_load_dwordx4 v24, s[4:7], s42 offen offset:0 lds
    buffer_load_dwordx4 v25, s[4:7], s42 offen offset:1024 lds
    buffer_load_dwordx4 v26, s[4:7], s42 offen offset:2048 lds
    buffer_load_dwordx4 v27, s[4:7], s42 offen offset:3072 lds
    s_add_u32 s55, s55, 1
    s_add_u32 s26, s26, 34816
    s_cmp_eq_u32 s26, 139264
    s_cselect_b32 s26, 0, s26
    s_cmp_lg_u32 s23, 0
    s_cbranch_scc1 lg_30
    s_mov_b32 s59, 0
    s_mov_b32 s56, 0xffffffff
    s_mov_b32 s57, 0x3fffff
    s_waitcnt vmcnt(4)
gt_33:
    v_cmp_ne_u64 vcc, v[252:253], v[250:251]
    s_add_u32 s59, s59, 1
    s_and_b64 vcc, vcc, s[56:57]
    s_cbranch_scc0 gt_34
    s_cmp_gt_u32 s59, 16384
    s_cbranch_scc1 gt_34
    s_sleep 4
    buffer_load_dwordx2 v[252:253], v248, s[16:19], s61 offen sc1
    s_waitcnt vmcnt(0)
    s_branch gt_33
gt_34:
    v_mov_b32 v40, 1
    ds_write_b32 v41, v40 offset:12
    s_branch lg_31
lg_30:
    s_mov_b32 s59, 0
lg_32:
    ds_read_b32 v40, v41 offset:12
    s_add_u32 s59, s59, 1
    s_waitcnt lgkmcnt(0)
    v_readfirstlane_b32 s58, v40
    s_cmp_gt_u32 s59, 1048576
    s_cbranch_scc1 lg_31
    s_cmp_eq_u32 s58, 0
    s_cbranch_scc1 lg_32
lg_31:
    s_mov_b32 s26, s62
    s_mov_b32 s55, 0
    s_and_b32 s45, s55, 3
    s_add_u32 s44, s55, 4
    s_cmp_lt_u32 s44, 18
    s_cselect_b32 s44, s44, s45
    s_cmp_eq_u32 s45, s46
    s_cselect_b32 s44, s44, s55
    s_lshl_b32 s42, s44, 18
    s_add_u32 s42, s42, s52
    s_mul_i32 s45, s44, 73728
    s_add_u32 s45, s45, s54
    s_add_u32 s43, s45, s40
    s_add_u32 m0, s26, s29
    s_nop 0
    buffer_load_dwordx4 v28, s[8:11], s43 offen offset:0 sc1 lds
    buffer_load_dwordx4 v28, s[8:11], s43 offen offset:1024 sc1 lds
    buffer_load_dwordx4 v28, s[8:11], s43 offen offset:2048 sc1 lds
    buffer_load_dwordx4 v28, s[8:11], s43 offen offset:3072 sc1 lds
    s_add_u32 s55, s55, 1
    s_add_u32 s26, s26, 34816
    s_cmp_eq_u32 s26, 139264
    s_cselect_b32 s26, 0, s26
    s_and_b32 s45, s55, 3
    s_add_u32 s44, s55, 4
    s_cmp_lt_u32 s44, 18
    s_cselect_b32 s44, s44, s45
    s_cmp_eq_u32 s45, s46
    s_cselect_b32 s44, s44, s55
    s_lshl_b32 s42, s44, 18
    s_add_u32 s42, s42, s52
    s_mul_i32 s45, s44, 73728
    s_add_u32 s45, s45, s54
    s_add_u32 s43, s45, s40
    s_add_u32 m0, s26, s29
    s_nop 0
    buffer_load_dwordx4 v28, s[8:11], s43 offen offset:0 sc1 lds
    buffer_load_dwordx4 v28, s[8:11], s43 offen offset:1024 sc1 lds
    buffer_load_dwordx4 v28, s[8:11], s43 offen offset:2048 sc1 lds
    buffer_load_dwordx4 v28, s[8:11], s43 offen offset:3072 sc1 lds
    s_add_u32 s55, s55, 1
    s_add_u32 s26, s26, 34816
    s_cmp_eq_u32 s26, 139264
    s_cselect_b32 s26, 0, s26
    s_and_b32 s45, s55, 3
    s_add_u32 s44, s55, 4
    s_cmp_lt_u32 s44, 18
    s_cselect_b32 s44, s44, s45
    s_cmp_eq_u32 s45, s46
    s_cselect_b32 s44, s44, s55
    s_lshl_b32 s42, s44, 18
    s_add_u32 s42, s42, s52
    s_mul_i32 s45, s44, 73728
    s_add_u32 s45, s45, s54
    s_add_u32 s43, s45, s40
    s_add_u32 m0, s26, s40
    s_nop 0
    s_waitcnt vmcnt(4)
    s_barrier
    buffer_load_dwordx4 v24, s[4:7], s42 offen offset:0 lds
    buffer_load_dwordx4 v25, s[4:7], s42 offen offset:1024 lds
    buffer_load_dwordx4 v26, s[4:7], s42 offen offset:2048 lds
    buffer_load_dwordx4 v27, s[4:7], s42 offen offset:3072 lds
    s_add_u32 m0, s26, s29
    s_nop 0
    buffer_load_dwordx4 v28, s[8:11], s43 offen offset:0 sc1 lds
    buffer_load_dwordx4 v28, s[8:11], s43 offen offset:1024 sc1 lds
    buffer_load_dwordx4 v28, s[8:11], s43 offen offset:2048 sc1 lds
    buffer_load_dwordx4 v28, s[8:11], s43 offen offset:3072 sc1 lds
    s_add_u32 s55, s55, 1
    s_add_u32 s26, s26, 34816
    s_cmp_eq_u32 s26, 139264
    s_cselect_b32 s26, 0, s26
    s_and_b32 s45, s55, 3
    s_add_u32 s44, s55, 4
    s_cmp_lt_u32 s44, 18
    s_cselect_b32 s44, s44, s45
    s_cmp_eq_u32 s45, s46
    s_cselect_b32 s44, s44, s55
    s_lshl_b32 s42, s44, 18
    s_add_u32 s42, s42, s52
    s_mul_i32 s45, s44, 73728
    s_add_u32 s45, s45, s54
    s_add_u32 s43, s45, s40
    s_add_u32 m0, s26, s40
    s_nop 0
    s_waitcnt vmcnt(8)
    s_barrier
    buffer_load_dwordx4 v24, s[4:7], s42 offen offset:0 lds
    buffer_load_dwordx4 v25, s[4:7], s42 offen offset:1024 lds
    buffer_load_dwordx4 v26, s[4:7], s42 offen offset:2048 lds
    buffer_load_dwordx4 v27, s[4:7], s42 offen offset:3072 lds
    s_add_u32 m0, s26, s29
    s_nop 0
    buffer_load_dwordx4 v28, s[8:11], s43 offen offset:0 sc1 lds
    buffer_load_dwordx4 v28, s[8:11], s43 offen offset:1024 sc1 lds
    buffer_load_dwordx4 v28, s[8:11], s43 offen offset:2048 sc1 lds
    buffer_load_dwordx4 v28, s[8:11], s43 offen offset:3072 sc1 lds
    s_add_u32 s55, s55, 1
    s_add_u32 s26, s26, 34816
    s_cmp_eq_u32 s26, 139264
    s_cselect_b32 s26, 0, s26
    s_mov_b32 s27, 7
l3b_u:
    s_and_b32 s45, s55, 3
    s_add_u32 s44, s55, 4
    s_cmp_lt_u32 s44, 18
    s_cselect_b32 s44, s44, s45
    s_cmp_eq_u32 s45, s46
    s_cselect_b32 s44, s44, s55
    s_lshl_b32 s42, s44, 18
    s_add_u32 s42, s42, s52
    s_mul_i32 s45, s44, 73728
    s_add_u32 s45, s45, s54
    s_add_u32 s43, s45, s40
    s_add_u32 m0, s26, s40
    s_nop 0
    s_waitcnt vmcnt(8)
    s_barrier
    buffer_load_dwordx4 v24, s[4:7], s42 offen offset:0 lds
    buffer_load_dwordx4 v25, s[4:7], s42 offen offset:1024 lds
    buffer_load_dwordx4 v26, s[4:7], s42 offen offset:2048 lds
    buffer_load_dwordx4 v27, s[4:7], s42 offen offset:3072 lds
    s_add_u32 m0, s26, s29
    s_nop 0
    buffer_load_dwordx4 v28, s[8:11], s43 offen offset:0 sc1 lds
    buffer_load_dwordx4 v28, s[8:11], s43 offen offset:1024 sc1 lds
    buffer_load_dwordx4 v28, s[8:11], s43 offen offset:2048 sc1 lds
    buffer_load_dwordx4 v28, s[8:11], s43 offen offset:3072 sc1 lds
    s_add_u32 s55, s55, 1
    s_add_u32 s26, s26, 34816
    s_cmp_eq_u32 s26, 139264
    s_cselect_b32 s26, 0, s26
    s_and_b32 s45, s55, 3
    s_add_u32 s44, s55, 4
    s_cmp_lt_u32 s44, 18
    s_cselect_b32 s44, s44, s45
    s_cmp_eq_u32 s45, s46
    s_cselect_b32 s44, s44, s55
    s_lshl_b32 s42, s44, 18
    s_add_u32 s42, s42, s52
    s_mul_i32 s45, s44, 73728
    s_add_u32 s45, s45, s54
    s_add_u32 s43, s45, s40
    s_add_u32 m0, s26, s40
    s_nop 0
    s_waitcnt vmcnt(8)
    s_barrier
    buffer_load_dwordx4 v24, s[4:7], s42 offen offset:0 lds
    buffer_load_dwordx4 v25, s[4:7], s42 offen offset:1024 lds
    buffer_load_dwordx4 v26, s[4:7], s42 offen offset:2048 lds
    buffer_load_dwordx4 v27, s[4:7], s42 offen offset:3072 lds
    s_add_u32 m0, s26, s29
    s_nop 0
    buffer_load_dwordx4 v28, s[8:11], s43 offen offset:0 sc1 lds
    buffer_load_dwordx4 v28, s[8:11], s43 offen offset:1024 sc1 lds
    buffer_load_dwordx4 v28, s[8:11], s43 offen offset:2048 sc1 lds
    buffer_load_dwordx4 v28, s[8:11], s43 offen offset:3072 sc1 lds
    s_add_u32 s55, s55, 1
    s_add_u32 s26, s26, 34816
    s_cmp_eq_u32 s26, 139264
    s_cselect_b32 s26, 0, s26
    s_sub_u32 s27, s27, 1
    s_cmp_lg_u32 s27, 0
    s_cbranch_scc1 l3b_u
    s_waitcnt vmcnt(8)
    s_barrier
    s_waitcnt vmcnt(0)
    s_barrier
    s_branch fin
l3_entry:
    s_sub_u32 s23, s20, 4
    s_lshl_b32 s40, s23, 12
    v_lshrrev_b32 v3, 4, v2
    v_and_b32 v4, 15, v2
    v_lshlrev_b32 v6, 1, v3
    v_xor_b32 v7, v4, v6
    v_xor_b32 v8, 8, v7
    s_movk_i32 s44, 9216
    v_mul_lo_u32 v5, v3, s44
    v_lshl_add_u32 v20, v7, 4, v5
    v_lshl_add_u32 v21, v8, 4, v5
    v_add_u32 v22, 0x11800, v20
    v_add_u32 v23, 0x1a400, v21
    v_add_u32 v21, 0x8c00, v21
    s_movk_i32 s44, 4096
    v_mul_lo_u32 v5, v3, s44
    v_lshl_add_u32 v24, v7, 4, v5
    v_lshl_add_u32 v25, v8, 4, v5
    v_add_u32 v26, 0x7800, v24
    v_add_u32 v27, 0xb400, v25
    v_add_u32 v25, 0x3c00, v25
    v_lshlrev_b32 v28, 4, v2
    v_lshrrev_b32 v5, 3, v2
    v_cmp_eq_u32 vcc, 3, v5
    v_add_u32 v5, 0x3000080, v28
    s_nop 0
    v_cndmask_b32 v28, v28, v5, vcc
    v_lshrrev_b32 v3, 3, v2
    v_and_b32 v4, 7, v2
    v_xor_b32 v4, v4, v3
    s_movk_i32 s44, 1152
    v_mul_lo_u32 v5, v3, s44
    v_lshl_add_u32 v30, v4, 4, v5
    v_add_u32 v31, 0x2000, v30
    v_add_u32 v32, 0x4000, v30
    v_add_u32 v33, 0x6000, v30
    s_lshl_b32 s52, s23, 16
    s_lshl_b32 s44, s35, 8
    s_add_u32 s52, s52, s44
    s_mul_i32 s53, s36, 165888
    s_mul_i32 s54, s36, 18432
    s_mul_i32 s44, s34, 1327104
    s_add_u32 s54, s54, s44
    s_mov_b32 s55, s39
    s_add_u32 s46, s36, s35
    s_and_b32 s46, s46, 3
    s_lshl_b32 s47, s23, 10
    s_add_u32 s47, s47, 32768
    s_add_u32 s29, s40, 16384
    v_mov_b32 v41, 163776
    ds_read_b64 v[250:251], v41
    s_add_u32 s16, s96, 0x1910000
    s_addc_u32 s17, s97, 0
    s_mov_b32 s18, 0x10000
    s_mov_b32 s19, 0x00020000
    s_lshr_b32 s60, s35, 1
    s_lshl_b32 s60, s60, 9
    s_add_u32 s60, s60, 16384
    s_lshl_b32 s61, s36, 2
    s_add_u32 s61, s61, s34
    s_lshl_b32 s61, s61, 9
    s_add_u32 s61, s61, 8192
    s_waitcnt lgkmcnt(0)
    s_cmp_lg_u32 s23, 0
    s_cbranch_scc1 lg_35
    buffer_load_dwordx2 v[252:253], v248, s[16:19], s60 offen sc1
lg_35:
    s_cmp_lg_u32 s23, 0
    s_cbranch_scc1 lg_36
    s_mov_b32 s59, 0
    s_mov_b32 s56, 0xffffffff
    s_mov_b32 s57, 0xf
    s_waitcnt vmcnt(0)
gt_39:
    v_cmp_ne_u64 vcc, v[252:253], v[250:251]
    s_add_u32 s59, s59, 1
    s_and_b64 vcc, vcc, s[56:57]
    s_cbranch_scc0 gt_40
    s_cmp_gt_u32 s59, 16384
    s_cbranch_scc1 gt_40
    s_sleep 4
    buffer_load_dwordx2 v[252:253], v248, s[16:19], s60 offen sc1
    s_waitcnt vmcnt(0)
    s_branch gt_39
gt_40:
    v_mov_b32 v40, 1
    ds_write_b32 v41, v40 offset:8
    s_branch lg_37
lg_36:
    s_mov_b32 s59, 0
lg_38:
    ds_read_b32 v40, v41 offset:8
    s_add_u32 s59, s59, 1
    s_waitcnt lgkmcnt(0)
    v_readfirstlane_b32 s58, v40
    s_cmp_gt_u32 s59, 1048576
    s_cbranch_scc1 lg_37
    s_cmp_eq_u32 s58, 0
    s_cbranch_scc1 lg_38
lg_37:
    v_and_b32 v42, 15, v2
    v_lshrrev_b32 v43, 4, v2
    v_mul_u32_u24 v46, 1152, v42
    v_lshl_add_u32 v46, v43, 3, v46
    v_lshlrev_b32 v47, 1, v46
    v_lshlrev_b32 v43, 3, v43
    v_lshlrev_b32 v45, 3, v42
    v_lshlrev_b32 v42, 1, v42
    s_lshl_b32 s44, s35, 3
    s_lshl_b32 s45, s34, 1
    s_add_u32 s44, s44, s45
    s_mul_i32 s45, s36, 9
    s_add_u32 s45, s45, s23
    s_lshl_b32 s45, s45, 5
    s_mul_i32 s50, s44, 18432
    s_add_u32 s50, s50, s45
    s_add_u32 s51, s50, 18432
    s_lshl_b32 s48, s44, 7
    s_lshl_b32 s49, s44, 5
    s_add_u32 s12, s96, 0x1900000
    s_addc_u32 s13, s97, 0
    s_mov_b32 s14, 0x6000
    s_mov_b32 s15, 0x00020000
    buffer_load_dwordx2 v[168:169], v45, s[12:15], s48 offen offset:0 sc1
    buffer_load_dwordx2 v[170:171], v45, s[12:15], s48 offen offset:128 sc1
    s_mov_b32 s12, s90
    s_mov_b32 s13, s91
    s_mov_b32 s14, 0x1000
    s_mov_b32 s15, 0x00020000
    buffer_load_ushort v172, v42, s[12:15], s49 offen offset:0
    buffer_load_ushort v174, v42, s[12:15], s49 offen offset:32
    s_mov_b32 s12, s80
    s_mov_b32 s13, s81
    s_mov_b32 s14, 0x480
    s_mov_b32 s15, 0x00020000
    buffer_load_dwordx2 v[162:163], v43, s[12:15], s45 offen offset:0
    buffer_load_dwordx2 v[164:165], v43, s[12:15], s45 offen offset:128
    buffer_load_dwordx2 v[166:167], v43, s[12:15], s45 offen offset:256
    s_mov_b32 s12, s64
    s_mov_b32 s13, s65
    s_mov_b32 s14, 0x240000
    s_mov_b32 s15, 0x00020000
    buffer_load_dwordx2 v[150:151], v46, s[12:15], s50 offen offset:0
    buffer_load_dwordx2 v[152:153], v46, s[12:15], s51 offen offset:0
    buffer_load_dwordx2 v[154:155], v46, s[12:15], s50 offen offset:128
    buffer_load_dwordx2 v[156:157], v46, s[12:15], s51 offen offset:128
    s_cmp_lg_u32 s23, 0
    s_cbranch_scc1 bl_41
    buffer_load_dwordx2 v[158:159], v46, s[12:15], s50 offen offset:256
    buffer_load_dwordx2 v[160:161], v46, s[12:15], s51 offen offset:256
bl_41:
    s_lshl_b32 s50, s50, 1
    s_lshl_b32 s51, s51, 1
    s_branch l3_main2
fin:
    v_lshlrev_b32 v9, 4, v2
    s_lshl_b32 s44, s35, 2
    s_add_u32 s44, s44, s36
    s_lshl_b32 s44, s44, 2
    s_add_u32 s44, s44, s34
    s_lshl_b32 s43, s44, 7
    s_add_u32 s43, s43, 20480
    s_mul_i32 s47, s44, 36864
    s_lshl_b32 s46, s23, 10
    s_add_u32 s47, s47, s46
    s_add_u32 s48, s34, 1
    s_and_b32 s48, s48, 3
    s_mul_i32 s48, s48, 9216
    s_add_u32 s40, s47, s48
    s_add_u32 s48, s34, 2
    s_and_b32 s48, s48, 3
    s_mul_i32 s48, s48, 9216
    s_add_u32 s41, s47, s48
    s_add_u32 s48, s34, 3
    s_and_b32 s48, s48, 3
    s_mul_i32 s48, s48, 9216
    s_add_u32 s42, s47, s48
    v_add_u32 v15, 4096, v9
    v_add_u32 v18, 8192, v9
    s_lshl_b32 s46, s23, 11
    s_add_u32 s46, s46, 139264
    v_add_u32 v10, s46, v9
    s_lshl_b32 s52, 1, s34
    s_xor_b32 s52, s52, 15
    s_mov_b32 s53, 0
    s_add_u32 s12, s96, 0x2000000
    s_addc_u32 s13, s97, 0
    s_mov_b32 s14, 0x900000
    s_mov_b32 s15, 0x00020000
    s_mov_b32 s8, s92
    s_mov_b32 s9, s93
    s_mov_b32 s10, 0x480000
    s_mov_b32 s11, 0x00020000
    v_cmp_gt_u32 vcc, 4, v2
    s_nop 1
    v_cndmask_b32 v248, 0, v248, vcc
    s_barrier
    s_cmp_lg_u32 s23, 0
    s_cbranch_scc1 lg_42
    buffer_load_dwordx2 v[252:253], v248, s[16:19], s43 offen sc1
lg_42:
    ds_read_b128 v[120:123], v10 offset:0
    ds_read_b128 v[124:127], v10 offset:1024
    ds_read_b128 v[128:131], v10 offset:8192
    ds_read_b128 v[132:135], v10 offset:9216
    ds_read_b128 v[136:139], v10 offset:16384
    ds_read_b128 v[140:143], v10 offset:17408
    s_waitcnt lgkmcnt(0)
    v_pk_add_f32 v[48:49], v[48:49], v[120:121]
    v_pk_add_f32 v[50:51], v[50:51], v[122:123]
    v_pk_add_f32 v[52:53], v[52:53], v[124:125]
    v_pk_add_f32 v[54:55], v[54:55], v[126:127]
    v_pk_add_f32 v[56:57], v[56:57], v[128:129]
    v_pk_add_f32 v[58:59], v[58:59], v[130:131]
    v_pk_add_f32 v[60:61], v[60:61], v[132:133]
    v_pk_add_f32 v[62:63], v[62:63], v[134:135]
    v_pk_add_f32 v[64:65], v[64:65], v[136:137]
    v_pk_add_f32 v[66:67], v[66:67], v[138:139]
    v_pk_add_f32 v[68:69], v[68:69], v[140:141]
    v_pk_add_f32 v[70:71], v[70:71], v[142:143]
    s_cmp_lg_u32 s23, 0
    s_cbranch_scc1 fin_w
    s_mov_b32 s59, 0
    s_waitcnt vmcnt(0)
gt_43:
    v_cmp_ne_u64 vcc, v[252:253], v[250:251]
    s_add_u32 s59, s59, 1
    s_and_b64 vcc, vcc, s[52:53]
    s_cbranch_scc0 gt_44
    s_cmp_gt_u32 s59, 16384
    s_cbranch_scc1 gt_44
    s_sleep 4
    buffer_load_dwordx2 v[252:253], v248, s[16:19], s43 offen sc1
    s_waitcnt vmcnt(0)
    s_branch gt_43
gt_44:
fin_w:
    s_barrier
    s_cmp_lg_u32 s23, 0
    s_cbranch_scc1 fin_b
    buffer_load_dwordx4 v[104:107], v18, s[12:15], s40 offen sc1
    buffer_load_dwordx4 v[108:111], v18, s[12:15], s41 offen sc1
    buffer_load_dwordx4 v[112:115], v18, s[12:15], s42 offen sc1
    buffer_load_dwordx4 v[80:83], v9, s[12:15], s40 offen sc1
    buffer_load_dwordx4 v[84:87], v9, s[12:15], s41 offen sc1
    buffer_load_dwordx4 v[88:91], v9, s[12:15], s42 offen sc1
    buffer_load_dwordx4 v[92:95], v15, s[12:15], s40 offen sc1
    buffer_load_dwordx4 v[96:99], v15, s[12:15], s41 offen sc1
    buffer_load_dwordx4 v[100:103], v15, s[12:15], s42 offen sc1
    s_waitcnt vmcnt(6)
    v_lshlrev_b32 v28, 16, v104
    v_and_b32 v29, 0xffff0000, v104
    v_pk_add_f32 v[64:65], v[64:65], v[28:29]
    v_lshlrev_b32 v30, 16, v105
    v_and_b32 v31, 0xffff0000, v105
    v_pk_add_f32 v[66:67], v[66:67], v[30:31]
    v_lshlrev_b32 v28, 16, v106
    v_and_b32 v29, 0xffff0000, v106
    v_pk_add_f32 v[68:69], v[68:69], v[28:29]
    v_lshlrev_b32 v30, 16, v107
    v_and_b32 v31, 0xffff0000, v107
    v_pk_add_f32 v[70:71], v[70:71], v[30:31]
    v_lshlrev_b32 v28, 16, v108
    v_and_b32 v29, 0xffff0000, v108
    v_pk_add_f32 v[64:65], v[64:65], v[28:29]
    v_lshlrev_b32 v30, 16, v109
    v_and_b32 v31, 0xffff0000, v109
    v_pk_add_f32 v[66:67], v[66:67], v[30:31]
    v_lshlrev_b32 v28, 16, v110
    v_and_b32 v29, 0xffff0000, v110
    v_pk_add_f32 v[68:69], v[68:69], v[28:29]
    v_lshlrev_b32 v30, 16, v111
    v_and_b32 v31, 0xffff0000, v111
    v_pk_add_f32 v[70:71], v[70:71], v[30:31]
    v_lshlrev_b32 v28, 16, v112
    v_and_b32 v29, 0xffff0000, v112
    v_pk_add_f32 v[64:65], v[64:65], v[28:29]
    v_lshlrev_b32 v30, 16, v113
    v_and_b32 v31, 0xffff0000, v113
    v_pk_add_f32 v[66:67], v[66:67], v[30:31]
    v_lshlrev_b32 v28, 16, v114
    v_and_b32 v29, 0xffff0000, v114
    v_pk_add_f32 v[68:69], v[68:69], v[28:29]
    v_lshlrev_b32 v30, 16, v115
    v_and_b32 v31, 0xffff0000, v115
    v_pk_add_f32 v[70:71], v[70:71], v[30:31]
    s_waitcnt vmcnt(3)
    v_lshlrev_b32 v28, 16, v80
    v_and_b32 v29, 0xffff0000, v80
    v_pk_add_f32 v[48:49], v[48:49], v[28:29]
    v_lshlrev_b32 v30, 16, v81
    v_and_b32 v31, 0xffff0000, v81
    v_pk_add_f32 v[50:51], v[50:51], v[30:31]
    v_lshlrev_b32 v28, 16, v82
    v_and_b32 v29, 0xffff0000, v82
    v_pk_add_f32 v[52:53], v[52:53], v[28:29]
    v_lshlrev_b32 v30, 16, v83
    v_and_b32 v31, 0xffff0000, v83
    v_pk_add_f32 v[54:55], v[54:55], v[30:31]
    v_lshlrev_b32 v28, 16, v84
    v_and_b32 v29, 0xffff0000, v84
    v_pk_add_f32 v[48:49], v[48:49], v[28:29]
    v_lshlrev_b32 v30, 16, v85
    v_and_b32 v31, 0xffff0000, v85
    v_pk_add_f32 v[50:51], v[50:51], v[30:31]
    v_lshlrev_b32 v28, 16, v86
    v_and_b32 v29, 0xffff0000, v86
    v_pk_add_f32 v[52:53], v[52:53], v[28:29]
    v_lshlrev_b32 v30, 16, v87
    v_and_b32 v31, 0xffff0000, v87
    v_pk_add_f32 v[54:55], v[54:55], v[30:31]
    v_lshlrev_b32 v28, 16, v88
    v_and_b32 v29, 0xffff0000, v88
    v_pk_add_f32 v[48:49], v[48:49], v[28:29]
    v_lshlrev_b32 v30, 16, v89
    v_and_b32 v31, 0xffff0000, v89
    v_pk_add_f32 v[50:51], v[50:51], v[30:31]
    v_lshlrev_b32 v28, 16, v90
    v_and_b32 v29, 0xffff0000, v90
    v_pk_add_f32 v[52:53], v[52:53], v[28:29]
    v_lshlrev_b32 v30, 16, v91
    v_and_b32 v31, 0xffff0000, v91
    v_pk_add_f32 v[54:55], v[54:55], v[30:31]
    s_waitcnt vmcnt(0)
    buffer_store_dwordx4 v[64:67], v47, s[8:11], s50 offen offset:512
    buffer_store_dwordx4 v[68:71], v47, s[8:11], s51 offen offset:512
    buffer_store_dwordx4 v[48:51], v47, s[8:11], s50 offen offset:0
    buffer_store_dwordx4 v[52:55], v47, s[8:11], s51 offen offset:0
    v_lshlrev_b32 v28, 16, v92
    v_and_b32 v29, 0xffff0000, v92
    v_pk_add_f32 v[56:57], v[56:57], v[28:29]
    v_lshlrev_b32 v30, 16, v93
    v_and_b32 v31, 0xffff0000, v93
    v_pk_add_f32 v[58:59], v[58:59], v[30:31]
    v_lshlrev_b32 v28, 16, v94
    v_and_b32 v29, 0xffff0000, v94
    v_pk_add_f32 v[60:61], v[60:61], v[28:29]
    v_lshlrev_b32 v30, 16, v95
    v_and_b32 v31, 0xffff0000, v95
    v_pk_add_f32 v[62:63], v[62:63], v[30:31]
    v_lshlrev_b32 v28, 16, v96
    v_and_b32 v29, 0xffff0000, v96
    v_pk_add_f32 v[56:57], v[56:57], v[28:29]
    v_lshlrev_b32 v30, 16, v97
    v_and_b32 v31, 0xffff0000, v97
    v_pk_add_f32 v[58:59], v[58:59], v[30:31]
    v_lshlrev_b32 v28, 16, v98
    v_and_b32 v29, 0xffff0000, v98
    v_pk_add_f32 v[60:61], v[60:61], v[28:29]
    v_lshlrev_b32 v30, 16, v99
    v_and_b32 v31, 0xffff0000, v99
    v_pk_add_f32 v[62:63], v[62:63], v[30:31]
    v_lshlrev_b32 v28, 16, v100
    v_and_b32 v29, 0xffff0000, v100
    v_pk_add_f32 v[56:57], v[56:57], v[28:29]
    v_lshlrev_b32 v30, 16, v101
    v_and_b32 v31, 0xffff0000, v101
    v_pk_add_f32 v[58:59], v[58:59], v[30:31]
    v_lshlrev_b32 v28, 16, v102
    v_and_b32 v29, 0xffff0000, v102
    v_pk_add_f32 v[60:61], v[60:61], v[28:29]
    v_lshlrev_b32 v30, 16, v103
    v_and_b32 v31, 0xffff0000, v103
    v_pk_add_f32 v[62:63], v[62:63], v[30:31]
    buffer_store_dwordx4 v[56:59], v47, s[8:11], s50 offen offset:256
    buffer_store_dwordx4 v[60:63], v47, s[8:11], s51 offen offset:256
    s_branch k_done
fin_b:
    buffer_load_dwordx4 v[80:83], v9, s[12:15], s40 offen sc1
    buffer_load_dwordx4 v[84:87], v9, s[12:15], s41 offen sc1
    buffer_load_dwordx4 v[88:91], v9, s[12:15], s42 offen sc1
    buffer_load_dwordx4 v[92:95], v15, s[12:15], s40 offen sc1
    buffer_load_dwordx4 v[96:99], v15, s[12:15], s41 offen sc1
    buffer_load_dwordx4 v[100:103], v15, s[12:15], s42 offen sc1
    s_waitcnt vmcnt(3)
    v_lshlrev_b32 v28, 16, v80
    v_and_b32 v29, 0xffff0000, v80
    v_pk_add_f32 v[48:49], v[48:49], v[28:29]
    v_lshlrev_b32 v30, 16, v81
    v_and_b32 v31, 0xffff0000, v81
    v_pk_add_f32 v[50:51], v[50:51], v[30:31]
    v_lshlrev_b32 v28, 16, v82
    v_and_b32 v29, 0xffff0000, v82
    v_pk_add_f32 v[52:53], v[52:53], v[28:29]
    v_lshlrev_b32 v30, 16, v83
    v_and_b32 v31, 0xffff0000, v83
    v_pk_add_f32 v[54:55], v[54:55], v[30:31]
    v_lshlrev_b32 v28, 16, v84
    v_and_b32 v29, 0xffff0000, v84
    v_pk_add_f32 v[48:49], v[48:49], v[28:29]
    v_lshlrev_b32 v30, 16, v85
    v_and_b32 v31, 0xffff0000, v85
    v_pk_add_f32 v[50:51], v[50:51], v[30:31]
    v_lshlrev_b32 v28, 16, v86
    v_and_b32 v29, 0xffff0000, v86
    v_pk_add_f32 v[52:53], v[52:53], v[28:29]
    v_lshlrev_b32 v30, 16, v87
    v_and_b32 v31, 0xffff0000, v87
    v_pk_add_f32 v[54:55], v[54:55], v[30:31]
    v_lshlrev_b32 v28, 16, v88
    v_and_b32 v29, 0xffff0000, v88
    v_pk_add_f32 v[48:49], v[48:49], v[28:29]
    v_lshlrev_b32 v30, 16, v89
    v_and_b32 v31, 0xffff0000, v89
    v_pk_add_f32 v[50:51], v[50:51], v[30:31]
    v_lshlrev_b32 v28, 16, v90
    v_and_b32 v29, 0xffff0000, v90
    v_pk_add_f32 v[52:53], v[52:53], v[28:29]
    v_lshlrev_b32 v30, 16, v91
    v_and_b32 v31, 0xffff0000, v91
    v_pk_add_f32 v[54:55], v[54:55], v[30:31]
    s_waitcnt vmcnt(0)
    buffer_store_dwordx4 v[48:51], v47, s[8:11], s50 offen offset:0
    buffer_store_dwordx4 v[52:55], v47, s[8:11], s51 offen offset:0
    v_lshlrev_b32 v28, 16, v92
    v_and_b32 v29, 0xffff0000, v92
    v_pk_add_f32 v[56:57], v[56:57], v[28:29]
    v_lshlrev_b32 v30, 16, v93
    v_and_b32 v31, 0xffff0000, v93
    v_pk_add_f32 v[58:59], v[58:59], v[30:31]
    v_lshlrev_b32 v28, 16, v94
    v_and_b32 v29, 0xffff0000, v94
    v_pk_add_f32 v[60:61], v[60:61], v[28:29]
    v_lshlrev_b32 v30, 16, v95
    v_and_b32 v31, 0xffff0000, v95
    v_pk_add_f32 v[62:63], v[62:63], v[30:31]
    v_lshlrev_b32 v28, 16, v96
    v_and_b32 v29, 0xffff0000, v96
    v_pk_add_f32 v[56:57], v[56:57], v[28:29]
    v_lshlrev_b32 v30, 16, v97
    v_and_b32 v31, 0xffff0000, v97
    v_pk_add_f32 v[58:59], v[58:59], v[30:31]
    v_lshlrev_b32 v28, 16, v98
    v_and_b32 v29, 0xffff0000, v98
    v_pk_add_f32 v[60:61], v[60:61], v[28:29]
    v_lshlrev_b32 v30, 16, v99
    v_and_b32 v31, 0xffff0000, v99
    v_pk_add_f32 v[62:63], v[62:63], v[30:31]
    v_lshlrev_b32 v28, 16, v100
    v_and_b32 v29, 0xffff0000, v100
    v_pk_add_f32 v[56:57], v[56:57], v[28:29]
    v_lshlrev_b32 v30, 16, v101
    v_and_b32 v31, 0xffff0000, v101
    v_pk_add_f32 v[58:59], v[58:59], v[30:31]
    v_lshlrev_b32 v28, 16, v102
    v_and_b32 v29, 0xffff0000, v102
    v_pk_add_f32 v[60:61], v[60:61], v[28:29]
    v_lshlrev_b32 v30, 16, v103
    v_and_b32 v31, 0xffff0000, v103
    v_pk_add_f32 v[62:63], v[62:63], v[30:31]
    buffer_store_dwordx4 v[56:59], v47, s[8:11], s50 offen offset:256
    buffer_store_dwordx4 v[60:63], v47, s[8:11], s51 offen offset:256
k_done:
k_end:
    s_endpgm
ln_lo:
    s_sub_u32 s29, s21, 19
    s_lshl_b32 s29, s29, 3
    s_add_u32 s29, s29, s22
    s_cmp_lg_u32 s20, 0
    s_cbranch_scc1 ph_45
    s_lshl_b32 s52, s2, 3
    s_waitcnt vmcnt(0)
    s_mov_b64 exec, 1
    buffer_store_dwordx2 v[250:251], v248, s[16:19], s52 offen sc1
    s_mov_b64 exec, -1
ph_45:
    s_mov_b32 s4, s86
    s_mov_b32 s5, s87
    s_mov_b32 s6, 0x2400
    s_mov_b32 s7, 0x00020000
    s_lshl_b32 s44, s32, 8
    s_lshl_b32 s45, s40, 7
    s_add_u32 s44, s44, s45
    buffer_load_dwordx2 v[24:25], v217, s[4:7], s44 offen offset:0
    buffer_load_dwordx2 v[26:27], v217, s[4:7], s44 offen offset:32
    buffer_load_dwordx2 v[28:29], v217, s[4:7], s44 offen offset:64
    buffer_load_dwordx2 v[30:31], v217, s[4:7], s44 offen offset:96
    s_barrier
    s_branch ln_join
ln_hi:
    s_sub_u32 s29, s21, 19
    s_lshl_b32 s29, s29, 3
    s_add_u32 s29, s29, s22
    v_mov_b32 v216, 0
    v_mov_b32 v217, 0
    v_mov_b32 v215, 0
    s_lshl_b32 s3, s22, 3
    s_mov_b32 s32, 0x206090c
    s_mov_b32 s33, 0xf121518
    s_lshr_b64 s[32:33], s[32:33], s3
    s_and_b32 s32, s32, 0xff
    s_add_u32 s32, s32, s21
    s_cmp_ge_u32 s32, 27
    s_cselect_b32 s3, 27, 0
    s_sub_u32 s32, s32, s3
    s_mul_i32 s3, s22, 27
    s_add_u32 s3, s3, s32
    s_mul_i32 s32, s3, 43691
    s_lshr_b32 s32, s32, 18
    s_mul_i32 s33, s32, 6
    s_sub_u32 s33, s3, s33
    s_lshr_b32 s34, s22, 1
    s_and_b32 s3, s22, 1
    s_lshl_b32 s3, s3, 3
    s_lshr_b32 s35, s21, 2
    s_add_u32 s35, s35, s3
    s_and_b32 s36, s21, 3
    s_cmp_ge_u32 s34, 2
    s_cselect_b32 s38, 4, 5
    s_add_u32 s37, s38, 18
    s_mul_i32 s39, s34, 5
    s_cmp_eq_u32 s34, 3
    s_cselect_b32 s39, 14, s39
    v_lshlrev_b32 v120, 7, v2
    s_waitcnt lgkmcnt(0)
    s_add_u32 s16, s96, 0x1910000
    s_addc_u32 s17, s97, 0
    s_mov_b32 s18, 0x10000
    s_mov_b32 s19, 0x00020000
    s_add_u32 s12, s96, 0x1900000
    s_addc_u32 s13, s97, 0
    s_mov_b32 s14, 0x6000
    s_mov_b32 s15, 0x00020000
    s_lshl_b32 s44, s29, 2
    s_add_u32 s44, s44, s20
    s_sub_u32 s44, s44, 4
    s_sub_u32 s45, s44, 112
    s_cbranch_scc1 ln_ncs
    s_cmp_ge_u32 s45, 72
    s_cselect_b32 s4, s72, s70
    s_cselect_b32 s5, s73, s71
    s_cselect_b32 s46, 72, 0
    s_cselect_b32 s47, 4, 0
    s_mov_b32 s6, 663552
    s_mov_b32 s7, 0x00020000
    s_sub_u32 s45, s45, s46
    s_mul_i32 s46, s45, 9216
    v_lshrrev_b32 v3, 3, v2
    v_and_b32 v4, 7, v2
    v_mul_u32_u24 v5, 1152, v3
    v_lshl_add_u32 v5, v4, 4, v5
    buffer_load_dwordx4 v[16:19], v5, s[4:7], s46 offen offset:0
    buffer_load_dwordx4 v[20:23], v5, s[4:7], s46 offen offset:128
    buffer_load_dwordx4 v[24:27], v5, s[4:7], s46 offen offset:256
    buffer_load_dwordx4 v[28:31], v5, s[4:7], s46 offen offset:384
    buffer_load_dwordx4 v[32:35], v5, s[4:7], s46 offen offset:512
    buffer_load_dwordx4 v[36:39], v5, s[4:7], s46 offen offset:640
    buffer_load_dwordx4 v[40:43], v5, s[4:7], s46 offen offset:768
    buffer_load_dwordx4 v[44:47], v5, s[4:7], s46 offen offset:896
    buffer_load_dwordx4 v[48:51], v5, s[4:7], s46 offen offset:1024
    s_lshl_b32 s45, s45, 6
    s_add_u32 s45, s45, s47
    s_add_u32 s45, s45, 16384
    v_lshlrev_b32 v3, 3, v3
    s_mov_b32 s46, 0x3f803f80
    v_mov_b32 v8, 0
    v_mov_b32 v9, 0
    v_mov_b32 v10, 0
    v_mov_b32 v11, 0
    s_waitcnt vmcnt(8)
    v_dot2_f32_bf16 v8, v16, s46, v8
    v_dot2_f32_bf16 v9, v17, s46, v9
    v_dot2_f32_bf16 v10, v18, s46, v10
    v_dot2_f32_bf16 v11, v19, s46, v11
    s_waitcnt vmcnt(7)
    v_dot2_f32_bf16 v8, v20, s46, v8
    v_dot2_f32_bf16 v9, v21, s46, v9
    v_dot2_f32_bf16 v10, v22, s46, v10
    v_dot2_f32_bf16 v11, v23, s46, v11
    s_waitcnt vmcnt(6)
    v_dot2_f32_bf16 v8, v24, s46, v8
    v_dot2_f32_bf16 v9, v25, s46, v9
    v_dot2_f32_bf16 v10, v26, s46, v10
    v_dot2_f32_bf16 v11, v27, s46, v11
    s_waitcnt vmcnt(5)
    v_dot2_f32_bf16 v8, v28, s46, v8
    v_dot2_f32_bf16 v9, v29, s46, v9
    v_dot2_f32_bf16 v10, v30, s46, v10
    v_dot2_f32_bf16 v11, v31, s46, v11
    s_waitcnt vmcnt(4)
    v_dot2_f32_bf16 v8, v32, s46, v8
    v_dot2_f32_bf16 v9, v33, s46, v9
    v_dot2_f32_bf16 v10, v34, s46, v10
    v_dot2_f32_bf16 v11, v35, s46, v11
    s_waitcnt vmcnt(3)
    v_dot2_f32_bf16 v8, v36, s46, v8
    v_dot2_f32_bf16 v9, v37, s46, v9
    v_dot2_f32_bf16 v10, v38, s46, v10
    v_dot2_f32_bf16 v11, v39, s46, v11
    s_waitcnt vmcnt(2)
    v_dot2_f32_bf16 v8, v40, s46, v8
    v_dot2_f32_bf16 v9, v41, s46, v9
    v_dot2_f32_bf16 v10, v42, s46, v10
    v_dot2_f32_bf16 v11, v43, s46, v11
    s_waitcnt vmcnt(1)
    v_dot2_f32_bf16 v8, v44, s46, v8
    v_dot2_f32_bf16 v9, v45, s46, v9
    v_dot2_f32_bf16 v10, v46, s46, v10
    v_dot2_f32_bf16 v11, v47, s46, v11
    s_waitcnt vmcnt(0)
    v_dot2_f32_bf16 v8, v48, s46, v8
    v_dot2_f32_bf16 v9, v49, s46, v9
    v_dot2_f32_bf16 v10, v50, s46, v10
    v_dot2_f32_bf16 v11, v51, s46, v11
    s_nop 2
    v_add_f32 v8, v8, v9
    v_add_f32 v10, v10, v11
    v_add_f32 v8, v8, v10
    s_nop 1
    v_add_f32_dpp v8, v8, v8 quad_perm:[1,0,3,2] row_mask:0xf bank_mask:0xf
    s_nop 1
    v_add_f32_dpp v8, v8, v8 quad_perm:[2,3,0,1] row_mask:0xf bank_mask:0xf
    s_nop 1
    v_add_f32_dpp v8, v8, v8 row_half_mirror row_mask:0xf bank_mask:0xf
    s_mov_b32 exec_lo, 0x01010101
    s_mov_b32 exec_hi, 0x01010101
    buffer_store_dword v8, v3, s[12:15], s45 offen sc1
    s_mov_b64 exec, -1
    s_waitcnt vmcnt(0)
    s_branch ln_nw
ln_ncs:
    s_mov_b32 s4, s86
    s_mov_b32 s5, s87
    s_mov_b32 s6, 0
    s_mov_b32 s45, 0
    s_cmp_eq_u32 s44, 32
    s_cselect_b32 s4, s86, s4
    s_cselect_b32 s5, s87, s5
    s_cselect_b32 s6, 9216, s6
    s_cmp_eq_u32 s44, 33
    s_cselect_b32 s4, s86, s4
    s_cselect_b32 s5, s87, s5
    s_cselect_b32 s6, 9216, s6
    s_cselect_b32 s45, 8192, s45
    s_cmp_eq_u32 s44, 34
    s_cselect_b32 s4, s90, s4
    s_cselect_b32 s5, s91, s5
    s_cselect_b32 s6, 4096, s6
    s_cmp_eq_u32 s44, 35
    s_cselect_b32 s4, s80, s4
    s_cselect_b32 s5, s81, s5
    s_cselect_b32 s6, 1152, s6
    s_cmp_eq_u32 s44, 36
    s_cselect_b32 s4, s66, s4
    s_cselect_b32 s5, s67, s5
    s_cselect_b32 s6, 1152, s6
    s_cmp_eq_u32 s44, 37
    s_cselect_b32 s4, s68, s4
    s_cselect_b32 s5, s69, s5
    s_cselect_b32 s6, 1152, s6
    s_cmp_eq_u32 s44, 38
    s_cselect_b32 s4, s78, s4
    s_cselect_b32 s5, s79, s5
    s_cselect_b32 s6, 1152, s6
    s_mov_b32 s7, 0x00020000
    s_cmp_eq_u32 s6, 0
    s_cbranch_scc1 ln_nt
    buffer_load_dword v121, v120, s[4:7], s45 offen
ln_nt:
    s_cmp_ge_u32 s44, 32
    s_cbranch_scc1 ln_nc
    s_getpc_b64 s[46:47]
ln_pc:
    s_sub_u32 s46, s46, ln_pc-parallel_sum__ssm_conv_s5__mixer_token_mlp__prompt_kernel
    s_subb_u32 s47, s47, 0
    s_and_b32 s45, s44, 3
    s_lshl_b32 s45, s45, 13
    v_add_u32 v122, s45, v120
    s_mov_b32 s45, text_end-parallel_sum__ssm_conv_s5__mixer_token_mlp__prompt_kernel
    v_cmp_gt_u32 vcc, s45, v122
    s_and_saveexec_b64 s[48:49], vcc
    s_cbranch_execz ln_nc2
    global_load_dword v123, v122, s[46:47]
    v_add_u32 v122, 32768, v122
    v_cmp_gt_u32 vcc, s45, v122
    s_and_saveexec_b64 s[48:49], vcc
    s_cbranch_execz ln_nc2
    global_load_dword v124, v122, s[46:47]
    v_add_u32 v122, 32768, v122
ln_nc2:
    s_mov_b64 exec, -1
ln_nc:
    s_mov_b32 s4, s84
    s_mov_b32 s5, s85
    s_mov_b32 s6, 0x1200000
    s_mov_b32 s7, 0x00020000
    s_sub_u32 s45, s44, 40
    s_cbranch_scc1 ln_nw
    s_lshl_b32 s45, s45, 13
    buffer_load_dword v121, v120, s[4:7], s45 offen
    s_add_u32 s45, s45, 589824
ln_nw:
    s_barrier
    s_mov_b32 s60, s94
    s_mov_b32 s61, s95
    s_mov_b32 s62, 0x100
    s_mov_b32 s63, 0x00020000
    v_mov_b32 v249, 0
    buffer_load_dwordx2 v[250:251], v249, s[60:63], 0 offen sc1
    s_barrier
    s_mov_b32 s59, 0
tg_46:
    s_waitcnt vmcnt(0)
    v_readfirstlane_b32 s58, v250
    s_add_u32 s59, s59, 1
    s_cmp_eq_u32 s58, 0
    s_cbranch_scc1 tg_48
    s_sub_u32 s58, s24, s58
    s_cmp_lt_i32 s58, 1500
    s_cbranch_scc1 tg_47
    s_cmp_gt_u32 s59, 64
    s_cbranch_scc1 tg_47
tg_48:
    s_cmp_gt_u32 s59, 16384
    s_cbranch_scc1 tg_47
    s_sleep 2
    s_mov_b32 s60, s94
    s_mov_b32 s61, s95
    s_mov_b32 s62, 0x100
    s_mov_b32 s63, 0x00020000
    v_mov_b32 v249, 0
    buffer_load_dwordx2 v[250:251], v249, s[60:63], 0 offen sc1
    s_branch tg_46
tg_47:
ln_join:
    v_lshlrev_b32 v120, 7, v2
    s_lshl_b32 s23, s29, 3
    s_add_u32 s23, s23, s20
    s_add_u32 s55, s23, 2304
    s_add_u32 s3, s23, 4294967206
    s_cmp_lt_u32 s23, 162
    s_cselect_b32 s3, s55, s3
    s_sub_u32 s58, s3, 2466
    s_bfe_u32 s54, s58, 0x20005
    s_mul_i32 s54, s54, 576
    s_lshr_b32 s55, s58, 7
    s_lshl_b32 s55, s55, 5
    s_add_u32 s54, s54, s55
    s_and_b32 s58, s58, 31
    s_add_u32 s58, s58, s54
    s_cmp_ge_u32 s3, 4770
    s_cselect_b32 s58, 4096, s58
    s_mov_b32 s60, s88
    s_mov_b32 s61, s89
    s_mov_b32 s62, 18874368
    s_sub_u32 s54, s3, 2385
    s_cmp_lt_u32 s3, 2466
    s_cselect_b32 s58, s54, s58
    s_cselect_b32 s60, s76, s60
    s_cselect_b32 s61, s77, s61
    s_cselect_b32 s62, 663552, s62
    s_sub_u32 s54, s3, 2304
    s_cmp_lt_u32 s3, 2385
    s_cselect_b32 s58, s54, s58
    s_cselect_b32 s60, s74, s60
    s_cselect_b32 s61, s75, s61
    s_cselect_b32 s62, 663552, s62
    s_sub_u32 s54, s3, 0
    s_cmp_lt_u32 s3, 2304
    s_cselect_b32 s58, s54, s58
    s_cselect_b32 s60, s84, s60
    s_cselect_b32 s61, s85, s61
    s_cselect_b32 s62, 18874368, s62
    s_mov_b32 s63, 0x00020000
    s_lshl_b32 s58, s58, 13
    buffer_load_dword v121, v120, s[60:63], s58 offen
    s_cmp_ge_u32 s20, 4
    s_cbranch_scc1 l2_entry
    s_cmp_lg_u32 s20, 0
    s_cbranch_scc1 ln_g
    s_sleep 10
    v_lshlrev_b32 v249, 4, v2
    buffer_load_dwordx4 v[240:243], v249, s[16:19], 0 offen sc1
    buffer_load_dwordx4 v[244:247], v249, s[16:19], 0 offen offset:1024 sc1
    s_mov_b32 s59, 0
gw_49:
    s_waitcnt vmcnt(0)
    v_cmp_ne_u64 vcc, v[240:241], v[250:251]
    v_cmp_ne_u64 s[56:57], v[242:243], v[250:251]
    s_or_b64 vcc, vcc, s[56:57]
    v_cmp_ne_u64 s[56:57], v[244:245], v[250:251]
    s_or_b64 vcc, vcc, s[56:57]
    v_cmp_ne_u64 s[56:57], v[246:247], v[250:251]
    s_or_b64 vcc, vcc, s[56:57]
    s_cbranch_scc0 gw_50
    s_add_u32 s59, s59, 1
    s_cmp_gt_u32 s59, 16384
    s_cbranch_scc1 gw_50
    s_sleep 4
    v_lshlrev_b32 v249, 4, v2
    buffer_load_dwordx4 v[240:243], v249, s[16:19], 0 offen sc1
    buffer_load_dwordx4 v[244:247], v249, s[16:19], 0 offen offset:1024 sc1
    s_branch gw_49
gw_50:
ln_g:
    s_waitcnt vmcnt(0)
    s_barrier
    s_branch c2_entry
scan_entry:
    s_sub_u32 s29, s21, 27
    s_lshl_b32 s29, s29, 3
    s_add_u32 s29, s29, s22
    s_mov_b32 s26, 0
    v_lshlrev_b32 v56, 7, v2
    s_lshl_b32 s23, s29, 3
    s_add_u32 s23, s23, s20
    s_add_u32 s23, s23, 2466
    s_cmp_lt_u32 s29, 36
    s_cbranch_scc1 scan2
    s_sub_u32 s58, s23, 2466
    s_bfe_u32 s54, s58, 0x20005
    s_mul_i32 s54, s54, 576
    s_lshr_b32 s55, s58, 7
    s_lshl_b32 s55, s55, 5
    s_add_u32 s54, s54, s55
    s_and_b32 s58, s58, 31
    s_add_u32 s58, s58, s54
    s_cmp_ge_u32 s23, 4770
    s_cselect_b32 s58, 4096, s58
    s_mov_b32 s60, s88
    s_mov_b32 s61, s89
    s_mov_b32 s62, 18874368
    s_sub_u32 s54, s23, 2385
    s_cmp_lt_u32 s23, 2466
    s_cselect_b32 s58, s54, s58
    s_cselect_b32 s60, s76, s60
    s_cselect_b32 s61, s77, s61
    s_cselect_b32 s62, 663552, s62
    s_sub_u32 s54, s23, 2304
    s_cmp_lt_u32 s23, 2385
    s_cselect_b32 s58, s54, s58
    s_cselect_b32 s60, s74, s60
    s_cselect_b32 s61, s75, s61
    s_cselect_b32 s62, 663552, s62
    s_mov_b32 s63, 0x00020000
    s_lshl_b32 s58, s58, 13
    buffer_load_dword v57, v56, s[60:63], s58 offen
    s_add_u32 s23, s23, 320
    s_branch scan_done
scan2:
    v_and_b32 v3, 7, v0
    v_lshrrev_b32 v4, 3, v0
    v_lshlrev_b32 v5, 10, v4
    v_and_b32 v6, 3, v3
    v_lshl_add_u32 v5, v6, 4, v5
    v_lshrrev_b32 v6, 2, v3
    v_lshl_add_u32 v5, v6, 16, v5
    s_lshl_b32 s40, s29, 17
    v_lshlrev_b32 v9, 2, v3
    s_lshl_b32 s41, s29, 5
    s_mov_b32 s4, s66
    s_mov_b32 s5, s67
    s_mov_b32 s6, 0x480
    s_mov_b32 s7, 0x00020000
    buffer_load_dword v10, v9, s[4:7], s41 offen
    s_mov_b32 s4, s68
    s_mov_b32 s5, s69
    s_mov_b32 s6, 0x480
    s_mov_b32 s7, 0x00020000
    buffer_load_dword v11, v9, s[4:7], s41 offen
    s_mov_b32 s4, s78
    s_mov_b32 s5, s79
    s_mov_b32 s6, 0x480
    s_mov_b32 s7, 0x00020000
    buffer_load_dword v12, v9, s[4:7], s41 offen
    s_mov_b32 s44, 0x3fb8aa3b
    s_mov_b32 s45, 0x3e22f983
    s_waitcnt vmcnt(0)
    v_lshlrev_b32 v34, 16, v10
    v_lshlrev_b32 v35, 16, v11
    v_lshlrev_b32 v36, 16, v12
    v_mul_f32 v36, s44, v36
    v_exp_f32 v36, v36
    s_nop 0
    v_cvt_pk_bf16_f32 v36, v36, v36
    v_lshlrev_b32 v36, 16, v36
    v_mul_f32 v37, v36, v34
    v_mul_f32 v38, v36, v35
    v_mul_f32 v37, s44, v37
    v_mul_f32 v38, s45, v38
    v_exp_f32 v37, v37
    v_fract_f32 v38, v38
    v_cos_f32 v39, v38
    v_sin_f32 v38, v38
    s_nop 0
    v_mul_f32 v18, v37, v39
    v_mul_f32 v19, v37, v38
    v_mul_f32 v40, v19, v19
    v_mul_f32 v41, v18, v19
    v_fma_f32 v22, v18, v18, -v40
    v_add_f32 v23, v41, v41
    v_mul_f32 v40, v23, v23
    v_mul_f32 v41, v22, v23
    v_fma_f32 v22, v22, v22, -v40
    v_add_f32 v23, v41, v41
    v_mul_f32 v40, v23, v23
    v_mul_f32 v41, v22, v23
    v_fma_f32 v22, v22, v22, -v40
    v_add_f32 v23, v41, v41
    v_mul_f32 v40, v23, v23
    v_mul_f32 v41, v22, v23
    v_fma_f32 v22, v22, v22, -v40
    v_add_f32 v23, v41, v41
    v_mul_f32 v40, v23, v23
    v_mul_f32 v41, v22, v23
    v_fma_f32 v22, v22, v22, -v40
    v_add_f32 v23, v41, v41
    v_mul_f32 v40, v23, v23
    v_mul_f32 v41, v22, v23
    v_fma_f32 v26, v22, v22, -v40
    v_add_f32 v27, v41, v41
    v_mul_f32 v40, v27, v27
    v_mul_f32 v41, v26, v27
    v_fma_f32 v26, v26, v26, -v40
    v_add_f32 v27, v41, v41
    v_mul_f32 v40, v27, v27
    v_mul_f32 v41, v26, v27
    v_fma_f32 v26, v26, v26, -v40
    v_add_f32 v27, v41, v41
    v_add_f32 v37, -1.0, v18
    v_mul_f32 v38, v34, v34
    v_fmac_f32 v38, v35, v35
    v_rcp_f32 v38, v38
    v_mul_f32 v39, v37, v34
    v_fmac_f32 v39, v19, v35
    v_mul_f32 v40, v19, v34
    v_fma_f32 v40, -v37, v35, v40
    v_add_f32 v38, v38, v38
    v_mul_f32 v30, v39, v38
    v_mul_f32 v31, v40, v38
    v_and_b32 v34, 0xffff0000, v10
    v_and_b32 v35, 0xffff0000, v11
    v_and_b32 v36, 0xffff0000, v12
    v_mul_f32 v36, s44, v36
    v_exp_f32 v36, v36
    s_nop 0
    v_cvt_pk_bf16_f32 v36, v36, v36
    v_lshlrev_b32 v36, 16, v36
    v_mul_f32 v37, v36, v34
    v_mul_f32 v38, v36, v35
    v_mul_f32 v37, s44, v37
    v_mul_f32 v38, s45, v38
    v_exp_f32 v37, v37
    v_fract_f32 v38, v38
    v_cos_f32 v39, v38
    v_sin_f32 v38, v38
    s_nop 0
    v_mul_f32 v20, v37, v39
    v_mul_f32 v21, v37, v38
    v_mul_f32 v40, v21, v21
    v_mul_f32 v41, v20, v21
    v_fma_f32 v24, v20, v20, -v40
    v_add_f32 v25, v41, v41
    v_mul_f32 v40, v25, v25
    v_mul_f32 v41, v24, v25
    v_fma_f32 v24, v24, v24, -v40
    v_add_f32 v25, v41, v41
    v_mul_f32 v40, v25, v25
    v_mul_f32 v41, v24, v25
    v_fma_f32 v24, v24, v24, -v40
    v_add_f32 v25, v41, v41
    v_mul_f32 v40, v25, v25
    v_mul_f32 v41, v24, v25
    v_fma_f32 v24, v24, v24, -v40
    v_add_f32 v25, v41, v41
    v_mul_f32 v40, v25, v25
    v_mul_f32 v41, v24, v25
    v_fma_f32 v24, v24, v24, -v40
    v_add_f32 v25, v41, v41
    v_mul_f32 v40, v25, v25
    v_mul_f32 v41, v24, v25
    v_fma_f32 v28, v24, v24, -v40
    v_add_f32 v29, v41, v41
    v_mul_f32 v40, v29, v29
    v_mul_f32 v41, v28, v29
    v_fma_f32 v28, v28, v28, -v40
    v_add_f32 v29, v41, v41
    v_mul_f32 v40, v29, v29
    v_mul_f32 v41, v28, v29
    v_fma_f32 v28, v28, v28, -v40
    v_add_f32 v29, v41, v41
    v_add_f32 v37, -1.0, v20
    v_mul_f32 v38, v34, v34
    v_fmac_f32 v38, v35, v35
    v_rcp_f32 v38, v38
    v_mul_f32 v39, v37, v34
    v_fmac_f32 v39, v21, v35
    v_mul_f32 v40, v21, v34
    v_fma_f32 v40, -v37, v35, v40
    v_add_f32 v38, v38, v38
    v_mul_f32 v32, v39, v38
    v_mul_f32 v33, v40, v38
    s_mul_i32 s43, s29, 21846
    s_lshr_b32 s43, s43, 16
    s_lshl_b32 s43, s43, 9
    s_add_u32 s43, s43, 2048
    s_cmp_lg_u32 s20, 0
    s_cbranch_scc1 scan_g
    buffer_load_dwordx2 v[252:253], v248, s[16:19], s43 offen sc1
    s_mov_b32 s59, 0
    s_mov_b32 s56, 0xffffffff
    s_mov_b32 s57, 0xffffffff
    s_waitcnt vmcnt(0)
gt_51:
    v_cmp_ne_u64 vcc, v[252:253], v[250:251]
    s_add_u32 s59, s59, 1
    s_and_b64 vcc, vcc, s[56:57]
    s_cbranch_scc0 gt_52
    s_cmp_gt_u32 s59, 16384
    s_cbranch_scc1 gt_52
    s_sleep 4
    buffer_load_dwordx2 v[252:253], v248, s[16:19], s43 offen sc1
    s_waitcnt vmcnt(0)
    s_branch gt_51
gt_52:
    buffer_inv sc1
    s_waitcnt vmcnt(0)
scan_g:
    s_barrier
    s_add_u32 s4, s96, 0xc00000
    s_addc_u32 s5, s97, 0
    s_mov_b32 s6, 0x480000
    s_mov_b32 s7, 0x00020000
    s_add_u32 s12, s96, 0x1400000
    s_addc_u32 s13, s97, 0
    s_mov_b32 s14, 0x480000
    s_mov_b32 s15, 0x00020000
    buffer_load_dwordx4 v[184:187], v5, s[4:7], s40 offen offset:0
    buffer_load_dwordx4 v[188:191], v5, s[4:7], s40 offen offset:64
    buffer_load_dwordx4 v[192:195], v5, s[4:7], s40 offen offset:128
    buffer_load_dwordx4 v[196:199], v5, s[4:7], s40 offen offset:192
    buffer_load_dwordx4 v[200:203], v5, s[4:7], s40 offen offset:256
    buffer_load_dwordx4 v[204:207], v5, s[4:7], s40 offen offset:320
    buffer_load_dwordx4 v[208:211], v5, s[4:7], s40 offen offset:384
    buffer_load_dwordx4 v[212:215], v5, s[4:7], s40 offen offset:448
    buffer_load_dwordx4 v[216:219], v5, s[4:7], s40 offen offset:512
    buffer_load_dwordx4 v[220:223], v5, s[4:7], s40 offen offset:576
    buffer_load_dwordx4 v[224:227], v5, s[4:7], s40 offen offset:640
    buffer_load_dwordx4 v[228:231], v5, s[4:7], s40 offen offset:704
    buffer_load_dwordx4 v[232:235], v5, s[4:7], s40 offen offset:768
    buffer_load_dwordx4 v[236:239], v5, s[4:7], s40 offen offset:832
    buffer_load_dwordx4 v[240:243], v5, s[4:7], s40 offen offset:896
    buffer_load_dwordx4 v[244:247], v5, s[4:7], s40 offen offset:960
    v_mov_b32 v10, 0
    v_mov_b32 v11, 0
    v_mov_b32 v12, 0
    v_mov_b32 v13, 0
    s_waitcnt vmcnt(15)
    v_lshlrev_b32 v56, 16, v184
    v_and_b32 v57, 0xffff0000, v184
    v_lshlrev_b32 v58, 16, v185
    v_and_b32 v59, 0xffff0000, v185
    v_lshlrev_b32 v60, 16, v186
    v_and_b32 v61, 0xffff0000, v186
    v_lshlrev_b32 v62, 16, v187
    v_and_b32 v63, 0xffff0000, v187
    v_pk_mul_f32 v[40:41], v[30:31], v[56:57] op_sel_hi:[0,1]
    v_pk_mul_f32 v[42:43], v[32:33], v[58:59] op_sel_hi:[0,1]
    v_pk_mul_f32 v[44:45], v[30:31], v[60:61] op_sel_hi:[0,1]
    v_pk_mul_f32 v[46:47], v[32:33], v[62:63] op_sel_hi:[0,1]
    v_pk_fma_f32 v[56:57], v[30:31], v[56:57], v[40:41] op_sel:[1,1,0] op_sel_hi:[1,0,1] neg_lo:[1,0,0]
    v_pk_fma_f32 v[58:59], v[32:33], v[58:59], v[42:43] op_sel:[1,1,0] op_sel_hi:[1,0,1] neg_lo:[1,0,0]
    v_pk_fma_f32 v[60:61], v[30:31], v[60:61], v[44:45] op_sel:[1,1,0] op_sel_hi:[1,0,1] neg_lo:[1,0,0]
    v_pk_fma_f32 v[62:63], v[32:33], v[62:63], v[46:47] op_sel:[1,1,0] op_sel_hi:[1,0,1] neg_lo:[1,0,0]
    v_pk_fma_f32 v[34:35], v[18:19], v[10:11], v[56:57] op_sel_hi:[0,1,1]
    v_pk_fma_f32 v[36:37], v[20:21], v[12:13], v[58:59] op_sel_hi:[0,1,1]
    v_pk_fma_f32 v[10:11], v[18:19], v[10:11], v[34:35] op_sel:[1,1,0] op_sel_hi:[1,0,1] neg_lo:[1,0,0]
    v_pk_fma_f32 v[12:13], v[20:21], v[12:13], v[36:37] op_sel:[1,1,0] op_sel_hi:[1,0,1] neg_lo:[1,0,0]
    v_pk_fma_f32 v[34:35], v[18:19], v[10:11], v[60:61] op_sel_hi:[0,1,1]
    v_pk_fma_f32 v[36:37], v[20:21], v[12:13], v[62:63] op_sel_hi:[0,1,1]
    v_pk_fma_f32 v[10:11], v[18:19], v[10:11], v[34:35] op_sel:[1,1,0] op_sel_hi:[1,0,1] neg_lo:[1,0,0]
    v_pk_fma_f32 v[12:13], v[20:21], v[12:13], v[36:37] op_sel:[1,1,0] op_sel_hi:[1,0,1] neg_lo:[1,0,0]
    s_waitcnt vmcnt(14)
    v_lshlrev_b32 v64, 16, v188
    v_and_b32 v65, 0xffff0000, v188
    v_lshlrev_b32 v66, 16, v189
    v_and_b32 v67, 0xffff0000, v189
    v_lshlrev_b32 v68, 16, v190
    v_and_b32 v69, 0xffff0000, v190
    v_lshlrev_b32 v70, 16, v191
    v_and_b32 v71, 0xffff0000, v191
    v_pk_mul_f32 v[40:41], v[30:31], v[64:65] op_sel_hi:[0,1]
    v_pk_mul_f32 v[42:43], v[32:33], v[66:67] op_sel_hi:[0,1]
    v_pk_mul_f32 v[44:45], v[30:31], v[68:69] op_sel_hi:[0,1]
    v_pk_mul_f32 v[46:47], v[32:33], v[70:71] op_sel_hi:[0,1]
    v_pk_fma_f32 v[64:65], v[30:31], v[64:65], v[40:41] op_sel:[1,1,0] op_sel_hi:[1,0,1] neg_lo:[1,0,0]
    v_pk_fma_f32 v[66:67], v[32:33], v[66:67], v[42:43] op_sel:[1,1,0] op_sel_hi:[1,0,1] neg_lo:[1,0,0]
    v_pk_fma_f32 v[68:69], v[30:31], v[68:69], v[44:45] op_sel:[1,1,0] op_sel_hi:[1,0,1] neg_lo:[1,0,0]
    v_pk_fma_f32 v[70:71], v[32:33], v[70:71], v[46:47] op_sel:[1,1,0] op_sel_hi:[1,0,1] neg_lo:[1,0,0]
    v_pk_fma_f32 v[34:35], v[18:19], v[10:11], v[64:65] op_sel_hi:[0,1,1]
    v_pk_fma_f32 v[36:37], v[20:21], v[12:13], v[66:67] op_sel_hi:[0,1,1]
    v_pk_fma_f32 v[10:11], v[18:19], v[10:11], v[34:35] op_sel:[1,1,0] op_sel_hi:[1,0,1] neg_lo:[1,0,0]
    v_pk_fma_f32 v[12:13], v[20:21], v[12:13], v[36:37] op_sel:[1,1,0] op_sel_hi:[1,0,1] neg_lo:[1,0,0]
    v_pk_fma_f32 v[34:35], v[18:19], v[10:11], v[68:69] op_sel_hi:[0,1,1]
    v_pk_fma_f32 v[36:37], v[20:21], v[12:13], v[70:71] op_sel_hi:[0,1,1]
    v_pk_fma_f32 v[10:11], v[18:19], v[10:11], v[34:35] op_sel:[1,1,0] op_sel_hi:[1,0,1] neg_lo:[1,0,0]
    v_pk_fma_f32 v[12:13], v[20:21], v[12:13], v[36:37] op_sel:[1,1,0] op_sel_hi:[1,0,1] neg_lo:[1,0,0]
    s_waitcnt vmcnt(13)
    v_lshlrev_b32 v72, 16, v192
    v_and_b32 v73, 0xffff0000, v192
    v_lshlrev_b32 v74, 16, v193
    v_and_b32 v75, 0xffff0000, v193
    v_lshlrev_b32 v76, 16, v194
    v_and_b32 v77, 0xffff0000, v194
    v_lshlrev_b32 v78, 16, v195
    v_and_b32 v79, 0xffff0000, v195
    v_pk_mul_f32 v[40:41], v[30:31], v[72:73] op_sel_hi:[0,1]
    v_pk_mul_f32 v[42:43], v[32:33], v[74:75] op_sel_hi:[0,1]
    v_pk_mul_f32 v[44:45], v[30:31], v[76:77] op_sel_hi:[0,1]
    v_pk_mul_f32 v[46:47], v[32:33], v[78:79] op_sel_hi:[0,1]
    v_pk_fma_f32 v[72:73], v[30:31], v[72:73], v[40:41] op_sel:[1,1,0] op_sel_hi:[1,0,1] neg_lo:[1,0,0]
    v_pk_fma_f32 v[74:75], v[32:33], v[74:75], v[42:43] op_sel:[1,1,0] op_sel_hi:[1,0,1] neg_lo:[1,0,0]
    v_pk_fma_f32 v[76:77], v[30:31], v[76:77], v[44:45] op_sel:[1,1,0] op_sel_hi:[1,0,1] neg_lo:[1,0,0]
    v_pk_fma_f32 v[78:79], v[32:33], v[78:79], v[46:47] op_sel:[1,1,0] op_sel_hi:[1,0,1] neg_lo:[1,0,0]
    v_pk_fma_f32 v[34:35], v[18:19], v[10:11], v[72:73] op_sel_hi:[0,1,1]
    v_pk_fma_f32 v[36:37], v[20:21], v[12:13], v[74:75] op_sel_hi:[0,1,1]
    v_pk_fma_f32 v[10:11], v[18:19], v[10:11], v[34:35] op_sel:[1,1,0] op_sel_hi:[1,0,1] neg_lo:[1,0,0]
    v_pk_fma_f32 v[12:13], v[20:21], v[12:13], v[36:37] op_sel:[1,1,0] op_sel_hi:[1,0,1] neg_lo:[1,0,0]
    v_pk_fma_f32 v[34:35], v[18:19], v[10:11], v[76:77] op_sel_hi:[0,1,1]
    v_pk_fma_f32 v[36:37], v[20:21], v[12:13], v[78:79] op_sel_hi:[0,1,1]
    v_pk_fma_f32 v[10:11], v[18:19], v[10:11], v[34:35] op_sel:[1,1,0] op_sel_hi:[1,0,1] neg_lo:[1,0,0]
    v_pk_fma_f32 v[12:13], v[20:21], v[12:13], v[36:37] op_sel:[1,1,0] op_sel_hi:[1,0,1] neg_lo:[1,0,0]
    s_waitcnt vmcnt(12)
    v_lshlrev_b32 v80, 16, v196
    v_and_b32 v81, 0xffff0000, v196
    v_lshlrev_b32 v82, 16, v197
    v_and_b32 v83, 0xffff0000, v197
    v_lshlrev_b32 v84, 16, v198
    v_and_b32 v85, 0xffff0000, v198
    v_lshlrev_b32 v86, 16, v199
    v_and_b32 v87, 0xffff0000, v199
    v_pk_mul_f32 v[40:41], v[30:31], v[80:81] op_sel_hi:[0,1]
    v_pk_mul_f32 v[42:43], v[32:33], v[82:83] op_sel_hi:[0,1]
    v_pk_mul_f32 v[44:45], v[30:31], v[84:85] op_sel_hi:[0,1]
    v_pk_mul_f32 v[46:47], v[32:33], v[86:87] op_sel_hi:[0,1]
    v_pk_fma_f32 v[80:81], v[30:31], v[80:81], v[40:41] op_sel:[1,1,0] op_sel_hi:[1,0,1] neg_lo:[1,0,0]
    v_pk_fma_f32 v[82:83], v[32:33], v[82:83], v[42:43] op_sel:[1,1,0] op_sel_hi:[1,0,1] neg_lo:[1,0,0]
    v_pk_fma_f32 v[84:85], v[30:31], v[84:85], v[44:45] op_sel:[1,1,0] op_sel_hi:[1,0,1] neg_lo:[1,0,0]
    v_pk_fma_f32 v[86:87], v[32:33], v[86:87], v[46:47] op_sel:[1,1,0] op_sel_hi:[1,0,1] neg_lo:[1,0,0]
    v_pk_fma_f32 v[34:35], v[18:19], v[10:11], v[80:81] op_sel_hi:[0,1,1]
    v_pk_fma_f32 v[36:37], v[20:21], v[12:13], v[82:83] op_sel_hi:[0,1,1]
    v_pk_fma_f32 v[10:11], v[18:19], v[10:11], v[34:35] op_sel:[1,1,0] op_sel_hi:[1,0,1] neg_lo:[1,0,0]
    v_pk_fma_f32 v[12:13], v[20:21], v[12:13], v[36:37] op_sel:[1,1,0] op_sel_hi:[1,0,1] neg_lo:[1,0,0]
    v_pk_fma_f32 v[34:35], v[18:19], v[10:11], v[84:85] op_sel_hi:[0,1,1]
    v_pk_fma_f32 v[36:37], v[20:21], v[12:13], v[86:87] op_sel_hi:[0,1,1]
    v_pk_fma_f32 v[10:11], v[18:19], v[10:11], v[34:35] op_sel:[1,1,0] op_sel_hi:[1,0,1] neg_lo:[1,0,0]
    v_pk_fma_f32 v[12:13], v[20:21], v[12:13], v[36:37] op_sel:[1,1,0] op_sel_hi:[1,0,1] neg_lo:[1,0,0]
    s_waitcnt vmcnt(11)
    v_lshlrev_b32 v88, 16, v200
    v_and_b32 v89, 0xffff0000, v200
    v_lshlrev_b32 v90, 16, v201
    v_and_b32 v91, 0xffff0000, v201
    v_lshlrev_b32 v92, 16, v202
    v_and_b32 v93, 0xffff0000, v202
    v_lshlrev_b32 v94, 16, v203
    v_and_b32 v95, 0xffff0000, v203
    v_pk_mul_f32 v[40:41], v[30:31], v[88:89] op_sel_hi:[0,1]
    v_pk_mul_f32 v[42:43], v[32:33], v[90:91] op_sel_hi:[0,1]
    v_pk_mul_f32 v[44:45], v[30:31], v[92:93] op_sel_hi:[0,1]
    v_pk_mul_f32 v[46:47], v[32:33], v[94:95] op_sel_hi:[0,1]
    v_pk_fma_f32 v[88:89], v[30:31], v[88:89], v[40:41] op_sel:[1,1,0] op_sel_hi:[1,0,1] neg_lo:[1,0,0]
    v_pk_fma_f32 v[90:91], v[32:33], v[90:91], v[42:43] op_sel:[1,1,0] op_sel_hi:[1,0,1] neg_lo:[1,0,0]
    v_pk_fma_f32 v[92:93], v[30:31], v[92:93], v[44:45] op_sel:[1,1,0] op_sel_hi:[1,0,1] neg_lo:[1,0,0]
    v_pk_fma_f32 v[94:95], v[32:33], v[94:95], v[46:47] op_sel:[1,1,0] op_sel_hi:[1,0,1] neg_lo:[1,0,0]
    v_pk_fma_f32 v[34:35], v[18:19], v[10:11], v[88:89] op_sel_hi:[0,1,1]
    v_pk_fma_f32 v[36:37], v[20:21], v[12:13], v[90:91] op_sel_hi:[0,1,1]
    v_pk_fma_f32 v[10:11], v[18:19], v[10:11], v[34:35] op_sel:[1,1,0] op_sel_hi:[1,0,1] neg_lo:[1,0,0]
    v_pk_fma_f32 v[12:13], v[20:21], v[12:13], v[36:37] op_sel:[1,1,0] op_sel_hi:[1,0,1] neg_lo:[1,0,0]
    v_pk_fma_f32 v[34:35], v[18:19], v[10:11], v[92:93] op_sel_hi:[0,1,1]
    v_pk_fma_f32 v[36:37], v[20:21], v[12:13], v[94:95] op_sel_hi:[0,1,1]
    v_pk_fma_f32 v[10:11], v[18:19], v[10:11], v[34:35] op_sel:[1,1,0] op_sel_hi:[1,0,1] neg_lo:[1,0,0]
    v_pk_fma_f32 v[12:13], v[20:21], v[12:13], v[36:37] op_sel:[1,1,0] op_sel_hi:[1,0,1] neg_lo:[1,0,0]
    s_waitcnt vmcnt(10)
    v_lshlrev_b32 v96, 16, v204
    v_and_b32 v97, 0xffff0000, v204
    v_lshlrev_b32 v98, 16, v205
    v_and_b32 v99, 0xffff0000, v205
    v_lshlrev_b32 v100, 16, v206
    v_and_b32 v101, 0xffff0000, v206
    v_lshlrev_b32 v102, 16, v207
    v_and_b32 v103, 0xffff0000, v207
    v_pk_mul_f32 v[40:41], v[30:31], v[96:97] op_sel_hi:[0,1]
    v_pk_mul_f32 v[42:43], v[32:33], v[98:99] op_sel_hi:[0,1]
    v_pk_mul_f32 v[44:45], v[30:31], v[100:101] op_sel_hi:[0,1]
    v_pk_mul_f32 v[46:47], v[32:33], v[102:103] op_sel_hi:[0,1]
    v_pk_fma_f32 v[96:97], v[30:31], v[96:97], v[40:41] op_sel:[1,1,0] op_sel_hi:[1,0,1] neg_lo:[1,0,0]
    v_pk_fma_f32 v[98:99], v[32:33], v[98:99], v[42:43] op_sel:[1,1,0] op_sel_hi:[1,0,1] neg_lo:[1,0,0]
    v_pk_fma_f32 v[100:101], v[30:31], v[100:101], v[44:45] op_sel:[1,1,0] op_sel_hi:[1,0,1] neg_lo:[1,0,0]
    v_pk_fma_f32 v[102:103], v[32:33], v[102:103], v[46:47] op_sel:[1,1,0] op_sel_hi:[1,0,1] neg_lo:[1,0,0]
    v_pk_fma_f32 v[34:35], v[18:19], v[10:11], v[96:97] op_sel_hi:[0,1,1]
    v_pk_fma_f32 v[36:37], v[20:21], v[12:13], v[98:99] op_sel_hi:[0,1,1]
    v_pk_fma_f32 v[10:11], v[18:19], v[10:11], v[34:35] op_sel:[1,1,0] op_sel_hi:[1,0,1] neg_lo:[1,0,0]
    v_pk_fma_f32 v[12:13], v[20:21], v[12:13], v[36:37] op_sel:[1,1,0] op_sel_hi:[1,0,1] neg_lo:[1,0,0]
    v_pk_fma_f32 v[34:35], v[18:19], v[10:11], v[100:101] op_sel_hi:[0,1,1]
    v_pk_fma_f32 v[36:37], v[20:21], v[12:13], v[102:103] op_sel_hi:[0,1,1]
    v_pk_fma_f32 v[10:11], v[18:19], v[10:11], v[34:35] op_sel:[1,1,0] op_sel_hi:[1,0,1] neg_lo:[1,0,0]
    v_pk_fma_f32 v[12:13], v[20:21], v[12:13], v[36:37] op_sel:[1,1,0] op_sel_hi:[1,0,1] neg_lo:[1,0,0]
    s_waitcnt vmcnt(9)
    v_lshlrev_b32 v104, 16, v208
    v_and_b32 v105, 0xffff0000, v208
    v_lshlrev_b32 v106, 16, v209
    v_and_b32 v107, 0xffff0000, v209
    v_lshlrev_b32 v108, 16, v210
    v_and_b32 v109, 0xffff0000, v210
    v_lshlrev_b32 v110, 16, v211
    v_and_b32 v111, 0xffff0000, v211
    v_pk_mul_f32 v[40:41], v[30:31], v[104:105] op_sel_hi:[0,1]
    v_pk_mul_f32 v[42:43], v[32:33], v[106:107] op_sel_hi:[0,1]
    v_pk_mul_f32 v[44:45], v[30:31], v[108:109] op_sel_hi:[0,1]
    v_pk_mul_f32 v[46:47], v[32:33], v[110:111] op_sel_hi:[0,1]
    v_pk_fma_f32 v[104:105], v[30:31], v[104:105], v[40:41] op_sel:[1,1,0] op_sel_hi:[1,0,1] neg_lo:[1,0,0]
    v_pk_fma_f32 v[106:107], v[32:33], v[106:107], v[42:43] op_sel:[1,1,0] op_sel_hi:[1,0,1] neg_lo:[1,0,0]
    v_pk_fma_f32 v[108:109], v[30:31], v[108:109], v[44:45] op_sel:[1,1,0] op_sel_hi:[1,0,1] neg_lo:[1,0,0]
    v_pk_fma_f32 v[110:111], v[32:33], v[110:111], v[46:47] op_sel:[1,1,0] op_sel_hi:[1,0,1] neg_lo:[1,0,0]
    v_pk_fma_f32 v[34:35], v[18:19], v[10:11], v[104:105] op_sel_hi:[0,1,1]
    v_pk_fma_f32 v[36:37], v[20:21], v[12:13], v[106:107] op_sel_hi:[0,1,1]
    v_pk_fma_f32 v[10:11], v[18:19], v[10:11], v[34:35] op_sel:[1,1,0] op_sel_hi:[1,0,1] neg_lo:[1,0,0]
    v_pk_fma_f32 v[12:13], v[20:21], v[12:13], v[36:37] op_sel:[1,1,0] op_sel_hi:[1,0,1] neg_lo:[1,0,0]
    v_pk_fma_f32 v[34:35], v[18:19], v[10:11], v[108:109] op_sel_hi:[0,1,1]
    v_pk_fma_f32 v[36:37], v[20:21], v[12:13], v[110:111] op_sel_hi:[0,1,1]
    v_pk_fma_f32 v[10:11], v[18:19], v[10:11], v[34:35] op_sel:[1,1,0] op_sel_hi:[1,0,1] neg_lo:[1,0,0]
    v_pk_fma_f32 v[12:13], v[20:21], v[12:13], v[36:37] op_sel:[1,1,0] op_sel_hi:[1,0,1] neg_lo:[1,0,0]
    s_waitcnt vmcnt(8)
    v_lshlrev_b32 v112, 16, v212
    v_and_b32 v113, 0xffff0000, v212
    v_lshlrev_b32 v114, 16, v213
    v_and_b32 v115, 0xffff0000, v213
    v_lshlrev_b32 v116, 16, v214
    v_and_b32 v117, 0xffff0000, v214
    v_lshlrev_b32 v118, 16, v215
    v_and_b32 v119, 0xffff0000, v215
    v_pk_mul_f32 v[40:41], v[30:31], v[112:113] op_sel_hi:[0,1]
    v_pk_mul_f32 v[42:43], v[32:33], v[114:115] op_sel_hi:[0,1]
    v_pk_mul_f32 v[44:45], v[30:31], v[116:117] op_sel_hi:[0,1]
    v_pk_mul_f32 v[46:47], v[32:33], v[118:119] op_sel_hi:[0,1]
    v_pk_fma_f32 v[112:113], v[30:31], v[112:113], v[40:41] op_sel:[1,1,0] op_sel_hi:[1,0,1] neg_lo:[1,0,0]
    v_pk_fma_f32 v[114:115], v[32:33], v[114:115], v[42:43] op_sel:[1,1,0] op_sel_hi:[1,0,1] neg_lo:[1,0,0]
    v_pk_fma_f32 v[116:117], v[30:31], v[116:117], v[44:45] op_sel:[1,1,0] op_sel_hi:[1,0,1] neg_lo:[1,0,0]
    v_pk_fma_f32 v[118:119], v[32:33], v[118:119], v[46:47] op_sel:[1,1,0] op_sel_hi:[1,0,1] neg_lo:[1,0,0]
    v_pk_fma_f32 v[34:35], v[18:19], v[10:11], v[112:113] op_sel_hi:[0,1,1]
    v_pk_fma_f32 v[36:37], v[20:21], v[12:13], v[114:115] op_sel_hi:[0,1,1]
    v_pk_fma_f32 v[10:11], v[18:19], v[10:11], v[34:35] op_sel:[1,1,0] op_sel_hi:[1,0,1] neg_lo:[1,0,0]
    v_pk_fma_f32 v[12:13], v[20:21], v[12:13], v[36:37] op_sel:[1,1,0] op_sel_hi:[1,0,1] neg_lo:[1,0,0]
    v_pk_fma_f32 v[34:35], v[18:19], v[10:11], v[116:117] op_sel_hi:[0,1,1]
    v_pk_fma_f32 v[36:37], v[20:21], v[12:13], v[118:119] op_sel_hi:[0,1,1]
    v_pk_fma_f32 v[10:11], v[18:19], v[10:11], v[34:35] op_sel:[1,1,0] op_sel_hi:[1,0,1] neg_lo:[1,0,0]
    v_pk_fma_f32 v[12:13], v[20:21], v[12:13], v[36:37] op_sel:[1,1,0] op_sel_hi:[1,0,1] neg_lo:[1,0,0]
    s_waitcnt vmcnt(7)
    v_lshlrev_b32 v120, 16, v216
    v_and_b32 v121, 0xffff0000, v216
    v_lshlrev_b32 v122, 16, v217
    v_and_b32 v123, 0xffff0000, v217
    v_lshlrev_b32 v124, 16, v218
    v_and_b32 v125, 0xffff0000, v218
    v_lshlrev_b32 v126, 16, v219
    v_and_b32 v127, 0xffff0000, v219
    v_pk_mul_f32 v[40:41], v[30:31], v[120:121] op_sel_hi:[0,1]
    v_pk_mul_f32 v[42:43], v[32:33], v[122:123] op_sel_hi:[0,1]
    v_pk_mul_f32 v[44:45], v[30:31], v[124:125] op_sel_hi:[0,1]
    v_pk_mul_f32 v[46:47], v[32:33], v[126:127] op_sel_hi:[0,1]
    v_pk_fma_f32 v[120:121], v[30:31], v[120:121], v[40:41] op_sel:[1,1,0] op_sel_hi:[1,0,1] neg_lo:[1,0,0]
    v_pk_fma_f32 v[122:123], v[32:33], v[122:123], v[42:43] op_sel:[1,1,0] op_sel_hi:[1,0,1] neg_lo:[1,0,0]
    v_pk_fma_f32 v[124:125], v[30:31], v[124:125], v[44:45] op_sel:[1,1,0] op_sel_hi:[1,0,1] neg_lo:[1,0,0]
    v_pk_fma_f32 v[126:127], v[32:33], v[126:127], v[46:47] op_sel:[1,1,0] op_sel_hi:[1,0,1] neg_lo:[1,0,0]
    v_pk_fma_f32 v[34:35], v[18:19], v[10:11], v[120:121] op_sel_hi:[0,1,1]
    v_pk_fma_f32 v[36:37], v[20:21], v[12:13], v[122:123] op_sel_hi:[0,1,1]
    v_pk_fma_f32 v[10:11], v[18:19], v[10:11], v[34:35] op_sel:[1,1,0] op_sel_hi:[1,0,1] neg_lo:[1,0,0]
    v_pk_fma_f32 v[12:13], v[20:21], v[12:13], v[36:37] op_sel:[1,1,0] op_sel_hi:[1,0,1] neg_lo:[1,0,0]
    v_pk_fma_f32 v[34:35], v[18:19], v[10:11], v[124:125] op_sel_hi:[0,1,1]
    v_pk_fma_f32 v[36:37], v[20:21], v[12:13], v[126:127] op_sel_hi:[0,1,1]
    v_pk_fma_f32 v[10:11], v[18:19], v[10:11], v[34:35] op_sel:[1,1,0] op_sel_hi:[1,0,1] neg_lo:[1,0,0]
    v_pk_fma_f32 v[12:13], v[20:21], v[12:13], v[36:37] op_sel:[1,1,0] op_sel_hi:[1,0,1] neg_lo:[1,0,0]
    s_waitcnt vmcnt(6)
    v_lshlrev_b32 v128, 16, v220
    v_and_b32 v129, 0xffff0000, v220
    v_lshlrev_b32 v130, 16, v221
    v_and_b32 v131, 0xffff0000, v221
    v_lshlrev_b32 v132, 16, v222
    v_and_b32 v133, 0xffff0000, v222
    v_lshlrev_b32 v134, 16, v223
    v_and_b32 v135, 0xffff0000, v223
    v_pk_mul_f32 v[40:41], v[30:31], v[128:129] op_sel_hi:[0,1]
    v_pk_mul_f32 v[42:43], v[32:33], v[130:131] op_sel_hi:[0,1]
    v_pk_mul_f32 v[44:45], v[30:31], v[132:133] op_sel_hi:[0,1]
    v_pk_mul_f32 v[46:47], v[32:33], v[134:135] op_sel_hi:[0,1]
    v_pk_fma_f32 v[128:129], v[30:31], v[128:129], v[40:41] op_sel:[1,1,0] op_sel_hi:[1,0,1] neg_lo:[1,0,0]
    v_pk_fma_f32 v[130:131], v[32:33], v[130:131], v[42:43] op_sel:[1,1,0] op_sel_hi:[1,0,1] neg_lo:[1,0,0]
    v_pk_fma_f32 v[132:133], v[30:31], v[132:133], v[44:45] op_sel:[1,1,0] op_sel_hi:[1,0,1] neg_lo:[1,0,0]
    v_pk_fma_f32 v[134:135], v[32:33], v[134:135], v[46:47] op_sel:[1,1,0] op_sel_hi:[1,0,1] neg_lo:[1,0,0]
    v_pk_fma_f32 v[34:35], v[18:19], v[10:11], v[128:129] op_sel_hi:[0,1,1]
    v_pk_fma_f32 v[36:37], v[20:21], v[12:13], v[130:131] op_sel_hi:[0,1,1]
    v_pk_fma_f32 v[10:11], v[18:19], v[10:11], v[34:35] op_sel:[1,1,0] op_sel_hi:[1,0,1] neg_lo:[1,0,0]
    v_pk_fma_f32 v[12:13], v[20:21], v[12:13], v[36:37] op_sel:[1,1,0] op_sel_hi:[1,0,1] neg_lo:[1,0,0]
    v_pk_fma_f32 v[34:35], v[18:19], v[10:11], v[132:133] op_sel_hi:[0,1,1]
    v_pk_fma_f32 v[36:37], v[20:21], v[12:13], v[134:135] op_sel_hi:[0,1,1]
    v_pk_fma_f32 v[10:11], v[18:19], v[10:11], v[34:35] op_sel:[1,1,0] op_sel_hi:[1,0,1] neg_lo:[1,0,0]
    v_pk_fma_f32 v[12:13], v[20:21], v[12:13], v[36:37] op_sel:[1,1,0] op_sel_hi:[1,0,1] neg_lo:[1,0,0]
    s_waitcnt vmcnt(5)
    v_lshlrev_b32 v136, 16, v224
    v_and_b32 v137, 0xffff0000, v224
    v_lshlrev_b32 v138, 16, v225
    v_and_b32 v139, 0xffff0000, v225
    v_lshlrev_b32 v140, 16, v226
    v_and_b32 v141, 0xffff0000, v226
    v_lshlrev_b32 v142, 16, v227
    v_and_b32 v143, 0xffff0000, v227
    v_pk_mul_f32 v[40:41], v[30:31], v[136:137] op_sel_hi:[0,1]
    v_pk_mul_f32 v[42:43], v[32:33], v[138:139] op_sel_hi:[0,1]
    v_pk_mul_f32 v[44:45], v[30:31], v[140:141] op_sel_hi:[0,1]
    v_pk_mul_f32 v[46:47], v[32:33], v[142:143] op_sel_hi:[0,1]
    v_pk_fma_f32 v[136:137], v[30:31], v[136:137], v[40:41] op_sel:[1,1,0] op_sel_hi:[1,0,1] neg_lo:[1,0,0]
    v_pk_fma_f32 v[138:139], v[32:33], v[138:139], v[42:43] op_sel:[1,1,0] op_sel_hi:[1,0,1] neg_lo:[1,0,0]
    v_pk_fma_f32 v[140:141], v[30:31], v[140:141], v[44:45] op_sel:[1,1,0] op_sel_hi:[1,0,1] neg_lo:[1,0,0]
    v_pk_fma_f32 v[142:143], v[32:33], v[142:143], v[46:47] op_sel:[1,1,0] op_sel_hi:[1,0,1] neg_lo:[1,0,0]
    v_pk_fma_f32 v[34:35], v[18:19], v[10:11], v[136:137] op_sel_hi:[0,1,1]
    v_pk_fma_f32 v[36:37], v[20:21], v[12:13], v[138:139] op_sel_hi:[0,1,1]
    v_pk_fma_f32 v[10:11], v[18:19], v[10:11], v[34:35] op_sel:[1,1,0] op_sel_hi:[1,0,1] neg_lo:[1,0,0]
    v_pk_fma_f32 v[12:13], v[20:21], v[12:13], v[36:37] op_sel:[1,1,0] op_sel_hi:[1,0,1] neg_lo:[1,0,0]
    v_pk_fma_f32 v[34:35], v[18:19], v[10:11], v[140:141] op_sel_hi:[0,1,1]
    v_pk_fma_f32 v[36:37], v[20:21], v[12:13], v[142:143] op_sel_hi:[0,1,1]
    v_pk_fma_f32 v[10:11], v[18:19], v[10:11], v[34:35] op_sel:[1,1,0] op_sel_hi:[1,0,1] neg_lo:[1,0,0]
    v_pk_fma_f32 v[12:13], v[20:21], v[12:13], v[36:37] op_sel:[1,1,0] op_sel_hi:[1,0,1] neg_lo:[1,0,0]
    s_waitcnt vmcnt(4)
    v_lshlrev_b32 v144, 16, v228
    v_and_b32 v145, 0xffff0000, v228
    v_lshlrev_b32 v146, 16, v229
    v_and_b32 v147, 0xffff0000, v229
    v_lshlrev_b32 v148, 16, v230
    v_and_b32 v149, 0xffff0000, v230
    v_lshlrev_b32 v150, 16, v231
    v_and_b32 v151, 0xffff0000, v231
    v_pk_mul_f32 v[40:41], v[30:31], v[144:145] op_sel_hi:[0,1]
    v_pk_mul_f32 v[42:43], v[32:33], v[146:147] op_sel_hi:[0,1]
    v_pk_mul_f32 v[44:45], v[30:31], v[148:149] op_sel_hi:[0,1]
    v_pk_mul_f32 v[46:47], v[32:33], v[150:151] op_sel_hi:[0,1]
    v_pk_fma_f32 v[144:145], v[30:31], v[144:145], v[40:41] op_sel:[1,1,0] op_sel_hi:[1,0,1] neg_lo:[1,0,0]
    v_pk_fma_f32 v[146:147], v[32:33], v[146:147], v[42:43] op_sel:[1,1,0] op_sel_hi:[1,0,1] neg_lo:[1,0,0]
    v_pk_fma_f32 v[148:149], v[30:31], v[148:149], v[44:45] op_sel:[1,1,0] op_sel_hi:[1,0,1] neg_lo:[1,0,0]
    v_pk_fma_f32 v[150:151], v[32:33], v[150:151], v[46:47] op_sel:[1,1,0] op_sel_hi:[1,0,1] neg_lo:[1,0,0]
    v_pk_fma_f32 v[34:35], v[18:19], v[10:11], v[144:145] op_sel_hi:[0,1,1]
    v_pk_fma_f32 v[36:37], v[20:21], v[12:13], v[146:147] op_sel_hi:[0,1,1]
    v_pk_fma_f32 v[10:11], v[18:19], v[10:11], v[34:35] op_sel:[1,1,0] op_sel_hi:[1,0,1] neg_lo:[1,0,0]
    v_pk_fma_f32 v[12:13], v[20:21], v[12:13], v[36:37] op_sel:[1,1,0] op_sel_hi:[1,0,1] neg_lo:[1,0,0]
    v_pk_fma_f32 v[34:35], v[18:19], v[10:11], v[148:149] op_sel_hi:[0,1,1]
    v_pk_fma_f32 v[36:37], v[20:21], v[12:13], v[150:151] op_sel_hi:[0,1,1]
    v_pk_fma_f32 v[10:11], v[18:19], v[10:11], v[34:35] op_sel:[1,1,0] op_sel_hi:[1,0,1] neg_lo:[1,0,0]
    v_pk_fma_f32 v[12:13], v[20:21], v[12:13], v[36:37] op_sel:[1,1,0] op_sel_hi:[1,0,1] neg_lo:[1,0,0]
    s_waitcnt vmcnt(3)
    v_lshlrev_b32 v152, 16, v232
    v_and_b32 v153, 0xffff0000, v232
    v_lshlrev_b32 v154, 16, v233
    v_and_b32 v155, 0xffff0000, v233
    v_lshlrev_b32 v156, 16, v234
    v_and_b32 v157, 0xffff0000, v234
    v_lshlrev_b32 v158, 16, v235
    v_and_b32 v159, 0xffff0000, v235
    v_pk_mul_f32 v[40:41], v[30:31], v[152:153] op_sel_hi:[0,1]
    v_pk_mul_f32 v[42:43], v[32:33], v[154:155] op_sel_hi:[0,1]
    v_pk_mul_f32 v[44:45], v[30:31], v[156:157] op_sel_hi:[0,1]
    v_pk_mul_f32 v[46:47], v[32:33], v[158:159] op_sel_hi:[0,1]
    v_pk_fma_f32 v[152:153], v[30:31], v[152:153], v[40:41] op_sel:[1,1,0] op_sel_hi:[1,0,1] neg_lo:[1,0,0]
    v_pk_fma_f32 v[154:155], v[32:33], v[154:155], v[42:43] op_sel:[1,1,0] op_sel_hi:[1,0,1] neg_lo:[1,0,0]
    v_pk_fma_f32 v[156:157], v[30:31], v[156:157], v[44:45] op_sel:[1,1,0] op_sel_hi:[1,0,1] neg_lo:[1,0,0]
    v_pk_fma_f32 v[158:159], v[32:33], v[158:159], v[46:47] op_sel:[1,1,0] op_sel_hi:[1,0,1] neg_lo:[1,0,0]
    v_pk_fma_f32 v[34:35], v[18:19], v[10:11], v[152:153] op_sel_hi:[0,1,1]
    v_pk_fma_f32 v[36:37], v[20:21], v[12:13], v[154:155] op_sel_hi:[0,1,1]
    v_pk_fma_f32 v[10:11], v[18:19], v[10:11], v[34:35] op_sel:[1,1,0] op_sel_hi:[1,0,1] neg_lo:[1,0,0]
    v_pk_fma_f32 v[12:13], v[20:21], v[12:13], v[36:37] op_sel:[1,1,0] op_sel_hi:[1,0,1] neg_lo:[1,0,0]
    v_pk_fma_f32 v[34:35], v[18:19], v[10:11], v[156:157] op_sel_hi:[0,1,1]
    v_pk_fma_f32 v[36:37], v[20:21], v[12:13], v[158:159] op_sel_hi:[0,1,1]
    v_pk_fma_f32 v[10:11], v[18:19], v[10:11], v[34:35] op_sel:[1,1,0] op_sel_hi:[1,0,1] neg_lo:[1,0,0]
    v_pk_fma_f32 v[12:13], v[20:21], v[12:13], v[36:37] op_sel:[1,1,0] op_sel_hi:[1,0,1] neg_lo:[1,0,0]
    s_waitcnt vmcnt(2)
    v_lshlrev_b32 v160, 16, v236
    v_and_b32 v161, 0xffff0000, v236
    v_lshlrev_b32 v162, 16, v237
    v_and_b32 v163, 0xffff0000, v237
    v_lshlrev_b32 v164, 16, v238
    v_and_b32 v165, 0xffff0000, v238
    v_lshlrev_b32 v166, 16, v239
    v_and_b32 v167, 0xffff0000, v239
    v_pk_mul_f32 v[40:41], v[30:31], v[160:161] op_sel_hi:[0,1]
    v_pk_mul_f32 v[42:43], v[32:33], v[162:163] op_sel_hi:[0,1]
    v_pk_mul_f32 v[44:45], v[30:31], v[164:165] op_sel_hi:[0,1]
    v_pk_mul_f32 v[46:47], v[32:33], v[166:167] op_sel_hi:[0,1]
    v_pk_fma_f32 v[160:161], v[30:31], v[160:161], v[40:41] op_sel:[1,1,0] op_sel_hi:[1,0,1] neg_lo:[1,0,0]
    v_pk_fma_f32 v[162:163], v[32:33], v[162:163], v[42:43] op_sel:[1,1,0] op_sel_hi:[1,0,1] neg_lo:[1,0,0]
    v_pk_fma_f32 v[164:165], v[30:31], v[164:165], v[44:45] op_sel:[1,1,0] op_sel_hi:[1,0,1] neg_lo:[1,0,0]
    v_pk_fma_f32 v[166:167], v[32:33], v[166:167], v[46:47] op_sel:[1,1,0] op_sel_hi:[1,0,1] neg_lo:[1,0,0]
    v_pk_fma_f32 v[34:35], v[18:19], v[10:11], v[160:161] op_sel_hi:[0,1,1]
    v_pk_fma_f32 v[36:37], v[20:21], v[12:13], v[162:163] op_sel_hi:[0,1,1]
    v_pk_fma_f32 v[10:11], v[18:19], v[10:11], v[34:35] op_sel:[1,1,0] op_sel_hi:[1,0,1] neg_lo:[1,0,0]
    v_pk_fma_f32 v[12:13], v[20:21], v[12:13], v[36:37] op_sel:[1,1,0] op_sel_hi:[1,0,1] neg_lo:[1,0,0]
    v_pk_fma_f32 v[34:35], v[18:19], v[10:11], v[164:165] op_sel_hi:[0,1,1]
    v_pk_fma_f32 v[36:37], v[20:21], v[12:13], v[166:167] op_sel_hi:[0,1,1]
    v_pk_fma_f32 v[10:11], v[18:19], v[10:11], v[34:35] op_sel:[1,1,0] op_sel_hi:[1,0,1] neg_lo:[1,0,0]
    v_pk_fma_f32 v[12:13], v[20:21], v[12:13], v[36:37] op_sel:[1,1,0] op_sel_hi:[1,0,1] neg_lo:[1,0,0]
    s_waitcnt vmcnt(1)
    v_lshlrev_b32 v168, 16, v240
    v_and_b32 v169, 0xffff0000, v240
    v_lshlrev_b32 v170, 16, v241
    v_and_b32 v171, 0xffff0000, v241
    v_lshlrev_b32 v172, 16, v242
    v_and_b32 v173, 0xffff0000, v242
    v_lshlrev_b32 v174, 16, v243
    v_and_b32 v175, 0xffff0000, v243
    v_pk_mul_f32 v[40:41], v[30:31], v[168:169] op_sel_hi:[0,1]
    v_pk_mul_f32 v[42:43], v[32:33], v[170:171] op_sel_hi:[0,1]
    v_pk_mul_f32 v[44:45], v[30:31], v[172:173] op_sel_hi:[0,1]
    v_pk_mul_f32 v[46:47], v[32:33], v[174:175] op_sel_hi:[0,1]
    v_pk_fma_f32 v[168:169], v[30:31], v[168:169], v[40:41] op_sel:[1,1,0] op_sel_hi:[1,0,1] neg_lo:[1,0,0]
    v_pk_fma_f32 v[170:171], v[32:33], v[170:171], v[42:43] op_sel:[1,1,0] op_sel_hi:[1,0,1] neg_lo:[1,0,0]
    v_pk_fma_f32 v[172:173], v[30:31], v[172:173], v[44:45] op_sel:[1,1,0] op_sel_hi:[1,0,1] neg_lo:[1,0,0]
    v_pk_fma_f32 v[174:175], v[32:33], v[174:175], v[46:47] op_sel:[1,1,0] op_sel_hi:[1,0,1] neg_lo:[1,0,0]
    v_pk_fma_f32 v[34:35], v[18:19], v[10:11], v[168:169] op_sel_hi:[0,1,1]
    v_pk_fma_f32 v[36:37], v[20:21], v[12:13], v[170:171] op_sel_hi:[0,1,1]
    v_pk_fma_f32 v[10:11], v[18:19], v[10:11], v[34:35] op_sel:[1,1,0] op_sel_hi:[1,0,1] neg_lo:[1,0,0]
    v_pk_fma_f32 v[12:13], v[20:21], v[12:13], v[36:37] op_sel:[1,1,0] op_sel_hi:[1,0,1] neg_lo:[1,0,0]
    v_pk_fma_f32 v[34:35], v[18:19], v[10:11], v[172:173] op_sel_hi:[0,1,1]
    v_pk_fma_f32 v[36:37], v[20:21], v[12:13], v[174:175] op_sel_hi:[0,1,1]
    v_pk_fma_f32 v[10:11], v[18:19], v[10:11], v[34:35] op_sel:[1,1,0] op_sel_hi:[1,0,1] neg_lo:[1,0,0]
    v_pk_fma_f32 v[12:13], v[20:21], v[12:13], v[36:37] op_sel:[1,1,0] op_sel_hi:[1,0,1] neg_lo:[1,0,0]
    s_waitcnt vmcnt(0)
    v_lshlrev_b32 v176, 16, v244
    v_and_b32 v177, 0xffff0000, v244
    v_lshlrev_b32 v178, 16, v245
    v_and_b32 v179, 0xffff0000, v245
    v_lshlrev_b32 v180, 16, v246
    v_and_b32 v181, 0xffff0000, v246
    v_lshlrev_b32 v182, 16, v247
    v_and_b32 v183, 0xffff0000, v247
    v_pk_mul_f32 v[40:41], v[30:31], v[176:177] op_sel_hi:[0,1]
    v_pk_mul_f32 v[42:43], v[32:33], v[178:179] op_sel_hi:[0,1]
    v_pk_mul_f32 v[44:45], v[30:31], v[180:181] op_sel_hi:[0,1]
    v_pk_mul_f32 v[46:47], v[32:33], v[182:183] op_sel_hi:[0,1]
    v_pk_fma_f32 v[176:177], v[30:31], v[176:177], v[40:41] op_sel:[1,1,0] op_sel_hi:[1,0,1] neg_lo:[1,0,0]
    v_pk_fma_f32 v[178:179], v[32:33], v[178:179], v[42:43] op_sel:[1,1,0] op_sel_hi:[1,0,1] neg_lo:[1,0,0]
    v_pk_fma_f32 v[180:181], v[30:31], v[180:181], v[44:45] op_sel:[1,1,0] op_sel_hi:[1,0,1] neg_lo:[1,0,0]
    v_pk_fma_f32 v[182:183], v[32:33], v[182:183], v[46:47] op_sel:[1,1,0] op_sel_hi:[1,0,1] neg_lo:[1,0,0]
    v_pk_fma_f32 v[34:35], v[18:19], v[10:11], v[176:177] op_sel_hi:[0,1,1]
    v_pk_fma_f32 v[36:37], v[20:21], v[12:13], v[178:179] op_sel_hi:[0,1,1]
    v_pk_fma_f32 v[10:11], v[18:19], v[10:11], v[34:35] op_sel:[1,1,0] op_sel_hi:[1,0,1] neg_lo:[1,0,0]
    v_pk_fma_f32 v[12:13], v[20:21], v[12:13], v[36:37] op_sel:[1,1,0] op_sel_hi:[1,0,1] neg_lo:[1,0,0]
    v_pk_fma_f32 v[34:35], v[18:19], v[10:11], v[180:181] op_sel_hi:[0,1,1]
    v_pk_fma_f32 v[36:37], v[20:21], v[12:13], v[182:183] op_sel_hi:[0,1,1]
    v_pk_fma_f32 v[10:11], v[18:19], v[10:11], v[34:35] op_sel:[1,1,0] op_sel_hi:[1,0,1] neg_lo:[1,0,0]
    v_pk_fma_f32 v[12:13], v[20:21], v[12:13], v[36:37] op_sel:[1,1,0] op_sel_hi:[1,0,1] neg_lo:[1,0,0]
    v_lshlrev_b32 v8, 7, v2
    v_lshlrev_b32 v15, 4, v3
    v_lshlrev_b32 v17, 4, v0
    ds_write_b128 v17, v[10:13] offset:9216
    s_lshl_b32 s44, s20, 10
    v_add_u32 v17, s44, v15
    s_waitcnt lgkmcnt(0)
    ds_read_b128 v[184:187], v17 offset:9216
    ds_read_b128 v[188:191], v17 offset:9344
    ds_read_b128 v[192:195], v17 offset:9472
    ds_read_b128 v[196:199], v17 offset:9600
    ds_read_b128 v[200:203], v17 offset:9728
    ds_read_b128 v[204:207], v17 offset:9856
    ds_read_b128 v[208:211], v17 offset:9984
    ds_read_b128 v[212:215], v17 offset:10112
    s_waitcnt lgkmcnt(7)
    v_mov_b32 v10, v184
    v_mov_b32 v11, v185
    v_mov_b32 v12, v186
    v_mov_b32 v13, v187
    s_waitcnt lgkmcnt(6)
    v_pk_fma_f32 v[34:35], v[22:23], v[10:11], v[188:189] op_sel_hi:[0,1,1]
    v_pk_fma_f32 v[36:37], v[24:25], v[12:13], v[190:191] op_sel_hi:[0,1,1]
    v_pk_fma_f32 v[10:11], v[22:23], v[10:11], v[34:35] op_sel:[1,1,0] op_sel_hi:[1,0,1] neg_lo:[1,0,0]
    v_pk_fma_f32 v[12:13], v[24:25], v[12:13], v[36:37] op_sel:[1,1,0] op_sel_hi:[1,0,1] neg_lo:[1,0,0]
    s_waitcnt lgkmcnt(5)
    v_pk_fma_f32 v[34:35], v[22:23], v[10:11], v[192:193] op_sel_hi:[0,1,1]
    v_pk_fma_f32 v[36:37], v[24:25], v[12:13], v[194:195] op_sel_hi:[0,1,1]
    v_pk_fma_f32 v[10:11], v[22:23], v[10:11], v[34:35] op_sel:[1,1,0] op_sel_hi:[1,0,1] neg_lo:[1,0,0]
    v_pk_fma_f32 v[12:13], v[24:25], v[12:13], v[36:37] op_sel:[1,1,0] op_sel_hi:[1,0,1] neg_lo:[1,0,0]
    s_waitcnt lgkmcnt(4)
    v_pk_fma_f32 v[34:35], v[22:23], v[10:11], v[196:197] op_sel_hi:[0,1,1]
    v_pk_fma_f32 v[36:37], v[24:25], v[12:13], v[198:199] op_sel_hi:[0,1,1]
    v_pk_fma_f32 v[10:11], v[22:23], v[10:11], v[34:35] op_sel:[1,1,0] op_sel_hi:[1,0,1] neg_lo:[1,0,0]
    v_pk_fma_f32 v[12:13], v[24:25], v[12:13], v[36:37] op_sel:[1,1,0] op_sel_hi:[1,0,1] neg_lo:[1,0,0]
    s_waitcnt lgkmcnt(3)
    v_pk_fma_f32 v[34:35], v[22:23], v[10:11], v[200:201] op_sel_hi:[0,1,1]
    v_pk_fma_f32 v[36:37], v[24:25], v[12:13], v[202:203] op_sel_hi:[0,1,1]
    v_pk_fma_f32 v[10:11], v[22:23], v[10:11], v[34:35] op_sel:[1,1,0] op_sel_hi:[1,0,1] neg_lo:[1,0,0]
    v_pk_fma_f32 v[12:13], v[24:25], v[12:13], v[36:37] op_sel:[1,1,0] op_sel_hi:[1,0,1] neg_lo:[1,0,0]
    s_waitcnt lgkmcnt(2)
    v_pk_fma_f32 v[34:35], v[22:23], v[10:11], v[204:205] op_sel_hi:[0,1,1]
    v_pk_fma_f32 v[36:37], v[24:25], v[12:13], v[206:207] op_sel_hi:[0,1,1]
    v_pk_fma_f32 v[10:11], v[22:23], v[10:11], v[34:35] op_sel:[1,1,0] op_sel_hi:[1,0,1] neg_lo:[1,0,0]
    v_pk_fma_f32 v[12:13], v[24:25], v[12:13], v[36:37] op_sel:[1,1,0] op_sel_hi:[1,0,1] neg_lo:[1,0,0]
    s_waitcnt lgkmcnt(1)
    v_pk_fma_f32 v[34:35], v[22:23], v[10:11], v[208:209] op_sel_hi:[0,1,1]
    v_pk_fma_f32 v[36:37], v[24:25], v[12:13], v[210:211] op_sel_hi:[0,1,1]
    v_pk_fma_f32 v[10:11], v[22:23], v[10:11], v[34:35] op_sel:[1,1,0] op_sel_hi:[1,0,1] neg_lo:[1,0,0]
    v_pk_fma_f32 v[12:13], v[24:25], v[12:13], v[36:37] op_sel:[1,1,0] op_sel_hi:[1,0,1] neg_lo:[1,0,0]
    s_waitcnt lgkmcnt(0)
    v_pk_fma_f32 v[34:35], v[22:23], v[10:11], v[212:213] op_sel_hi:[0,1,1]
    v_pk_fma_f32 v[36:37], v[24:25], v[12:13], v[214:215] op_sel_hi:[0,1,1]
    v_pk_fma_f32 v[10:11], v[22:23], v[10:11], v[34:35] op_sel:[1,1,0] op_sel_hi:[1,0,1] neg_lo:[1,0,0]
    v_pk_fma_f32 v[12:13], v[24:25], v[12:13], v[36:37] op_sel:[1,1,0] op_sel_hi:[1,0,1] neg_lo:[1,0,0]
    s_lshl_b32 s44, s20, 7
    v_add_u32 v17, s44, v15
    ds_write_b128 v17, v[10:13] offset:17408
    s_waitcnt lgkmcnt(0)
    s_barrier
    ds_read_b128 v[216:219], v15 offset:17408
    ds_read_b128 v[220:223], v15 offset:17536
    ds_read_b128 v[224:227], v15 offset:17664
    ds_read_b128 v[228:231], v15 offset:17792
    ds_read_b128 v[232:235], v15 offset:17920
    ds_read_b128 v[236:239], v15 offset:18048
    ds_read_b128 v[240:243], v15 offset:18176
    v_mov_b32 v10, 0
    v_mov_b32 v11, 0
    v_mov_b32 v12, 0
    v_mov_b32 v13, 0
    v_lshrrev_b32 v17, 3, v2
    s_waitcnt lgkmcnt(0)
    s_cmp_le_u32 s20, 0
    s_cbranch_scc1 scan_w
    v_pk_fma_f32 v[34:35], v[26:27], v[10:11], v[216:217] op_sel_hi:[0,1,1]
    v_pk_fma_f32 v[36:37], v[28:29], v[12:13], v[218:219] op_sel_hi:[0,1,1]
    v_pk_fma_f32 v[10:11], v[26:27], v[10:11], v[34:35] op_sel:[1,1,0] op_sel_hi:[1,0,1] neg_lo:[1,0,0]
    v_pk_fma_f32 v[12:13], v[28:29], v[12:13], v[36:37] op_sel:[1,1,0] op_sel_hi:[1,0,1] neg_lo:[1,0,0]
    s_cmp_le_u32 s20, 1
    s_cbranch_scc1 scan_w
    v_pk_fma_f32 v[34:35], v[26:27], v[10:11], v[220:221] op_sel_hi:[0,1,1]
    v_pk_fma_f32 v[36:37], v[28:29], v[12:13], v[222:223] op_sel_hi:[0,1,1]
    v_pk_fma_f32 v[10:11], v[26:27], v[10:11], v[34:35] op_sel:[1,1,0] op_sel_hi:[1,0,1] neg_lo:[1,0,0]
    v_pk_fma_f32 v[12:13], v[28:29], v[12:13], v[36:37] op_sel:[1,1,0] op_sel_hi:[1,0,1] neg_lo:[1,0,0]
    s_cmp_le_u32 s20, 2
    s_cbranch_scc1 scan_w
    v_pk_fma_f32 v[34:35], v[26:27], v[10:11], v[224:225] op_sel_hi:[0,1,1]
    v_pk_fma_f32 v[36:37], v[28:29], v[12:13], v[226:227] op_sel_hi:[0,1,1]
    v_pk_fma_f32 v[10:11], v[26:27], v[10:11], v[34:35] op_sel:[1,1,0] op_sel_hi:[1,0,1] neg_lo:[1,0,0]
    v_pk_fma_f32 v[12:13], v[28:29], v[12:13], v[36:37] op_sel:[1,1,0] op_sel_hi:[1,0,1] neg_lo:[1,0,0]
    s_cmp_le_u32 s20, 3
    s_cbranch_scc1 scan_w
    v_pk_fma_f32 v[34:35], v[26:27], v[10:11], v[228:229] op_sel_hi:[0,1,1]
    v_pk_fma_f32 v[36:37], v[28:29], v[12:13], v[230:231] op_sel_hi:[0,1,1]
    v_pk_fma_f32 v[10:11], v[26:27], v[10:11], v[34:35] op_sel:[1,1,0] op_sel_hi:[1,0,1] neg_lo:[1,0,0]
    v_pk_fma_f32 v[12:13], v[28:29], v[12:13], v[36:37] op_sel:[1,1,0] op_sel_hi:[1,0,1] neg_lo:[1,0,0]
    s_cmp_le_u32 s20, 4
    s_cbranch_scc1 scan_w
    v_pk_fma_f32 v[34:35], v[26:27], v[10:11], v[232:233] op_sel_hi:[0,1,1]
    v_pk_fma_f32 v[36:37], v[28:29], v[12:13], v[234:235] op_sel_hi:[0,1,1]
    v_pk_fma_f32 v[10:11], v[26:27], v[10:11], v[34:35] op_sel:[1,1,0] op_sel_hi:[1,0,1] neg_lo:[1,0,0]
    v_pk_fma_f32 v[12:13], v[28:29], v[12:13], v[36:37] op_sel:[1,1,0] op_sel_hi:[1,0,1] neg_lo:[1,0,0]
    s_cmp_le_u32 s20, 5
    s_cbranch_scc1 scan_w
    v_pk_fma_f32 v[34:35], v[26:27], v[10:11], v[236:237] op_sel_hi:[0,1,1]
    v_pk_fma_f32 v[36:37], v[28:29], v[12:13], v[238:239] op_sel_hi:[0,1,1]
    v_pk_fma_f32 v[10:11], v[26:27], v[10:11], v[34:35] op_sel:[1,1,0] op_sel_hi:[1,0,1] neg_lo:[1,0,0]
    v_pk_fma_f32 v[12:13], v[28:29], v[12:13], v[36:37] op_sel:[1,1,0] op_sel_hi:[1,0,1] neg_lo:[1,0,0]
    s_cmp_le_u32 s20, 6
    s_cbranch_scc1 scan_w
    v_pk_fma_f32 v[34:35], v[26:27], v[10:11], v[240:241] op_sel_hi:[0,1,1]
    v_pk_fma_f32 v[36:37], v[28:29], v[12:13], v[242:243] op_sel_hi:[0,1,1]
    v_pk_fma_f32 v[10:11], v[26:27], v[10:11], v[34:35] op_sel:[1,1,0] op_sel_hi:[1,0,1] neg_lo:[1,0,0]
    v_pk_fma_f32 v[12:13], v[28:29], v[12:13], v[36:37] op_sel:[1,1,0] op_sel_hi:[1,0,1] neg_lo:[1,0,0]
scan_w:
    v_cmpx_lt_u32 vcc, 0, v17
    v_pk_fma_f32 v[34:35], v[22:23], v[10:11], v[184:185] op_sel_hi:[0,1,1]
    v_pk_fma_f32 v[36:37], v[24:25], v[12:13], v[186:187] op_sel_hi:[0,1,1]
    v_pk_fma_f32 v[10:11], v[22:23], v[10:11], v[34:35] op_sel:[1,1,0] op_sel_hi:[1,0,1] neg_lo:[1,0,0]
    v_pk_fma_f32 v[12:13], v[24:25], v[12:13], v[36:37] op_sel:[1,1,0] op_sel_hi:[1,0,1] neg_lo:[1,0,0]
    v_cmpx_lt_u32 vcc, 1, v17
    v_pk_fma_f32 v[34:35], v[22:23], v[10:11], v[188:189] op_sel_hi:[0,1,1]
    v_pk_fma_f32 v[36:37], v[24:25], v[12:13], v[190:191] op_sel_hi:[0,1,1]
    v_pk_fma_f32 v[10:11], v[22:23], v[10:11], v[34:35] op_sel:[1,1,0] op_sel_hi:[1,0,1] neg_lo:[1,0,0]
    v_pk_fma_f32 v[12:13], v[24:25], v[12:13], v[36:37] op_sel:[1,1,0] op_sel_hi:[1,0,1] neg_lo:[1,0,0]
    v_cmpx_lt_u32 vcc, 2, v17
    v_pk_fma_f32 v[34:35], v[22:23], v[10:11], v[192:193] op_sel_hi:[0,1,1]
    v_pk_fma_f32 v[36:37], v[24:25], v[12:13], v[194:195] op_sel_hi:[0,1,1]
    v_pk_fma_f32 v[10:11], v[22:23], v[10:11], v[34:35] op_sel:[1,1,0] op_sel_hi:[1,0,1] neg_lo:[1,0,0]
    v_pk_fma_f32 v[12:13], v[24:25], v[12:13], v[36:37] op_sel:[1,1,0] op_sel_hi:[1,0,1] neg_lo:[1,0,0]
    v_cmpx_lt_u32 vcc, 3, v17
    v_pk_fma_f32 v[34:35], v[22:23], v[10:11], v[196:197] op_sel_hi:[0,1,1]
    v_pk_fma_f32 v[36:37], v[24:25], v[12:13], v[198:199] op_sel_hi:[0,1,1]
    v_pk_fma_f32 v[10:11], v[22:23], v[10:11], v[34:35] op_sel:[1,1,0] op_sel_hi:[1,0,1] neg_lo:[1,0,0]
    v_pk_fma_f32 v[12:13], v[24:25], v[12:13], v[36:37] op_sel:[1,1,0] op_sel_hi:[1,0,1] neg_lo:[1,0,0]
    v_cmpx_lt_u32 vcc, 4, v17
    v_pk_fma_f32 v[34:35], v[22:23], v[10:11], v[200:201] op_sel_hi:[0,1,1]
    v_pk_fma_f32 v[36:37], v[24:25], v[12:13], v[202:203] op_sel_hi:[0,1,1]
    v_pk_fma_f32 v[10:11], v[22:23], v[10:11], v[34:35] op_sel:[1,1,0] op_sel_hi:[1,0,1] neg_lo:[1,0,0]
    v_pk_fma_f32 v[12:13], v[24:25], v[12:13], v[36:37] op_sel:[1,1,0] op_sel_hi:[1,0,1] neg_lo:[1,0,0]
    v_cmpx_lt_u32 vcc, 5, v17
    v_pk_fma_f32 v[34:35], v[22:23], v[10:11], v[204:205] op_sel_hi:[0,1,1]
    v_pk_fma_f32 v[36:37], v[24:25], v[12:13], v[206:207] op_sel_hi:[0,1,1]
    v_pk_fma_f32 v[10:11], v[22:23], v[10:11], v[34:35] op_sel:[1,1,0] op_sel_hi:[1,0,1] neg_lo:[1,0,0]
    v_pk_fma_f32 v[12:13], v[24:25], v[12:13], v[36:37] op_sel:[1,1,0] op_sel_hi:[1,0,1] neg_lo:[1,0,0]
    v_cmpx_lt_u32 vcc, 6, v17
    v_pk_fma_f32 v[34:35], v[22:23], v[10:11], v[208:209] op_sel_hi:[0,1,1]
    v_pk_fma_f32 v[36:37], v[24:25], v[12:13], v[210:211] op_sel_hi:[0,1,1]
    v_pk_fma_f32 v[10:11], v[22:23], v[10:11], v[34:35] op_sel:[1,1,0] op_sel_hi:[1,0,1] neg_lo:[1,0,0]
    v_pk_fma_f32 v[12:13], v[24:25], v[12:13], v[36:37] op_sel:[1,1,0] op_sel_hi:[1,0,1] neg_lo:[1,0,0]
    s_mov_b64 exec, -1
    s_barrier
    s_mul_i32 s44, s20, 16896
    v_mul_u32_u24 v48, 528, v3
    v_lshl_add_u32 v48, v17, 6, v48
    v_add_u32 v48, s44, v48
    v_lshrrev_b32 v49, 5, v2
    v_and_b32 v50, 31, v2
    v_lshlrev_b32 v50, 4, v50
    v_mul_u32_u24 v51, 528, v49
    v_add3_u32 v51, v51, v50, s44
    v_lshl_add_u32 v50, v49, 13, v50
    s_lshr_b32 s45, s29, 1
    s_lshl_b32 s45, s45, 5
    s_and_b32 s46, s29, 1
    s_lshl_b32 s46, s46, 3
    s_add_u32 s45, s45, s46
    s_lshl_b32 s45, s45, 12
    s_lshl_b32 s46, s20, 9
    s_add_u32 s45, s45, s46
    v_pk_fma_f32 v[56:57], v[18:19], v[10:11], v[56:57] op_sel_hi:[0,1,1]
    v_pk_fma_f32 v[56:57], v[18:19], v[10:11], v[56:57] op_sel:[1,1,0] op_sel_hi:[1,0,1] neg_lo:[1,0,0]
    v_pk_fma_f32 v[60:61], v[18:19], v[56:57], v[60:61] op_sel_hi:[0,1,1]
    v_pk_fma_f32 v[60:61], v[18:19], v[56:57], v[60:61] op_sel:[1,1,0] op_sel_hi:[1,0,1] neg_lo:[1,0,0]
    v_pk_fma_f32 v[64:65], v[18:19], v[60:61], v[64:65] op_sel_hi:[0,1,1]
    v_pk_fma_f32 v[64:65], v[18:19], v[60:61], v[64:65] op_sel:[1,1,0] op_sel_hi:[1,0,1] neg_lo:[1,0,0]
    v_pk_fma_f32 v[68:69], v[18:19], v[64:65], v[68:69] op_sel_hi:[0,1,1]
    v_pk_fma_f32 v[68:69], v[18:19], v[64:65], v[68:69] op_sel:[1,1,0] op_sel_hi:[1,0,1] neg_lo:[1,0,0]
    v_pk_fma_f32 v[72:73], v[18:19], v[68:69], v[72:73] op_sel_hi:[0,1,1]
    v_pk_fma_f32 v[72:73], v[18:19], v[68:69], v[72:73] op_sel:[1,1,0] op_sel_hi:[1,0,1] neg_lo:[1,0,0]
    v_pk_fma_f32 v[76:77], v[18:19], v[72:73], v[76:77] op_sel_hi:[0,1,1]
    v_pk_fma_f32 v[76:77], v[18:19], v[72:73], v[76:77] op_sel:[1,1,0] op_sel_hi:[1,0,1] neg_lo:[1,0,0]
    v_pk_fma_f32 v[80:81], v[18:19], v[76:77], v[80:81] op_sel_hi:[0,1,1]
    v_pk_fma_f32 v[80:81], v[18:19], v[76:77], v[80:81] op_sel:[1,1,0] op_sel_hi:[1,0,1] neg_lo:[1,0,0]
    v_pk_fma_f32 v[84:85], v[18:19], v[80:81], v[84:85] op_sel_hi:[0,1,1]
    v_pk_fma_f32 v[84:85], v[18:19], v[80:81], v[84:85] op_sel:[1,1,0] op_sel_hi:[1,0,1] neg_lo:[1,0,0]
    v_cvt_pk_bf16_f32 v184, v56, v60
    v_cvt_pk_bf16_f32 v185, v64, v68
    v_cvt_pk_bf16_f32 v186, v72, v76
    v_cvt_pk_bf16_f32 v187, v80, v84
    v_cvt_pk_bf16_f32 v188, -v57, -v61
    v_cvt_pk_bf16_f32 v189, -v65, -v69
    v_cvt_pk_bf16_f32 v190, -v73, -v77
    v_cvt_pk_bf16_f32 v191, -v81, -v85
    ds_write_b128 v48, v[184:187] offset:0
    ds_write_b128 v48, v[188:191] offset:4224
    v_pk_fma_f32 v[88:89], v[18:19], v[84:85], v[88:89] op_sel_hi:[0,1,1]
    v_pk_fma_f32 v[88:89], v[18:19], v[84:85], v[88:89] op_sel:[1,1,0] op_sel_hi:[1,0,1] neg_lo:[1,0,0]
    v_pk_fma_f32 v[92:93], v[18:19], v[88:89], v[92:93] op_sel_hi:[0,1,1]
    v_pk_fma_f32 v[92:93], v[18:19], v[88:89], v[92:93] op_sel:[1,1,0] op_sel_hi:[1,0,1] neg_lo:[1,0,0]
    v_pk_fma_f32 v[96:97], v[18:19], v[92:93], v[96:97] op_sel_hi:[0,1,1]
    v_pk_fma_f32 v[96:97], v[18:19], v[92:93], v[96:97] op_sel:[1,1,0] op_sel_hi:[1,0,1] neg_lo:[1,0,0]
    v_pk_fma_f32 v[100:101], v[18:19], v[96:97], v[100:101] op_sel_hi:[0,1,1]
    v_pk_fma_f32 v[100:101], v[18:19], v[96:97], v[100:101] op_sel:[1,1,0] op_sel_hi:[1,0,1] neg_lo:[1,0,0]
    v_pk_fma_f32 v[104:105], v[18:19], v[100:101], v[104:105] op_sel_hi:[0,1,1]
    v_pk_fma_f32 v[104:105], v[18:19], v[100:101], v[104:105] op_sel:[1,1,0] op_sel_hi:[1,0,1] neg_lo:[1,0,0]
    v_pk_fma_f32 v[108:109], v[18:19], v[104:105], v[108:109] op_sel_hi:[0,1,1]
    v_pk_fma_f32 v[108:109], v[18:19], v[104:105], v[108:109] op_sel:[1,1,0] op_sel_hi:[1,0,1] neg_lo:[1,0,0]
    v_pk_fma_f32 v[112:113], v[18:19], v[108:109], v[112:113] op_sel_hi:[0,1,1]
    v_pk_fma_f32 v[112:113], v[18:19], v[108:109], v[112:113] op_sel:[1,1,0] op_sel_hi:[1,0,1] neg_lo:[1,0,0]
    v_pk_fma_f32 v[116:117], v[18:19], v[112:113], v[116:117] op_sel_hi:[0,1,1]
    v_pk_fma_f32 v[116:117], v[18:19], v[112:113], v[116:117] op_sel:[1,1,0] op_sel_hi:[1,0,1] neg_lo:[1,0,0]
    v_cvt_pk_bf16_f32 v192, v88, v92
    v_cvt_pk_bf16_f32 v193, v96, v100
    v_cvt_pk_bf16_f32 v194, v104, v108
    v_cvt_pk_bf16_f32 v195, v112, v116
    v_cvt_pk_bf16_f32 v196, -v89, -v93
    v_cvt_pk_bf16_f32 v197, -v97, -v101
    v_cvt_pk_bf16_f32 v198, -v105, -v109
    v_cvt_pk_bf16_f32 v199, -v113, -v117
    ds_write_b128 v48, v[192:195] offset:16
    ds_write_b128 v48, v[196:199] offset:4240
    v_pk_fma_f32 v[120:121], v[18:19], v[116:117], v[120:121] op_sel_hi:[0,1,1]
    v_pk_fma_f32 v[120:121], v[18:19], v[116:117], v[120:121] op_sel:[1,1,0] op_sel_hi:[1,0,1] neg_lo:[1,0,0]
    v_pk_fma_f32 v[124:125], v[18:19], v[120:121], v[124:125] op_sel_hi:[0,1,1]
    v_pk_fma_f32 v[124:125], v[18:19], v[120:121], v[124:125] op_sel:[1,1,0] op_sel_hi:[1,0,1] neg_lo:[1,0,0]
    v_pk_fma_f32 v[128:129], v[18:19], v[124:125], v[128:129] op_sel_hi:[0,1,1]
    v_pk_fma_f32 v[128:129], v[18:19], v[124:125], v[128:129] op_sel:[1,1,0] op_sel_hi:[1,0,1] neg_lo:[1,0,0]
    v_pk_fma_f32 v[132:133], v[18:19], v[128:129], v[132:133] op_sel_hi:[0,1,1]
    v_pk_fma_f32 v[132:133], v[18:19], v[128:129], v[132:133] op_sel:[1,1,0] op_sel_hi:[1,0,1] neg_lo:[1,0,0]
    v_pk_fma_f32 v[136:137], v[18:19], v[132:133], v[136:137] op_sel_hi:[0,1,1]
    v_pk_fma_f32 v[136:137], v[18:19], v[132:133], v[136:137] op_sel:[1,1,0] op_sel_hi:[1,0,1] neg_lo:[1,0,0]
    v_pk_fma_f32 v[140:141], v[18:19], v[136:137], v[140:141] op_sel_hi:[0,1,1]
    v_pk_fma_f32 v[140:141], v[18:19], v[136:137], v[140:141] op_sel:[1,1,0] op_sel_hi:[1,0,1] neg_lo:[1,0,0]
    v_pk_fma_f32 v[144:145], v[18:19], v[140:141], v[144:145] op_sel_hi:[0,1,1]
    v_pk_fma_f32 v[144:145], v[18:19], v[140:141], v[144:145] op_sel:[1,1,0] op_sel_hi:[1,0,1] neg_lo:[1,0,0]
    v_pk_fma_f32 v[148:149], v[18:19], v[144:145], v[148:149] op_sel_hi:[0,1,1]
    v_pk_fma_f32 v[148:149], v[18:19], v[144:145], v[148:149] op_sel:[1,1,0] op_sel_hi:[1,0,1] neg_lo:[1,0,0]
    v_cvt_pk_bf16_f32 v200, v120, v124
    v_cvt_pk_bf16_f32 v201, v128, v132
    v_cvt_pk_bf16_f32 v202, v136, v140
    v_cvt_pk_bf16_f32 v203, v144, v148
    v_cvt_pk_bf16_f32 v204, -v121, -v125
    v_cvt_pk_bf16_f32 v205, -v129, -v133
    v_cvt_pk_bf16_f32 v206, -v137, -v141
    v_cvt_pk_bf16_f32 v207, -v145, -v149
    ds_write_b128 v48, v[200:203] offset:32
    ds_write_b128 v48, v[204:207] offset:4256
    v_pk_fma_f32 v[152:153], v[18:19], v[148:149], v[152:153] op_sel_hi:[0,1,1]
    v_pk_fma_f32 v[152:153], v[18:19], v[148:149], v[152:153] op_sel:[1,1,0] op_sel_hi:[1,0,1] neg_lo:[1,0,0]
    v_pk_fma_f32 v[156:157], v[18:19], v[152:153], v[156:157] op_sel_hi:[0,1,1]
    v_pk_fma_f32 v[156:157], v[18:19], v[152:153], v[156:157] op_sel:[1,1,0] op_sel_hi:[1,0,1] neg_lo:[1,0,0]
    v_pk_fma_f32 v[160:161], v[18:19], v[156:157], v[160:161] op_sel_hi:[0,1,1]
    v_pk_fma_f32 v[160:161], v[18:19], v[156:157], v[160:161] op_sel:[1,1,0] op_sel_hi:[1,0,1] neg_lo:[1,0,0]
    v_pk_fma_f32 v[164:165], v[18:19], v[160:161], v[164:165] op_sel_hi:[0,1,1]
    v_pk_fma_f32 v[164:165], v[18:19], v[160:161], v[164:165] op_sel:[1,1,0] op_sel_hi:[1,0,1] neg_lo:[1,0,0]
    v_pk_fma_f32 v[168:169], v[18:19], v[164:165], v[168:169] op_sel_hi:[0,1,1]
    v_pk_fma_f32 v[168:169], v[18:19], v[164:165], v[168:169] op_sel:[1,1,0] op_sel_hi:[1,0,1] neg_lo:[1,0,0]
    v_pk_fma_f32 v[172:173], v[18:19], v[168:169], v[172:173] op_sel_hi:[0,1,1]
    v_pk_fma_f32 v[172:173], v[18:19], v[168:169], v[172:173] op_sel:[1,1,0] op_sel_hi:[1,0,1] neg_lo:[1,0,0]
    v_pk_fma_f32 v[176:177], v[18:19], v[172:173], v[176:177] op_sel_hi:[0,1,1]
    v_pk_fma_f32 v[176:177], v[18:19], v[172:173], v[176:177] op_sel:[1,1,0] op_sel_hi:[1,0,1] neg_lo:[1,0,0]
    v_pk_fma_f32 v[180:181], v[18:19], v[176:177], v[180:181] op_sel_hi:[0,1,1]
    v_pk_fma_f32 v[180:181], v[18:19], v[176:177], v[180:181] op_sel:[1,1,0] op_sel_hi:[1,0,1] neg_lo:[1,0,0]
    v_cvt_pk_bf16_f32 v208, v152, v156
    v_cvt_pk_bf16_f32 v209, v160, v164
    v_cvt_pk_bf16_f32 v210, v168, v172
    v_cvt_pk_bf16_f32 v211, v176, v180
    v_cvt_pk_bf16_f32 v212, -v153, -v157
    v_cvt_pk_bf16_f32 v213, -v161, -v165
    v_cvt_pk_bf16_f32 v214, -v169, -v173
    v_cvt_pk_bf16_f32 v215, -v177, -v181
    ds_write_b128 v48, v[208:211] offset:48
    ds_write_b128 v48, v[212:215] offset:4272
    s_waitcnt lgkmcnt(0)
    ds_read_b128 v[216:219], v51 offset:0
    ds_read_b128 v[220:223], v51 offset:1056
    ds_read_b128 v[224:227], v51 offset:2112
    ds_read_b128 v[228:231], v51 offset:3168
    ds_read_b128 v[232:235], v51 offset:4224
    ds_read_b128 v[236:239], v51 offset:5280
    ds_read_b128 v[240:243], v51 offset:6336
    ds_read_b128 v[244:247], v51 offset:7392
    s_waitcnt lgkmcnt(7)
    s_add_u32 s46, s45, 0
    buffer_store_dwordx4 v[216:219], v50, s[12:15], s46 offen sc1
    s_waitcnt lgkmcnt(6)
    s_add_u32 s46, s45, 65536
    buffer_store_dwordx4 v[220:223], v50, s[12:15], s46 offen sc1
    s_waitcnt lgkmcnt(5)
    s_add_u32 s46, s45, 16384
    buffer_store_dwordx4 v[224:227], v50, s[12:15], s46 offen sc1
    s_waitcnt lgkmcnt(4)
    s_add_u32 s46, s45, 81920
    buffer_store_dwordx4 v[228:231], v50, s[12:15], s46 offen sc1
    s_waitcnt lgkmcnt(3)
    s_add_u32 s46, s45, 2359296
    buffer_store_dwordx4 v[232:235], v50, s[12:15], s46 offen sc1
    s_waitcnt lgkmcnt(2)
    s_add_u32 s46, s45, 2424832
    buffer_store_dwordx4 v[236:239], v50, s[12:15], s46 offen sc1
    s_waitcnt lgkmcnt(1)
    s_add_u32 s46, s45, 2375680
    buffer_store_dwordx4 v[240:243], v50, s[12:15], s46 offen sc1
    s_waitcnt lgkmcnt(0)
    s_add_u32 s46, s45, 2441216
    buffer_store_dwordx4 v[244:247], v50, s[12:15], s46 offen sc1
    v_pk_fma_f32 v[58:59], v[20:21], v[12:13], v[58:59] op_sel_hi:[0,1,1]
    v_pk_fma_f32 v[58:59], v[20:21], v[12:13], v[58:59] op_sel:[1,1,0] op_sel_hi:[1,0,1] neg_lo:[1,0,0]
    v_pk_fma_f32 v[62:63], v[20:21], v[58:59], v[62:63] op_sel_hi:[0,1,1]
    v_pk_fma_f32 v[62:63], v[20:21], v[58:59], v[62:63] op_sel:[1,1,0] op_sel_hi:[1,0,1] neg_lo:[1,0,0]
    v_pk_fma_f32 v[66:67], v[20:21], v[62:63], v[66:67] op_sel_hi:[0,1,1]
    v_pk_fma_f32 v[66:67], v[20:21], v[62:63], v[66:67] op_sel:[1,1,0] op_sel_hi:[1,0,1] neg_lo:[1,0,0]
    v_pk_fma_f32 v[70:71], v[20:21], v[66:67], v[70:71] op_sel_hi:[0,1,1]
    v_pk_fma_f32 v[70:71], v[20:21], v[66:67], v[70:71] op_sel:[1,1,0] op_sel_hi:[1,0,1] neg_lo:[1,0,0]
    v_pk_fma_f32 v[74:75], v[20:21], v[70:71], v[74:75] op_sel_hi:[0,1,1]
    v_pk_fma_f32 v[74:75], v[20:21], v[70:71], v[74:75] op_sel:[1,1,0] op_sel_hi:[1,0,1] neg_lo:[1,0,0]
    v_pk_fma_f32 v[78:79], v[20:21], v[74:75], v[78:79] op_sel_hi:[0,1,1]
    v_pk_fma_f32 v[78:79], v[20:21], v[74:75], v[78:79] op_sel:[1,1,0] op_sel_hi:[1,0,1] neg_lo:[1,0,0]
    v_pk_fma_f32 v[82:83], v[20:21], v[78:79], v[82:83] op_sel_hi:[0,1,1]
    v_pk_fma_f32 v[82:83], v[20:21], v[78:79], v[82:83] op_sel:[1,1,0] op_sel_hi:[1,0,1] neg_lo:[1,0,0]
    v_pk_fma_f32 v[86:87], v[20:21], v[82:83], v[86:87] op_sel_hi:[0,1,1]
    v_pk_fma_f32 v[86:87], v[20:21], v[82:83], v[86:87] op_sel:[1,1,0] op_sel_hi:[1,0,1] neg_lo:[1,0,0]
    v_cvt_pk_bf16_f32 v184, v58, v62
    v_cvt_pk_bf16_f32 v185, v66, v70
    v_cvt_pk_bf16_f32 v186, v74, v78
    v_cvt_pk_bf16_f32 v187, v82, v86
    v_cvt_pk_bf16_f32 v188, -v59, -v63
    v_cvt_pk_bf16_f32 v189, -v67, -v71
    v_cvt_pk_bf16_f32 v190, -v75, -v79
    v_cvt_pk_bf16_f32 v191, -v83, -v87
    ds_write_b128 v48, v[184:187] offset:8448
    ds_write_b128 v48, v[188:191] offset:12672
    v_pk_fma_f32 v[90:91], v[20:21], v[86:87], v[90:91] op_sel_hi:[0,1,1]
    v_pk_fma_f32 v[90:91], v[20:21], v[86:87], v[90:91] op_sel:[1,1,0] op_sel_hi:[1,0,1] neg_lo:[1,0,0]
    v_pk_fma_f32 v[94:95], v[20:21], v[90:91], v[94:95] op_sel_hi:[0,1,1]
    v_pk_fma_f32 v[94:95], v[20:21], v[90:91], v[94:95] op_sel:[1,1,0] op_sel_hi:[1,0,1] neg_lo:[1,0,0]
    v_pk_fma_f32 v[98:99], v[20:21], v[94:95], v[98:99] op_sel_hi:[0,1,1]
    v_pk_fma_f32 v[98:99], v[20:21], v[94:95], v[98:99] op_sel:[1,1,0] op_sel_hi:[1,0,1] neg_lo:[1,0,0]
    v_pk_fma_f32 v[102:103], v[20:21], v[98:99], v[102:103] op_sel_hi:[0,1,1]
    v_pk_fma_f32 v[102:103], v[20:21], v[98:99], v[102:103] op_sel:[1,1,0] op_sel_hi:[1,0,1] neg_lo:[1,0,0]
    v_pk_fma_f32 v[106:107], v[20:21], v[102:103], v[106:107] op_sel_hi:[0,1,1]
    v_pk_fma_f32 v[106:107], v[20:21], v[102:103], v[106:107] op_sel:[1,1,0] op_sel_hi:[1,0,1] neg_lo:[1,0,0]
    v_pk_fma_f32 v[110:111], v[20:21], v[106:107], v[110:111] op_sel_hi:[0,1,1]
    v_pk_fma_f32 v[110:111], v[20:21], v[106:107], v[110:111] op_sel:[1,1,0] op_sel_hi:[1,0,1] neg_lo:[1,0,0]
    v_pk_fma_f32 v[114:115], v[20:21], v[110:111], v[114:115] op_sel_hi:[0,1,1]
    v_pk_fma_f32 v[114:115], v[20:21], v[110:111], v[114:115] op_sel:[1,1,0] op_sel_hi:[1,0,1] neg_lo:[1,0,0]
    v_pk_fma_f32 v[118:119], v[20:21], v[114:115], v[118:119] op_sel_hi:[0,1,1]
    v_pk_fma_f32 v[118:119], v[20:21], v[114:115], v[118:119] op_sel:[1,1,0] op_sel_hi:[1,0,1] neg_lo:[1,0,0]
    v_cvt_pk_bf16_f32 v192, v90, v94
    v_cvt_pk_bf16_f32 v193, v98, v102
    v_cvt_pk_bf16_f32 v194, v106, v110
    v_cvt_pk_bf16_f32 v195, v114, v118
    v_cvt_pk_bf16_f32 v196, -v91, -v95
    v_cvt_pk_bf16_f32 v197, -v99, -v103
    v_cvt_pk_bf16_f32 v198, -v107, -v111
    v_cvt_pk_bf16_f32 v199, -v115, -v119
    ds_write_b128 v48, v[192:195] offset:8464
    ds_write_b128 v48, v[196:199] offset:12688
    v_pk_fma_f32 v[122:123], v[20:21], v[118:119], v[122:123] op_sel_hi:[0,1,1]
    v_pk_fma_f32 v[122:123], v[20:21], v[118:119], v[122:123] op_sel:[1,1,0] op_sel_hi:[1,0,1] neg_lo:[1,0,0]
    v_pk_fma_f32 v[126:127], v[20:21], v[122:123], v[126:127] op_sel_hi:[0,1,1]
    v_pk_fma_f32 v[126:127], v[20:21], v[122:123], v[126:127] op_sel:[1,1,0] op_sel_hi:[1,0,1] neg_lo:[1,0,0]
    v_pk_fma_f32 v[130:131], v[20:21], v[126:127], v[130:131] op_sel_hi:[0,1,1]
    v_pk_fma_f32 v[130:131], v[20:21], v[126:127], v[130:131] op_sel:[1,1,0] op_sel_hi:[1,0,1] neg_lo:[1,0,0]
    v_pk_fma_f32 v[134:135], v[20:21], v[130:131], v[134:135] op_sel_hi:[0,1,1]
    v_pk_fma_f32 v[134:135], v[20:21], v[130:131], v[134:135] op_sel:[1,1,0] op_sel_hi:[1,0,1] neg_lo:[1,0,0]
    v_pk_fma_f32 v[138:139], v[20:21], v[134:135], v[138:139] op_sel_hi:[0,1,1]
    v_pk_fma_f32 v[138:139], v[20:21], v[134:135], v[138:139] op_sel:[1,1,0] op_sel_hi:[1,0,1] neg_lo:[1,0,0]
    v_pk_fma_f32 v[142:143], v[20:21], v[138:139], v[142:143] op_sel_hi:[0,1,1]
    v_pk_fma_f32 v[142:143], v[20:21], v[138:139], v[142:143] op_sel:[1,1,0] op_sel_hi:[1,0,1] neg_lo:[1,0,0]
    v_pk_fma_f32 v[146:147], v[20:21], v[142:143], v[146:147] op_sel_hi:[0,1,1]
    v_pk_fma_f32 v[146:147], v[20:21], v[142:143], v[146:147] op_sel:[1,1,0] op_sel_hi:[1,0,1] neg_lo:[1,0,0]
    v_pk_fma_f32 v[150:151], v[20:21], v[146:147], v[150:151] op_sel_hi:[0,1,1]
    v_pk_fma_f32 v[150:151], v[20:21], v[146:147], v[150:151] op_sel:[1,1,0] op_sel_hi:[1,0,1] neg_lo:[1,0,0]
    v_cvt_pk_bf16_f32 v200, v122, v126
    v_cvt_pk_bf16_f32 v201, v130, v134
    v_cvt_pk_bf16_f32 v202, v138, v142
    v_cvt_pk_bf16_f32 v203, v146, v150
    v_cvt_pk_bf16_f32 v204, -v123, -v127
    v_cvt_pk_bf16_f32 v205, -v131, -v135
    v_cvt_pk_bf16_f32 v206, -v139, -v143
    v_cvt_pk_bf16_f32 v207, -v147, -v151
    ds_write_b128 v48, v[200:203] offset:8480
    ds_write_b128 v48, v[204:207] offset:12704
    v_pk_fma_f32 v[154:155], v[20:21], v[150:151], v[154:155] op_sel_hi:[0,1,1]
    v_pk_fma_f32 v[154:155], v[20:21], v[150:151], v[154:155] op_sel:[1,1,0] op_sel_hi:[1,0,1] neg_lo:[1,0,0]
    v_pk_fma_f32 v[158:159], v[20:21], v[154:155], v[158:159] op_sel_hi:[0,1,1]
    v_pk_fma_f32 v[158:159], v[20:21], v[154:155], v[158:159] op_sel:[1,1,0] op_sel_hi:[1,0,1] neg_lo:[1,0,0]
    v_pk_fma_f32 v[162:163], v[20:21], v[158:159], v[162:163] op_sel_hi:[0,1,1]
    v_pk_fma_f32 v[162:163], v[20:21], v[158:159], v[162:163] op_sel:[1,1,0] op_sel_hi:[1,0,1] neg_lo:[1,0,0]
    v_pk_fma_f32 v[166:167], v[20:21], v[162:163], v[166:167] op_sel_hi:[0,1,1]
    v_pk_fma_f32 v[166:167], v[20:21], v[162:163], v[166:167] op_sel:[1,1,0] op_sel_hi:[1,0,1] neg_lo:[1,0,0]
    v_pk_fma_f32 v[170:171], v[20:21], v[166:167], v[170:171] op_sel_hi:[0,1,1]
    v_pk_fma_f32 v[170:171], v[20:21], v[166:167], v[170:171] op_sel:[1,1,0] op_sel_hi:[1,0,1] neg_lo:[1,0,0]
    v_pk_fma_f32 v[174:175], v[20:21], v[170:171], v[174:175] op_sel_hi:[0,1,1]
    v_pk_fma_f32 v[174:175], v[20:21], v[170:171], v[174:175] op_sel:[1,1,0] op_sel_hi:[1,0,1] neg_lo:[1,0,0]
    v_pk_fma_f32 v[178:179], v[20:21], v[174:175], v[178:179] op_sel_hi:[0,1,1]
    v_pk_fma_f32 v[178:179], v[20:21], v[174:175], v[178:179] op_sel:[1,1,0] op_sel_hi:[1,0,1] neg_lo:[1,0,0]
    v_pk_fma_f32 v[182:183], v[20:21], v[178:179], v[182:183] op_sel_hi:[0,1,1]
    v_pk_fma_f32 v[182:183], v[20:21], v[178:179], v[182:183] op_sel:[1,1,0] op_sel_hi:[1,0,1] neg_lo:[1,0,0]
    v_cvt_pk_bf16_f32 v208, v154, v158
    v_cvt_pk_bf16_f32 v209, v162, v166
    v_cvt_pk_bf16_f32 v210, v170, v174
    v_cvt_pk_bf16_f32 v211, v178, v182
    v_cvt_pk_bf16_f32 v212, -v155, -v159
    v_cvt_pk_bf16_f32 v213, -v163, -v167
    v_cvt_pk_bf16_f32 v214, -v171, -v175
    v_cvt_pk_bf16_f32 v215, -v179, -v183
    ds_write_b128 v48, v[208:211] offset:8496
    ds_write_b128 v48, v[212:215] offset:12720
    s_waitcnt lgkmcnt(0)
    ds_read_b128 v[56:59], v51 offset:8448
    ds_read_b128 v[60:63], v51 offset:9504
    ds_read_b128 v[64:67], v51 offset:10560
    ds_read_b128 v[68:71], v51 offset:11616
    ds_read_b128 v[72:75], v51 offset:12672
    ds_read_b128 v[76:79], v51 offset:13728
    ds_read_b128 v[80:83], v51 offset:14784
    ds_read_b128 v[84:87], v51 offset:15840
    s_waitcnt lgkmcnt(7)
    s_add_u32 s46, s45, 4096
    buffer_store_dwordx4 v[56:59], v50, s[12:15], s46 offen sc1
    s_waitcnt lgkmcnt(6)
    s_add_u32 s46, s45, 69632
    buffer_store_dwordx4 v[60:63], v50, s[12:15], s46 offen sc1
    s_waitcnt lgkmcnt(5)
    s_add_u32 s46, s45, 20480
    buffer_store_dwordx4 v[64:67], v50, s[12:15], s46 offen sc1
    s_waitcnt lgkmcnt(4)
    s_add_u32 s46, s45, 86016
    buffer_store_dwordx4 v[68:71], v50, s[12:15], s46 offen sc1
    s_waitcnt lgkmcnt(3)
    s_add_u32 s46, s45, 2363392
    buffer_store_dwordx4 v[72:75], v50, s[12:15], s46 offen sc1
    s_waitcnt lgkmcnt(2)
    s_add_u32 s46, s45, 2428928
    buffer_store_dwordx4 v[76:79], v50, s[12:15], s46 offen sc1
    s_waitcnt lgkmcnt(1)
    s_add_u32 s46, s45, 2379776
    buffer_store_dwordx4 v[80:83], v50, s[12:15], s46 offen sc1
    s_waitcnt lgkmcnt(0)
    s_add_u32 s46, s45, 2445312
    buffer_store_dwordx4 v[84:87], v50, s[12:15], s46 offen sc1
    s_lshl_b32 s52, s20, 9
    s_lshl_b32 s44, s29, 3
    s_add_u32 s52, s52, s44
    s_add_u32 s52, s52, 16384
    s_waitcnt vmcnt(0)
    s_mov_b64 exec, 1
    buffer_store_dwordx2 v[250:251], v248, s[16:19], s52 offen sc1
    s_mov_b64 exec, -1
    s_barrier
    s_cmp_ge_u32 s20, 4
    s_cbranch_scc1 scan_done
    s_lshl_b32 s44, s29, 2
    s_sub_u32 s23, s23, s44
    s_sub_u32 s58, s23, 2466
    s_bfe_u32 s54, s58, 0x20005
    s_mul_i32 s54, s54, 576
    s_lshr_b32 s55, s58, 7
    s_lshl_b32 s55, s55, 5
    s_add_u32 s54, s54, s55
    s_and_b32 s58, s58, 31
    s_add_u32 s58, s58, s54
    s_cmp_ge_u32 s23, 4770
    s_cselect_b32 s58, 4096, s58
    s_mov_b32 s60, s88
    s_mov_b32 s61, s89
    s_mov_b32 s62, 18874368
    s_sub_u32 s54, s23, 2385
    s_cmp_lt_u32 s23, 2466
    s_cselect_b32 s58, s54, s58
    s_cselect_b32 s60, s76, s60
    s_cselect_b32 s61, s77, s61
    s_cselect_b32 s62, 663552, s62
    s_sub_u32 s54, s23, 2304
    s_cmp_lt_u32 s23, 2385
    s_cselect_b32 s58, s54, s58
    s_cselect_b32 s60, s74, s60
    s_cselect_b32 s61, s75, s61
    s_cselect_b32 s62, 663552, s62
    s_mov_b32 s63, 0x00020000
    s_lshl_b32 s58, s58, 13
    buffer_load_dword v9, v8, s[60:63], s58 offen
    s_add_u32 s23, s23, 320
scan_done:
    s_waitcnt vmcnt(0)
    s_barrier
    s_cmp_lt_u32 s20, 4
    s_cbranch_scc1 c3_entry
    s_branch l3_entry
text_end:
    s_endpgm
.section .rodata,"a"
.p2align 6
.amdhsa_kernel parallel_sum__ssm_conv_s5__mixer_token_mlp__prompt_kernel
  .amdhsa_next_free_vgpr 256
  .amdhsa_next_free_sgpr 102
  .amdhsa_accum_offset 256
  .amdhsa_group_segment_fixed_size 0
  .amdhsa_kernarg_size 136
  .amdhsa_user_sgpr_count 2
  .amdhsa_user_sgpr_kernarg_segment_ptr 1
  .amdhsa_system_sgpr_workgroup_id_x 1
.end_amdhsa_kernel
```
